```python
import torch

def _softmax(x, axis=-1):
    return torch.softmax(x, dim=axis)
def _gelu(x):
    return torch.nn.functional.gelu(x, approximate="tanh")
def _silu(x):
    return torch.nn.functional.silu(x)
def _sigmoid(x):
    return torch.sigmoid(x)
def _layernorm(x, axis=-1, eps=1e-5):
    m = x.mean(dim=axis, keepdim=True)
    v = x.var(dim=axis, keepdim=True, unbiased=False)
    return (x - m) / torch.sqrt(v + eps)
def _scatter_add(tgt, idx, src, axis=0):
    return tgt.clone().index_add_(axis, idx, src)
def _segment_sum(src, seg, n):
    out = torch.zeros((n,) + src.shape[1:], dtype=src.dtype)
    return out.index_add_(0, seg, src)
def _pad(x, pw):
    flat = tuple(v for pair in reversed(pw) for v in pair)
    return torch.nn.functional.pad(x, flat)

kernel_name = 'interleave_layers__mha_block__dense_activation_mish__prompt'

def setup_inputs():

    _w = (lambda a: (lambda t: t.to(torch.bfloat16) if t.is_floating_point() else t)(torch.as_tensor(a)))
    def _A_setup():
        B, S, D, H = 1, 2048, 512, 32
        return {
            "x": _w((lambda *s: torch.randn(*s, dtype=torch.bfloat16) * 0.05)(B, S, D)),
            "wqkv": _w((lambda *s: torch.randn(*s, dtype=torch.bfloat16) * 0.05)(D, 3 * D)),
            "wo": _w((lambda *s: torch.randn(*s, dtype=torch.bfloat16) * 0.05)(D, D)),
        }
    _A_in = _A_setup()

    def _B_setup():
        B, S, D, F = 1, 2048, 512, 1376
        return {
            "x": _w((lambda *s: torch.randn(*s, dtype=torch.bfloat16) * 0.05)(B, S, D)),
            "w1": _w((lambda *s: torch.randn(*s, dtype=torch.bfloat16) * 1.6)(D, F) * (D ** -0.5)),
            "b1": _w((lambda *s: torch.randn(*s, dtype=torch.bfloat16) * 0.2)(F)),
            "w2": _w((lambda *s: torch.randn(*s, dtype=torch.bfloat16) * 0.2)(F, D) * (F ** -0.5)),
        }
    _B_in = _B_setup()

    return {
        "A_x": _A_in["x"],
        "A_wqkv": _A_in["wqkv"],
        "A_wo": _A_in["wo"],
        "B_x": _B_in["x"],
        "B_w1": _B_in["w1"],
        "B_b1": _B_in["b1"],
        "B_w2": _B_in["w2"],
    }

def reference(A_x, A_wqkv, A_wo, B_x, B_w1, B_b1, B_w2):
    def _A_ref(x, wqkv, wo):
        B, S, D = x.shape
        H = 32
        Dh = D // H
        qkv = (lambda x, *d: x.permute(*d))((x @ wqkv).reshape(B, S, 3, H, Dh), 2, 0, 3, 1, 4)
        q, k, v = qkv[0], qkv[1], qkv[2]
        scores = torch.einsum("bhqd,bhkd->bhqk", q, k) * (Dh ** -0.5)
        p = _softmax(scores, axis=-1)
        o = torch.einsum("bhqk,bhkd->bhqd", p, v)
        return (lambda x, *d: x.permute(*d))(o, 0, 2, 1, 3).reshape(B, S, D) @ wo

    def _B_ref(x, w1, b1, w2):
        h = torch.einsum("bsd,df->bsf", x, w1) + b1
        sp = torch.log1p(torch.exp(-torch.abs(h))) + torch.where(h > 0, h, torch.zeros_like(h))
        act = h * torch.tanh(sp)
        return torch.einsum("bsf,fd->bsd", act, w2)

    x = A_x
    x = x + _A_ref(_layernorm(x, axis=-1), A_wqkv, A_wo)
    x = x + _B_ref(_layernorm(x, axis=-1), B_w1, B_b1, B_w2)
    x = x + _A_ref(_layernorm(x, axis=-1), A_wqkv, A_wo)
    x = x + _B_ref(_layernorm(x, axis=-1), B_w1, B_b1, B_w2)
    return x
```

```asm
; @launch grid=(256,1,1) block=(256,1,1) lds=163840
.amdgcn_target "amdgcn-amd-amdhsa--gfx950"
.text
.globl interleave_layers__mha_block__dense_activation_mish__prompt_kernel
.p2align 8
.type interleave_layers__mha_block__dense_activation_mish__prompt_kernel,@function
interleave_layers__mha_block__dense_activation_mish__prompt_kernel:
  s_cmp_ge_u32 s2, 256
  s_cbranch_scc1 main_end
  s_load_dwordx4 s[8:11], s[0:1], 0
  s_load_dwordx4 s[20:23], s[0:1], 64
  s_getpc_b64 s[60:61]
p0_pc:
  s_and_b32 s62, s2, 8
  s_lshl_b32 s62, s62, 12
  s_sub_u32 s63, main_end-p0_pc, s62
  s_add_u32 s60, s60, s62
  s_addc_u32 s61, s61, 0
  v_lshlrev_b32 v182, 7, v0
  v_min_u32 v182, s63, v182
  v_mov_b32 v183, s61
  v_add_co_u32 v182, vcc, s60, v182
  s_nop 1
  v_addc_co_u32 v183, vcc, 0, v183, vcc
  global_load_dword v184, v[182:183], off
  s_load_dwordx2 s[84:85], s[0:1], 16
  s_load_dwordx4 s[88:91], s[0:1], 32
  s_load_dwordx2 s[86:87], s[0:1], 48
  v_and_b32 v1, 63, v0
  v_lshrrev_b32 v4, 6, v0
  s_nop 0
  v_readfirstlane_b32 s12, v4
  s_and_b32 s13, s2, 7
  s_lshr_b32 s14, s2, 3
  s_lshl_b32 s15, s13, 2
  s_and_b32 s33, s14, 3
  s_add_u32 s15, s15, s33
  s_lshr_b32 s18, s14, 2
  s_add_u32 s48, s18, s13
  s_and_b32 s48, s48, 7
  v_lshrrev_b32 v4, 3, v1
  v_and_b32 v5, 7, v1
  v_bfe_u32 v6, v1, 4, 1
  v_lshlrev_b32 v6, 2, v6
  v_xor_b32 v6, v5, v6
  v_mul_u32_u24 v8, 3072, v4
  v_lshl_add_u32 v8, v6, 4, v8
  v_lshrrev_b32 v6, 4, v1
  v_xor_b32 v6, v5, v6
  v_lshlrev_b32 v9, 10, v4
  v_lshl_add_u32 v9, v6, 4, v9
  v_xor_b32 v10, 64, v9
  v_add_u32 v10, 7168, v10
  s_mul_i32 s40, s12, 24576
  s_lshl_b32 s33, s18, 7
  s_add_u32 s40, s40, s33
  s_lshl_b32 s43, s15, 16
  s_lshl_b32 s33, s12, 14
  s_add_u32 s43, s43, s33
  s_mul_i32 s33, s48, 196608
  s_add_u32 s40, s40, s33
  s_lshl_b32 s33, s48, 7
  s_add_u32 s43, s43, s33
  s_mov_b32 s49, 196608
  s_movk_i32 s51, 128
  s_mov_b32 s76, s18
  s_mov_b32 s77, s18
  s_mul_i32 s44, s12, 3072
  s_lshl_b32 s45, s12, 11
  s_add_u32 s45, s45, 98304
  s_sub_u32 s33, s2, 64
  s_lshl_b32 s34, s33, 2
  s_add_u32 s34, s34, s12
  s_mul_i32 s34, s34, 23040
  s_add_u32 s34, s34, 42991616
  s_add_u32 s53, s34, 11520
  v_min_u32 v4, 44, v1
  v_lshlrev_b32 v4, 8, v4
  v_mov_b32 v5, 0
  s_waitcnt lgkmcnt(0)
  s_mov_b32 s4, s22
  s_and_b32 s5, s23, 0xffff
  s_mov_b32 s6, 268435456
  s_mov_b32 s7, 0x00020000
  s_mov_b32 s28, s10
  s_and_b32 s29, s11, 0xffff
  s_mov_b32 s30, 1572864
  s_mov_b32 s31, 0x00020000
  s_and_b32 s9, s9, 0xffff
  s_mov_b32 s10, 2097152
  s_mov_b32 s11, 0x00020000
  s_cmp_lt_u32 s33, 32
  s_cselect_b32 s35, 1, 0
  s_cbranch_scc0 p0_noclr
  buffer_store_dword v5, v4, s[4:7], s34 offen sc1
  buffer_store_dword v5, v4, s[4:7], s53 offen sc1
p0_noclr:
  s_lshl_b32 s33, s2, 2
  s_add_u32 s33, s33, s12
  s_mul_i32 s33, s33, 1536
  v_lshlrev_b32 v185, 7, v1
  s_mov_b64 exec, 0xfff
  buffer_load_dword v187, v185, s[28:31], s33 offen
  s_mov_b64 exec, -1
  s_add_u32 m0, s45, 0
  s_add_u32 s46, s40, 98304
  buffer_load_dwordx4 v9, s[8:11], s43 offen lds
  buffer_load_dwordx4 v10, s[8:11], s43 offen offset:1024 lds
  s_add_u32 m0, s44, 0
  s_add_u32 s48, s48, 1
  buffer_load_dwordx4 v8, s[28:31], s40 offen offset:0 lds
  buffer_load_dwordx4 v8, s[28:31], s40 offen offset:1024 lds
  buffer_load_dwordx4 v8, s[28:31], s40 offen offset:2048 lds
  s_cmp_eq_u32 s48, 8
  s_cselect_b32 s50, 4294966400, s51
  s_cselect_b32 s52, 4293591040, s49
  s_add_u32 m0, s44, 12288
  s_add_u32 s43, s43, s50
  buffer_load_dwordx4 v8, s[28:31], s46 offen offset:0 lds
  buffer_load_dwordx4 v8, s[28:31], s46 offen offset:1024 lds
  buffer_load_dwordx4 v8, s[28:31], s46 offen offset:2048 lds
  s_add_u32 s40, s40, s52
  s_and_b32 s21, s21, 0xffff
  s_mov_b32 s22, 256
  s_mov_b32 s23, 0x00020000
  s_add_u32 m0, s45, 8192
  s_add_u32 s46, s40, 98304
  buffer_load_dwordx4 v9, s[8:11], s43 offen lds
  buffer_load_dwordx4 v10, s[8:11], s43 offen offset:1024 lds
  s_add_u32 m0, s44, 24576
  s_add_u32 s48, s48, 1
  buffer_load_dwordx4 v8, s[28:31], s40 offen offset:0 lds
  buffer_load_dwordx4 v8, s[28:31], s40 offen offset:1024 lds
  buffer_load_dwordx4 v8, s[28:31], s40 offen offset:2048 lds
  s_cmp_eq_u32 s48, 8
  s_cselect_b32 s50, 4294966400, s51
  s_cselect_b32 s52, 4293591040, s49
  s_add_u32 m0, s44, 36864
  s_add_u32 s43, s43, s50
  buffer_load_dwordx4 v8, s[28:31], s46 offen offset:0 lds
  buffer_load_dwordx4 v8, s[28:31], s46 offen offset:1024 lds
  buffer_load_dwordx4 v8, s[28:31], s46 offen offset:2048 lds
  s_add_u32 s40, s40, s52
  v_lshlrev_b32 v2, 4, v1
  v_lshlrev_b32 v3, 2, v1
  s_lshr_b32 s19, s12, 1
  s_and_b32 s24, s12, 1
  s_xor_b32 s25, s19, s24
  v_lshrrev_b32 v4, 5, v1
  v_mul_u32_u24 v4, 3072, v4
  v_bfe_u32 v5, v1, 2, 2
  v_lshl_add_u32 v66, v5, 7, v4
  v_bfe_u32 v5, v1, 3, 1
  v_xor_b32 v5, s24, v5
  v_lshl_add_u32 v66, v5, 6, v66
  v_bfe_u32 v5, v1, 4, 1
  v_lshl_add_u32 v66, v5, 5, v66
  v_and_b32 v5, 3, v1
  v_lshl_add_u32 v66, v5, 3, v66
  s_mul_i32 s33, s25, 6144
  s_sub_u32 s34, 6144, s33
  v_add_u32 v67, s34, v66
  v_add_u32 v66, s33, v66
  v_add_u32 v70, 49152, v66
  v_add_u32 v71, 49152, v67
  v_and_b32 v4, 31, v1
  v_lshlrev_b32 v5, 7, v4
  v_bfe_u32 v6, v1, 1, 3
  v_lshrrev_b32 v7, 5, v1
  v_xor_b32 v6, v6, v7
  v_lshl_add_u32 v5, v6, 4, v5
  s_lshl_b32 s33, s25, 5
  v_xor_b32 v5, s33, v5
  s_lshl_b32 s33, s19, 12
  s_add_u32 s33, s33, 98304
  v_add_u32 v12, s33, v5
  v_xor_b32 v13, 32, v12
  v_xor_b32 v14, 64, v12
  v_xor_b32 v15, 96, v12
  v_mov_b32 v32, 0
  v_mov_b32 v33, 0
  v_mov_b32 v34, 0
  v_mov_b32 v35, 0
  v_mov_b32 v36, 0
  v_mov_b32 v37, 0x3f803f80
  v_and_b32 v4, 31, v1
  v_cmp_eq_u32 vcc, 0, v4
  v_cmp_eq_u32 s[60:61], 17, v4
  s_or_b64 vcc, vcc, s[60:61]
  v_cndmask_b32 v44, 0, v37, vcc
  v_cndmask_b32 v45, 0, v37, vcc
  v_cndmask_b32 v46, 0, v37, vcc
  v_cndmask_b32 v47, 0, v37, vcc
  s_and_b32 s26, s2, 0xf0
  s_lshl_b32 s33, s13, 1
  s_add_u32 s26, s26, s33
  s_and_b32 s33, s14, 1
  s_add_u32 s26, s26, s33
  s_add_u32 s26, s26, 128
  s_and_b32 s26, s26, 255
  s_mov_b32 s95, 0x00020000
  s_lshl_b32 s71, s12, 12
  s_add_u32 s71, s71, 131072
  v_lshrrev_b32 v4, 5, v1
  v_lshlrev_b32 v4, 2, v4
  v_bfe_u32 v6, v1, 2, 2
  v_add_u32 v4, v4, v6
  v_bfe_u32 v6, v1, 4, 1
  v_lshlrev_b32 v6, 5, v6
  v_and_b32 v5, 3, v1
  v_lshl_add_u32 v6, v5, 3, v6
  s_cmp_ge_u32 s26, 88
  s_cbranch_scc1 p0_rows
  s_mov_b32 s92, s88
  s_mov_b32 s93, s89
  s_mov_b32 s94, 1409024
  s_mov_b32 s65, 2
  s_cmp_ge_u32 s26, 44
  s_cselect_b32 s69, 1, 0
  s_mul_i32 s33, s69, 44
  s_sub_u32 s68, s26, s33
  s_mul_i32 s70, s68, 33792
  s_add_u32 s70, s70, 39370752
  s_lshl_b32 s33, s69, 2
  s_add_u32 s33, s33, s12
  s_lshl_b32 s66, s33, 12
  s_add_u32 s66, s66, s70
  s_movk_i32 s72, 1024
  s_mov_b32 s73, 44032
  s_mul_i32 s67, s33, 176128
  s_lshl_b32 s33, s68, 6
  s_add_u32 s67, s67, s33
  v_lshrrev_b32 v40, 2, v1
  v_mul_u32_u24 v40, 2752, v40
  v_lshl_add_u32 v40, v5, 4, v40
  v_lshl_add_u32 v41, v4, 6, v6
  v_add_u32 v41, s71, v41
  s_branch p0_prm
p0_rows:
  s_mov_b32 s65, 0
  s_movk_i32 s73, 1024
  s_mov_b32 s92, s84
  s_mov_b32 s93, s85
  s_mov_b32 s94, 524288
  s_sub_u32 s68, s26, 88
  s_mov_b32 s72, 32768
  s_mov_b32 s70, 40894464
  s_cmp_lt_u32 s26, 120
  s_cbranch_scc1 p0_rows2
  s_mov_b32 s92, s86
  s_mov_b32 s93, s87
  s_mov_b32 s94, 1409024
  s_sub_u32 s68, s26, 120
  s_mov_b32 s72, 98304
  s_mov_b32 s70, 41418752
  s_cmp_ge_u32 s26, 206
  s_cselect_b32 s94, 0, s94
p0_rows2:
  s_lshl_b32 s67, s68, 14
  s_lshl_b32 s33, s12, 12
  s_add_u32 s67, s67, s33
  s_lshl_b32 s33, s12, 2
  s_mul_i32 s66, s33, s72
  s_lshl_b32 s33, s68, 10
  s_add_u32 s66, s66, s33
  s_add_u32 s66, s66, s70
  v_mov_b32 v40, v2
  s_lshl_b32 s33, s12, 8
  s_add_u32 s33, s33, 131072
  v_lshl_add_u32 v41, v4, 10, v6
  v_add_u32 v41, s33, v41
p0_prm:
  s_and_b32 s93, s93, 0xffff
  s_add_u32 m0, s45, 16384
  s_add_u32 s46, s40, 98304
  buffer_load_dwordx4 v9, s[8:11], s43 offen lds
  buffer_load_dwordx4 v10, s[8:11], s43 offen offset:1024 lds
  s_add_u32 m0, s44, 49152
  s_add_u32 s48, s48, 1
  buffer_load_dwordx4 v8, s[28:31], s40 offen offset:0 lds
  buffer_load_dwordx4 v8, s[28:31], s40 offen offset:1024 lds
  buffer_load_dwordx4 v8, s[28:31], s40 offen offset:2048 lds
  s_cmp_eq_u32 s48, 8
  s_cselect_b32 s50, 4294966400, s51
  s_cselect_b32 s52, 4293591040, s49
  s_add_u32 m0, s44, 61440
  s_add_u32 s43, s43, s50
  buffer_load_dwordx4 v8, s[28:31], s46 offen offset:0 lds
  buffer_load_dwordx4 v8, s[28:31], s46 offen offset:1024 lds
  buffer_load_dwordx4 v8, s[28:31], s46 offen offset:2048 lds
  s_add_u32 s40, s40, s52
  s_waitcnt vmcnt(16)
  s_barrier
  ds_read_b128 v[192:195], v12 offset:0
  ds_read_b64_tr_b16 v[196:197], v66 offset:0
  ds_read_b64_tr_b16 v[198:199], v66 offset:512
  ds_read_b64_tr_b16 v[200:201], v66 offset:1024
  ds_read_b64_tr_b16 v[202:203], v66 offset:1536
  ds_read_b64_tr_b16 v[204:205], v66 offset:2048
  ds_read_b64_tr_b16 v[206:207], v66 offset:2560
  ds_read_b128 v[208:211], v13 offset:0
  ds_read_b64_tr_b16 v[212:213], v67 offset:0
  ds_read_b64_tr_b16 v[214:215], v67 offset:512
  ds_read_b64_tr_b16 v[216:217], v67 offset:1024
  ds_read_b64_tr_b16 v[218:219], v67 offset:1536
  ds_read_b64_tr_b16 v[220:221], v67 offset:2048
  ds_read_b64_tr_b16 v[222:223], v67 offset:2560
  ds_read_b128 v[224:227], v14 offset:0
  ds_read_b64_tr_b16 v[228:229], v66 offset:12288
  ds_read_b64_tr_b16 v[230:231], v66 offset:12800
  ds_read_b64_tr_b16 v[232:233], v66 offset:13312
  ds_read_b64_tr_b16 v[234:235], v66 offset:13824
  ds_read_b64_tr_b16 v[236:237], v66 offset:14336
  ds_read_b64_tr_b16 v[238:239], v66 offset:14848
  ds_read_b128 v[240:243], v15 offset:0
  ds_read_b64_tr_b16 v[244:245], v67 offset:12288
  ds_read_b64_tr_b16 v[246:247], v67 offset:12800
  ds_read_b64_tr_b16 v[248:249], v67 offset:13312
  ds_read_b64_tr_b16 v[250:251], v67 offset:13824
  ds_read_b64_tr_b16 v[252:253], v67 offset:14336
  ds_read_b64_tr_b16 v[254:255], v67 offset:14848
  s_waitcnt vmcnt(8) lgkmcnt(0)
  s_barrier
  v_mfma_f32_32x32x16_bf16 v[80:95], v[196:199], v[192:195], 0
  ds_read_b128 v[128:131], v12 offset:8192
  ds_read_b64_tr_b16 v[132:133], v66 offset:24576
  ds_read_b64_tr_b16 v[134:135], v66 offset:25088
  s_cmp_eq_u32 s35, 0
  s_cbranch_scc0 p0_clr0
p0_back0:
  v_mfma_f32_32x32x16_bf16 v[96:111], v[200:203], v[192:195], 0
  ds_read_b64_tr_b16 v[136:137], v66 offset:25600
  ds_read_b64_tr_b16 v[138:139], v66 offset:26112
  ds_read_b64_tr_b16 v[140:141], v66 offset:26624
  s_add_u32 m0, s45, 24576
  s_add_u32 s46, s40, 98304
  buffer_load_dwordx4 v9, s[8:11], s43 offen lds
  v_mfma_f32_16x16x32_bf16 v[60:63], v[44:47], v[192:195], 0
  v_mfma_f32_32x32x16_bf16 v[112:127], v[192:195], v[204:207], 0
  ds_read_b64_tr_b16 v[142:143], v66 offset:27136
  ds_read_b128 v[144:147], v13 offset:8192
  ds_read_b64_tr_b16 v[148:149], v67 offset:24576
  buffer_load_dwordx4 v10, s[8:11], s43 offen offset:1024 lds
  v_mfma_f32_32x32x16_bf16 v[80:95], v[212:215], v[208:211], v[80:95]
  ds_read_b64_tr_b16 v[150:151], v67 offset:25088
  ds_read_b64_tr_b16 v[152:153], v67 offset:25600
  ds_read_b64_tr_b16 v[154:155], v67 offset:26112
  v_mfma_f32_16x16x32_bf16 v[48:51], v[44:47], v[212:215], 0
  v_mfma_f32_32x32x16_bf16 v[96:111], v[216:219], v[208:211], v[96:111]
  ds_read_b64_tr_b16 v[156:157], v67 offset:26624
  ds_read_b64_tr_b16 v[158:159], v67 offset:27136
  s_add_u32 m0, s44, 73728
  s_add_u32 s48, s48, 1
  buffer_load_dwordx4 v8, s[28:31], s40 offen offset:0 lds
  v_mfma_f32_16x16x32_bf16 v[52:55], v[44:47], v[216:219], 0
  v_mfma_f32_32x32x16_bf16 v[112:127], v[208:211], v[220:223], v[112:127]
  ds_read_b128 v[160:163], v14 offset:8192
  ds_read_b64_tr_b16 v[164:165], v66 offset:36864
  buffer_load_dwordx4 v8, s[28:31], s40 offen offset:1024 lds
  v_mfma_f32_16x16x32_bf16 v[56:59], v[44:47], v[220:223], 0
  v_mfma_f32_32x32x16_bf16 v[80:95], v[228:231], v[224:227], v[80:95]
  ds_read_b64_tr_b16 v[166:167], v66 offset:37376
  ds_read_b64_tr_b16 v[168:169], v66 offset:37888
  v_mfma_f32_32x32x16_bf16 v[96:111], v[232:235], v[224:227], v[96:111]
  ds_read_b64_tr_b16 v[170:171], v66 offset:38400
  ds_read_b64_tr_b16 v[172:173], v66 offset:38912
  buffer_load_dwordx4 v8, s[28:31], s40 offen offset:2048 lds
  v_mfma_f32_16x16x32_bf16 v[60:63], v[44:47], v[224:227], v[60:63]
  v_mfma_f32_32x32x16_bf16 v[112:127], v[224:227], v[236:239], v[112:127]
  ds_read_b64_tr_b16 v[174:175], v66 offset:39424
  ds_read_b128 v[176:179], v15 offset:8192
  s_cmp_eq_u32 s48, 8
  s_cselect_b32 s50, 4294966400, s51
  s_cselect_b32 s52, 4293591040, s49
  s_add_u32 m0, s44, 86016
  s_add_u32 s43, s43, s50
  buffer_load_dwordx4 v8, s[28:31], s46 offen offset:0 lds
  v_mfma_f32_32x32x16_bf16 v[80:95], v[244:247], v[240:243], v[80:95]
  ds_read_b64_tr_b16 v[180:181], v67 offset:36864
  ds_read_b64_tr_b16 v[182:183], v67 offset:37376
  v_mfma_f32_16x16x32_bf16 v[48:51], v[44:47], v[244:247], v[48:51]
  v_mfma_f32_32x32x16_bf16 v[96:111], v[248:251], v[240:243], v[96:111]
  ds_read_b64_tr_b16 v[184:185], v67 offset:37888
  ds_read_b64_tr_b16 v[186:187], v67 offset:38400
  buffer_load_dwordx4 v8, s[28:31], s46 offen offset:1024 lds
  v_mfma_f32_16x16x32_bf16 v[52:55], v[44:47], v[248:251], v[52:55]
  v_mfma_f32_32x32x16_bf16 v[112:127], v[240:243], v[252:255], v[112:127]
  ds_read_b64_tr_b16 v[188:189], v67 offset:38912
  ds_read_b64_tr_b16 v[190:191], v67 offset:39424
  buffer_load_dwordx4 v8, s[28:31], s46 offen offset:2048 lds
  s_add_u32 s40, s40, s52
  v_mfma_f32_16x16x32_bf16 v[56:59], v[44:47], v[252:255], v[56:59]
  v_dot2_f32_bf16 v32, v192, v192, v32
  v_dot2_f32_bf16 v33, v224, v224, v33
  v_dot2_f32_bf16 v32, v193, v193, v32
  v_dot2_f32_bf16 v33, v225, v225, v33
  v_dot2_f32_bf16 v32, v194, v194, v32
  v_dot2_f32_bf16 v33, v226, v226, v33
  v_dot2_f32_bf16 v32, v195, v195, v32
  v_dot2_f32_bf16 v33, v227, v227, v33
  s_waitcnt vmcnt(8) lgkmcnt(0)
  s_barrier
  v_mfma_f32_32x32x16_bf16 v[80:95], v[132:135], v[128:131], v[80:95]
  ds_read_b128 v[192:195], v12 offset:16384
  ds_read_b64_tr_b16 v[196:197], v70 offset:0
  ds_read_b64_tr_b16 v[198:199], v70 offset:512
  v_mfma_f32_32x32x16_bf16 v[96:111], v[136:139], v[128:131], v[96:111]
  ds_read_b64_tr_b16 v[200:201], v70 offset:1024
  ds_read_b64_tr_b16 v[202:203], v70 offset:1536
  ds_read_b64_tr_b16 v[204:205], v70 offset:2048
  s_add_u32 m0, s45, 0
  s_add_u32 s46, s40, 98304
  buffer_load_dwordx4 v9, s[8:11], s43 offen lds
  v_mfma_f32_16x16x32_bf16 v[60:63], v[44:47], v[128:131], v[60:63]
  v_mfma_f32_32x32x16_bf16 v[112:127], v[128:131], v[140:143], v[112:127]
  ds_read_b64_tr_b16 v[206:207], v70 offset:2560
  ds_read_b128 v[208:211], v13 offset:16384
  ds_read_b64_tr_b16 v[212:213], v71 offset:0
  buffer_load_dwordx4 v10, s[8:11], s43 offen offset:1024 lds
  v_mfma_f32_32x32x16_bf16 v[80:95], v[148:151], v[144:147], v[80:95]
  ds_read_b64_tr_b16 v[214:215], v71 offset:512
  ds_read_b64_tr_b16 v[216:217], v71 offset:1024
  ds_read_b64_tr_b16 v[218:219], v71 offset:1536
  v_mfma_f32_16x16x32_bf16 v[48:51], v[44:47], v[148:151], v[48:51]
  v_mfma_f32_32x32x16_bf16 v[96:111], v[152:155], v[144:147], v[96:111]
  ds_read_b64_tr_b16 v[220:221], v71 offset:2048
  ds_read_b64_tr_b16 v[222:223], v71 offset:2560
  s_add_u32 m0, s44, 0
  s_add_u32 s48, s48, 1
  buffer_load_dwordx4 v8, s[28:31], s40 offen offset:0 lds
  v_mfma_f32_16x16x32_bf16 v[52:55], v[44:47], v[152:155], v[52:55]
  v_mfma_f32_32x32x16_bf16 v[112:127], v[144:147], v[156:159], v[112:127]
  ds_read_b128 v[224:227], v14 offset:16384
  ds_read_b64_tr_b16 v[228:229], v70 offset:12288
  buffer_load_dwordx4 v8, s[28:31], s40 offen offset:1024 lds
  v_mfma_f32_16x16x32_bf16 v[56:59], v[44:47], v[156:159], v[56:59]
  v_mfma_f32_32x32x16_bf16 v[80:95], v[164:167], v[160:163], v[80:95]
  ds_read_b64_tr_b16 v[230:231], v70 offset:12800
  ds_read_b64_tr_b16 v[232:233], v70 offset:13312
  v_mfma_f32_32x32x16_bf16 v[96:111], v[168:171], v[160:163], v[96:111]
  ds_read_b64_tr_b16 v[234:235], v70 offset:13824
  ds_read_b64_tr_b16 v[236:237], v70 offset:14336
  buffer_load_dwordx4 v8, s[28:31], s40 offen offset:2048 lds
  v_mfma_f32_16x16x32_bf16 v[60:63], v[44:47], v[160:163], v[60:63]
  v_mfma_f32_32x32x16_bf16 v[112:127], v[160:163], v[172:175], v[112:127]
  ds_read_b64_tr_b16 v[238:239], v70 offset:14848
  ds_read_b128 v[240:243], v15 offset:16384
  s_cmp_eq_u32 s48, 8
  s_cselect_b32 s50, 4294966400, s51
  s_cselect_b32 s52, 4293591040, s49
  s_add_u32 m0, s44, 12288
  s_add_u32 s43, s43, s50
  buffer_load_dwordx4 v8, s[28:31], s46 offen offset:0 lds
  v_mfma_f32_32x32x16_bf16 v[80:95], v[180:183], v[176:179], v[80:95]
  ds_read_b64_tr_b16 v[244:245], v71 offset:12288
  ds_read_b64_tr_b16 v[246:247], v71 offset:12800
  v_mfma_f32_16x16x32_bf16 v[48:51], v[44:47], v[180:183], v[48:51]
  v_mfma_f32_32x32x16_bf16 v[96:111], v[184:187], v[176:179], v[96:111]
  ds_read_b64_tr_b16 v[248:249], v71 offset:13312
  ds_read_b64_tr_b16 v[250:251], v71 offset:13824
  buffer_load_dwordx4 v8, s[28:31], s46 offen offset:1024 lds
  v_mfma_f32_16x16x32_bf16 v[52:55], v[44:47], v[184:187], v[52:55]
  v_mfma_f32_32x32x16_bf16 v[112:127], v[176:179], v[188:191], v[112:127]
  ds_read_b64_tr_b16 v[252:253], v71 offset:14336
  ds_read_b64_tr_b16 v[254:255], v71 offset:14848
  buffer_load_dwordx4 v8, s[28:31], s46 offen offset:2048 lds
  s_add_u32 s40, s40, s52
  v_mfma_f32_16x16x32_bf16 v[56:59], v[44:47], v[188:191], v[56:59]
  v_dot2_f32_bf16 v32, v128, v128, v32
  v_dot2_f32_bf16 v33, v160, v160, v33
  v_dot2_f32_bf16 v32, v129, v129, v32
  v_dot2_f32_bf16 v33, v161, v161, v33
  v_dot2_f32_bf16 v32, v130, v130, v32
  v_dot2_f32_bf16 v33, v162, v162, v33
  v_dot2_f32_bf16 v32, v131, v131, v32
  v_dot2_f32_bf16 v33, v163, v163, v33
  s_waitcnt vmcnt(8) lgkmcnt(0)
  s_barrier
  v_mfma_f32_32x32x16_bf16 v[80:95], v[196:199], v[192:195], v[80:95]
  ds_read_b128 v[128:131], v12 offset:24576
  ds_read_b64_tr_b16 v[132:133], v70 offset:24576
  ds_read_b64_tr_b16 v[134:135], v70 offset:25088
  v_mfma_f32_32x32x16_bf16 v[96:111], v[200:203], v[192:195], v[96:111]
  ds_read_b64_tr_b16 v[136:137], v70 offset:25600
  ds_read_b64_tr_b16 v[138:139], v70 offset:26112
  ds_read_b64_tr_b16 v[140:141], v70 offset:26624
  s_add_u32 m0, s45, 8192
  s_add_u32 s46, s40, 98304
  buffer_load_dwordx4 v9, s[8:11], s43 offen lds
  v_mfma_f32_16x16x32_bf16 v[60:63], v[44:47], v[192:195], v[60:63]
  v_mfma_f32_32x32x16_bf16 v[112:127], v[192:195], v[204:207], v[112:127]
  ds_read_b64_tr_b16 v[142:143], v70 offset:27136
  ds_read_b128 v[144:147], v13 offset:24576
  ds_read_b64_tr_b16 v[148:149], v71 offset:24576
  buffer_load_dwordx4 v10, s[8:11], s43 offen offset:1024 lds
  v_mfma_f32_32x32x16_bf16 v[80:95], v[212:215], v[208:211], v[80:95]
  ds_read_b64_tr_b16 v[150:151], v71 offset:25088
  ds_read_b64_tr_b16 v[152:153], v71 offset:25600
  ds_read_b64_tr_b16 v[154:155], v71 offset:26112
  s_add_u32 m0, s44, 24576
  s_add_u32 s48, s48, 1
  buffer_load_dwordx4 v8, s[28:31], s40 offen offset:0 lds
  v_mfma_f32_16x16x32_bf16 v[48:51], v[44:47], v[212:215], v[48:51]
  v_mfma_f32_32x32x16_bf16 v[96:111], v[216:219], v[208:211], v[96:111]
  ds_read_b64_tr_b16 v[156:157], v71 offset:26624
  ds_read_b64_tr_b16 v[158:159], v71 offset:27136
  buffer_load_dwordx4 v8, s[28:31], s40 offen offset:1024 lds
  v_mfma_f32_16x16x32_bf16 v[52:55], v[44:47], v[216:219], v[52:55]
  v_mfma_f32_32x32x16_bf16 v[112:127], v[208:211], v[220:223], v[112:127]
  ds_read_b128 v[160:163], v14 offset:24576
  ds_read_b64_tr_b16 v[164:165], v70 offset:36864
  buffer_load_dwordx4 v8, s[28:31], s40 offen offset:2048 lds
  v_mfma_f32_16x16x32_bf16 v[56:59], v[44:47], v[220:223], v[56:59]
  v_mfma_f32_32x32x16_bf16 v[80:95], v[228:231], v[224:227], v[80:95]
  ds_read_b64_tr_b16 v[166:167], v70 offset:37376
  ds_read_b64_tr_b16 v[168:169], v70 offset:37888
  s_cmp_eq_u32 s48, 8
  s_cselect_b32 s50, 4294966400, s51
  s_cselect_b32 s52, 4293591040, s49
  s_add_u32 m0, s44, 36864
  s_add_u32 s43, s43, s50
  buffer_load_dwordx4 v8, s[28:31], s46 offen offset:0 lds
  v_mfma_f32_32x32x16_bf16 v[96:111], v[232:235], v[224:227], v[96:111]
  ds_read_b64_tr_b16 v[170:171], v70 offset:38400
  ds_read_b64_tr_b16 v[172:173], v70 offset:38912
  buffer_load_dwordx4 v8, s[28:31], s46 offen offset:1024 lds
  v_mfma_f32_16x16x32_bf16 v[60:63], v[44:47], v[224:227], v[60:63]
  v_mfma_f32_32x32x16_bf16 v[112:127], v[224:227], v[236:239], v[112:127]
  ds_read_b64_tr_b16 v[174:175], v70 offset:39424
  ds_read_b128 v[176:179], v15 offset:24576
  buffer_load_dwordx4 v8, s[28:31], s46 offen offset:2048 lds
  s_add_u32 s40, s40, s52
  v_mfma_f32_32x32x16_bf16 v[80:95], v[244:247], v[240:243], v[80:95]
  ds_read_b64_tr_b16 v[180:181], v71 offset:36864
  ds_read_b64_tr_b16 v[182:183], v71 offset:37376
  v_mfma_f32_16x16x32_bf16 v[48:51], v[44:47], v[244:247], v[48:51]
  v_mfma_f32_32x32x16_bf16 v[96:111], v[248:251], v[240:243], v[96:111]
  ds_read_b64_tr_b16 v[184:185], v71 offset:37888
  ds_read_b64_tr_b16 v[186:187], v71 offset:38400
  s_add_u32 m0, s71, 0
  s_nop 0
  buffer_load_dwordx4 v40, s[92:95], s67 offen lds
  s_add_u32 s67, s67, s73
  v_mfma_f32_16x16x32_bf16 v[52:55], v[44:47], v[248:251], v[52:55]
  v_mfma_f32_32x32x16_bf16 v[112:127], v[240:243], v[252:255], v[112:127]
  ds_read_b64_tr_b16 v[188:189], v71 offset:38912
  ds_read_b64_tr_b16 v[190:191], v71 offset:39424
  s_add_u32 m0, s71, 1024
  s_nop 0
  buffer_load_dwordx4 v40, s[92:95], s67 offen lds
  s_add_u32 s67, s67, s73
  v_mfma_f32_16x16x32_bf16 v[56:59], v[44:47], v[252:255], v[56:59]
  v_dot2_f32_bf16 v32, v192, v192, v32
  v_dot2_f32_bf16 v33, v224, v224, v33
  v_dot2_f32_bf16 v32, v193, v193, v32
  v_dot2_f32_bf16 v33, v225, v225, v33
  v_dot2_f32_bf16 v32, v194, v194, v32
  v_dot2_f32_bf16 v33, v226, v226, v33
  v_dot2_f32_bf16 v32, v195, v195, v32
  v_dot2_f32_bf16 v33, v227, v227, v33
  s_waitcnt vmcnt(10) lgkmcnt(0)
  s_barrier
  v_mfma_f32_32x32x16_bf16 v[80:95], v[132:135], v[128:131], v[80:95]
  ds_read_b128 v[192:195], v12 offset:0
  ds_read_b64_tr_b16 v[196:197], v66 offset:0
  ds_read_b64_tr_b16 v[198:199], v66 offset:512
  s_cmp_eq_u32 s35, 0
  s_cbranch_scc0 p0_clr3
p0_back3:
  v_mfma_f32_32x32x16_bf16 v[96:111], v[136:139], v[128:131], v[96:111]
  ds_read_b64_tr_b16 v[200:201], v66 offset:1024
  ds_read_b64_tr_b16 v[202:203], v66 offset:1536
  ds_read_b64_tr_b16 v[204:205], v66 offset:2048
  s_add_u32 m0, s45, 16384
  s_add_u32 s46, s40, 98304
  buffer_load_dwordx4 v9, s[8:11], s43 offen lds
  v_mfma_f32_16x16x32_bf16 v[60:63], v[44:47], v[128:131], v[60:63]
  v_mfma_f32_32x32x16_bf16 v[112:127], v[128:131], v[140:143], v[112:127]
  ds_read_b64_tr_b16 v[206:207], v66 offset:2560
  ds_read_b128 v[208:211], v13 offset:0
  ds_read_b64_tr_b16 v[212:213], v67 offset:0
  buffer_load_dwordx4 v10, s[8:11], s43 offen offset:1024 lds
  v_mfma_f32_32x32x16_bf16 v[80:95], v[148:151], v[144:147], v[80:95]
  ds_read_b64_tr_b16 v[214:215], v67 offset:512
  ds_read_b64_tr_b16 v[216:217], v67 offset:1024
  ds_read_b64_tr_b16 v[218:219], v67 offset:1536
  s_add_u32 m0, s44, 49152
  s_add_u32 s48, s48, 1
  buffer_load_dwordx4 v8, s[28:31], s40 offen offset:0 lds
  v_mfma_f32_16x16x32_bf16 v[48:51], v[44:47], v[148:151], v[48:51]
  v_mfma_f32_32x32x16_bf16 v[96:111], v[152:155], v[144:147], v[96:111]
  ds_read_b64_tr_b16 v[220:221], v67 offset:2048
  ds_read_b64_tr_b16 v[222:223], v67 offset:2560
  buffer_load_dwordx4 v8, s[28:31], s40 offen offset:1024 lds
  v_mfma_f32_16x16x32_bf16 v[52:55], v[44:47], v[152:155], v[52:55]
  v_mfma_f32_32x32x16_bf16 v[112:127], v[144:147], v[156:159], v[112:127]
  ds_read_b128 v[224:227], v14 offset:0
  ds_read_b64_tr_b16 v[228:229], v66 offset:12288
  buffer_load_dwordx4 v8, s[28:31], s40 offen offset:2048 lds
  v_mfma_f32_16x16x32_bf16 v[56:59], v[44:47], v[156:159], v[56:59]
  v_mfma_f32_32x32x16_bf16 v[80:95], v[164:167], v[160:163], v[80:95]
  ds_read_b64_tr_b16 v[230:231], v66 offset:12800
  ds_read_b64_tr_b16 v[232:233], v66 offset:13312
  s_cmp_eq_u32 s48, 8
  s_cselect_b32 s50, 4294966400, s51
  s_cselect_b32 s52, 4293591040, s49
  s_add_u32 m0, s44, 61440
  s_add_u32 s43, s43, s50
  buffer_load_dwordx4 v8, s[28:31], s46 offen offset:0 lds
  v_mfma_f32_32x32x16_bf16 v[96:111], v[168:171], v[160:163], v[96:111]
  ds_read_b64_tr_b16 v[234:235], v66 offset:13824
  ds_read_b64_tr_b16 v[236:237], v66 offset:14336
  buffer_load_dwordx4 v8, s[28:31], s46 offen offset:1024 lds
  v_mfma_f32_16x16x32_bf16 v[60:63], v[44:47], v[160:163], v[60:63]
  v_mfma_f32_32x32x16_bf16 v[112:127], v[160:163], v[172:175], v[112:127]
  ds_read_b64_tr_b16 v[238:239], v66 offset:14848
  ds_read_b128 v[240:243], v15 offset:0
  buffer_load_dwordx4 v8, s[28:31], s46 offen offset:2048 lds
  s_add_u32 s40, s40, s52
  v_mfma_f32_32x32x16_bf16 v[80:95], v[180:183], v[176:179], v[80:95]
  ds_read_b64_tr_b16 v[244:245], v67 offset:12288
  ds_read_b64_tr_b16 v[246:247], v67 offset:12800
  v_mfma_f32_16x16x32_bf16 v[48:51], v[44:47], v[180:183], v[48:51]
  v_mfma_f32_32x32x16_bf16 v[96:111], v[184:187], v[176:179], v[96:111]
  ds_read_b64_tr_b16 v[248:249], v67 offset:13312
  ds_read_b64_tr_b16 v[250:251], v67 offset:13824
  s_add_u32 m0, s71, 2048
  s_nop 0
  buffer_load_dwordx4 v40, s[92:95], s67 offen lds
  s_add_u32 s67, s67, s73
  v_mfma_f32_16x16x32_bf16 v[52:55], v[44:47], v[184:187], v[52:55]
  v_mfma_f32_32x32x16_bf16 v[112:127], v[176:179], v[188:191], v[112:127]
  ds_read_b64_tr_b16 v[252:253], v67 offset:14336
  ds_read_b64_tr_b16 v[254:255], v67 offset:14848
  s_add_u32 m0, s71, 3072
  s_nop 0
  buffer_load_dwordx4 v40, s[92:95], s67 offen lds
  s_add_u32 s67, s67, s73
  v_mfma_f32_16x16x32_bf16 v[56:59], v[44:47], v[188:191], v[56:59]
  v_dot2_f32_bf16 v32, v128, v128, v32
  v_dot2_f32_bf16 v33, v160, v160, v33
  v_dot2_f32_bf16 v32, v129, v129, v32
  v_dot2_f32_bf16 v33, v161, v161, v33
  v_dot2_f32_bf16 v32, v130, v130, v32
  v_dot2_f32_bf16 v33, v162, v162, v33
  v_dot2_f32_bf16 v32, v131, v131, v32
  v_dot2_f32_bf16 v33, v163, v163, v33
  s_waitcnt vmcnt(12) lgkmcnt(0)
  s_barrier
  v_mfma_f32_32x32x16_bf16 v[80:95], v[196:199], v[192:195], v[80:95]
  ds_read_b128 v[128:131], v12 offset:8192
  ds_read_b64_tr_b16 v[132:133], v66 offset:24576
  ds_read_b64_tr_b16 v[134:135], v66 offset:25088
  v_mfma_f32_32x32x16_bf16 v[96:111], v[200:203], v[192:195], v[96:111]
  ds_read_b64_tr_b16 v[136:137], v66 offset:25600
  ds_read_b64_tr_b16 v[138:139], v66 offset:26112
  ds_read_b64_tr_b16 v[140:141], v66 offset:26624
  s_add_u32 m0, s45, 24576
  s_add_u32 s46, s40, 98304
  buffer_load_dwordx4 v9, s[8:11], s43 offen lds
  v_mfma_f32_16x16x32_bf16 v[60:63], v[44:47], v[192:195], v[60:63]
  v_mfma_f32_32x32x16_bf16 v[112:127], v[192:195], v[204:207], v[112:127]
  ds_read_b64_tr_b16 v[142:143], v66 offset:27136
  ds_read_b128 v[144:147], v13 offset:8192
  ds_read_b64_tr_b16 v[148:149], v67 offset:24576
  buffer_load_dwordx4 v10, s[8:11], s43 offen offset:1024 lds
  v_mfma_f32_32x32x16_bf16 v[80:95], v[212:215], v[208:211], v[80:95]
  ds_read_b64_tr_b16 v[150:151], v67 offset:25088
  ds_read_b64_tr_b16 v[152:153], v67 offset:25600
  ds_read_b64_tr_b16 v[154:155], v67 offset:26112
  v_mfma_f32_16x16x32_bf16 v[48:51], v[44:47], v[212:215], v[48:51]
  v_mfma_f32_32x32x16_bf16 v[96:111], v[216:219], v[208:211], v[96:111]
  ds_read_b64_tr_b16 v[156:157], v67 offset:26624
  ds_read_b64_tr_b16 v[158:159], v67 offset:27136
  s_add_u32 m0, s44, 73728
  s_add_u32 s48, s48, 1
  buffer_load_dwordx4 v8, s[28:31], s40 offen offset:0 lds
  v_mfma_f32_16x16x32_bf16 v[52:55], v[44:47], v[216:219], v[52:55]
  v_mfma_f32_32x32x16_bf16 v[112:127], v[208:211], v[220:223], v[112:127]
  ds_read_b128 v[160:163], v14 offset:8192
  ds_read_b64_tr_b16 v[164:165], v66 offset:36864
  buffer_load_dwordx4 v8, s[28:31], s40 offen offset:1024 lds
  v_mfma_f32_16x16x32_bf16 v[56:59], v[44:47], v[220:223], v[56:59]
  v_mfma_f32_32x32x16_bf16 v[80:95], v[228:231], v[224:227], v[80:95]
  ds_read_b64_tr_b16 v[166:167], v66 offset:37376
  ds_read_b64_tr_b16 v[168:169], v66 offset:37888
  v_mfma_f32_32x32x16_bf16 v[96:111], v[232:235], v[224:227], v[96:111]
  ds_read_b64_tr_b16 v[170:171], v66 offset:38400
  ds_read_b64_tr_b16 v[172:173], v66 offset:38912
  buffer_load_dwordx4 v8, s[28:31], s40 offen offset:2048 lds
  v_mfma_f32_16x16x32_bf16 v[60:63], v[44:47], v[224:227], v[60:63]
  v_mfma_f32_32x32x16_bf16 v[112:127], v[224:227], v[236:239], v[112:127]
  ds_read_b64_tr_b16 v[174:175], v66 offset:39424
  ds_read_b128 v[176:179], v15 offset:8192
  s_cmp_eq_u32 s48, 8
  s_cselect_b32 s50, 4294966400, s51
  s_cselect_b32 s52, 4293591040, s49
  s_add_u32 m0, s44, 86016
  s_add_u32 s43, s43, s50
  buffer_load_dwordx4 v8, s[28:31], s46 offen offset:0 lds
  v_mfma_f32_32x32x16_bf16 v[80:95], v[244:247], v[240:243], v[80:95]
  ds_read_b64_tr_b16 v[180:181], v67 offset:36864
  ds_read_b64_tr_b16 v[182:183], v67 offset:37376
  v_mfma_f32_16x16x32_bf16 v[48:51], v[44:47], v[244:247], v[48:51]
  v_mfma_f32_32x32x16_bf16 v[96:111], v[248:251], v[240:243], v[96:111]
  ds_read_b64_tr_b16 v[184:185], v67 offset:37888
  ds_read_b64_tr_b16 v[186:187], v67 offset:38400
  buffer_load_dwordx4 v8, s[28:31], s46 offen offset:1024 lds
  v_mfma_f32_16x16x32_bf16 v[52:55], v[44:47], v[248:251], v[52:55]
  v_mfma_f32_32x32x16_bf16 v[112:127], v[240:243], v[252:255], v[112:127]
  ds_read_b64_tr_b16 v[188:189], v67 offset:38912
  ds_read_b64_tr_b16 v[190:191], v67 offset:39424
  buffer_load_dwordx4 v8, s[28:31], s46 offen offset:2048 lds
  s_add_u32 s40, s40, s52
  v_mfma_f32_16x16x32_bf16 v[56:59], v[44:47], v[252:255], v[56:59]
  v_dot2_f32_bf16 v32, v192, v192, v32
  v_dot2_f32_bf16 v33, v224, v224, v33
  v_dot2_f32_bf16 v32, v193, v193, v32
  v_dot2_f32_bf16 v33, v225, v225, v33
  v_dot2_f32_bf16 v32, v194, v194, v32
  v_dot2_f32_bf16 v33, v226, v226, v33
  v_dot2_f32_bf16 v32, v195, v195, v32
  v_dot2_f32_bf16 v33, v227, v227, v33
  s_waitcnt vmcnt(10) lgkmcnt(0)
  s_barrier
  v_mfma_f32_32x32x16_bf16 v[80:95], v[132:135], v[128:131], v[80:95]
  ds_read_b128 v[192:195], v12 offset:16384
  ds_read_b64_tr_b16 v[196:197], v70 offset:0
  ds_read_b64_tr_b16 v[198:199], v70 offset:512
  v_mfma_f32_32x32x16_bf16 v[96:111], v[136:139], v[128:131], v[96:111]
  ds_read_b64_tr_b16 v[200:201], v70 offset:1024
  ds_read_b64_tr_b16 v[202:203], v70 offset:1536
  ds_read_b64_tr_b16 v[204:205], v70 offset:2048
  v_mfma_f32_16x16x32_bf16 v[60:63], v[44:47], v[128:131], v[60:63]
  v_mfma_f32_32x32x16_bf16 v[112:127], v[128:131], v[140:143], v[112:127]
  ds_read_b64_tr_b16 v[206:207], v70 offset:2560
  ds_read_b128 v[208:211], v13 offset:16384
  ds_read_b64_tr_b16 v[212:213], v71 offset:0
  v_mfma_f32_32x32x16_bf16 v[80:95], v[148:151], v[144:147], v[80:95]
  ds_read_b64_tr_b16 v[214:215], v71 offset:512
  ds_read_b64_tr_b16 v[216:217], v71 offset:1024
  ds_read_b64_tr_b16 v[218:219], v71 offset:1536
  v_mfma_f32_16x16x32_bf16 v[48:51], v[44:47], v[148:151], v[48:51]
  v_mfma_f32_32x32x16_bf16 v[96:111], v[152:155], v[144:147], v[96:111]
  ds_read_b64_tr_b16 v[220:221], v71 offset:2048
  ds_read_b64_tr_b16 v[222:223], v71 offset:2560
  v_mfma_f32_16x16x32_bf16 v[52:55], v[44:47], v[152:155], v[52:55]
  v_mfma_f32_32x32x16_bf16 v[112:127], v[144:147], v[156:159], v[112:127]
  ds_read_b128 v[224:227], v14 offset:16384
  ds_read_b64_tr_b16 v[228:229], v70 offset:12288
  v_mfma_f32_16x16x32_bf16 v[56:59], v[44:47], v[156:159], v[56:59]
  v_mfma_f32_32x32x16_bf16 v[80:95], v[164:167], v[160:163], v[80:95]
  ds_read_b64_tr_b16 v[230:231], v70 offset:12800
  ds_read_b64_tr_b16 v[232:233], v70 offset:13312
  v_mfma_f32_32x32x16_bf16 v[96:111], v[168:171], v[160:163], v[96:111]
  ds_read_b64_tr_b16 v[234:235], v70 offset:13824
  ds_read_b64_tr_b16 v[236:237], v70 offset:14336
  v_mfma_f32_16x16x32_bf16 v[60:63], v[44:47], v[160:163], v[60:63]
  v_mfma_f32_32x32x16_bf16 v[112:127], v[160:163], v[172:175], v[112:127]
  ds_read_b64_tr_b16 v[238:239], v70 offset:14848
  ds_read_b128 v[240:243], v15 offset:16384
  v_mfma_f32_32x32x16_bf16 v[80:95], v[180:183], v[176:179], v[80:95]
  ds_read_b64_tr_b16 v[244:245], v71 offset:12288
  ds_read_b64_tr_b16 v[246:247], v71 offset:12800
  v_mfma_f32_16x16x32_bf16 v[48:51], v[44:47], v[180:183], v[48:51]
  v_mfma_f32_32x32x16_bf16 v[96:111], v[184:187], v[176:179], v[96:111]
  ds_read_b64_tr_b16 v[248:249], v71 offset:13312
  ds_read_b64_tr_b16 v[250:251], v71 offset:13824
  v_mfma_f32_16x16x32_bf16 v[52:55], v[44:47], v[184:187], v[52:55]
  v_mfma_f32_32x32x16_bf16 v[112:127], v[176:179], v[188:191], v[112:127]
  ds_read_b64_tr_b16 v[252:253], v71 offset:14336
  ds_read_b64_tr_b16 v[254:255], v71 offset:14848
  v_mfma_f32_16x16x32_bf16 v[56:59], v[44:47], v[188:191], v[56:59]
  v_dot2_f32_bf16 v32, v128, v128, v32
  v_dot2_f32_bf16 v33, v160, v160, v33
  v_dot2_f32_bf16 v32, v129, v129, v32
  v_dot2_f32_bf16 v33, v161, v161, v33
  v_dot2_f32_bf16 v32, v130, v130, v32
  v_dot2_f32_bf16 v33, v162, v162, v33
  v_dot2_f32_bf16 v32, v131, v131, v32
  v_dot2_f32_bf16 v33, v163, v163, v33
  s_waitcnt vmcnt(0) lgkmcnt(0)
  s_barrier
  v_mfma_f32_32x32x16_bf16 v[80:95], v[196:199], v[192:195], v[80:95]
  s_mov_b32 s10, 2097152
  s_lshl_b32 s17, s15, 1
  s_add_u32 s17, s17, s19
  s_lshl_b32 s16, s18, 1
  s_add_u32 s16, s16, s24
  s_lshl_b32 s76, s76, 1
  ds_read_b128 v[128:131], v12 offset:24576
  ds_read_b64_tr_b16 v[132:133], v70 offset:24576
  ds_read_b64_tr_b16 v[134:135], v70 offset:25088
  v_mfma_f32_32x32x16_bf16 v[96:111], v[200:203], v[192:195], v[96:111]
  s_add_u32 s76, s76, s24
  s_lshl_b32 s77, s77, 1
  s_add_u32 s77, s77, s24
  s_lshl_b32 s33, s17, 10
  s_lshl_b32 s56, s16, 17
  s_add_u32 s56, s56, s33
  ds_read_b64_tr_b16 v[136:137], v70 offset:25600
  ds_read_b64_tr_b16 v[138:139], v70 offset:26112
  ds_read_b64_tr_b16 v[140:141], v70 offset:26624
  v_mfma_f32_16x16x32_bf16 v[60:63], v[44:47], v[192:195], v[60:63]
  v_mfma_f32_32x32x16_bf16 v[112:127], v[192:195], v[204:207], v[112:127]
  s_add_u32 s57, s56, 0x10000
  s_lshl_b32 s58, s76, 17
  s_add_u32 s58, s58, s33
  s_add_u32 s58, s58, 4194304
  s_add_u32 s59, s58, 0x10000
  s_lshl_b32 s54, s77, 17
  ds_read_b64_tr_b16 v[142:143], v70 offset:27136
  ds_read_b128 v[144:147], v13 offset:24576
  ds_read_b64_tr_b16 v[148:149], v71 offset:24576
  v_mfma_f32_32x32x16_bf16 v[80:95], v[212:215], v[208:211], v[80:95]
  s_add_u32 s54, s54, s33
  s_add_u32 s54, s54, 8388608
  v_bfe_u32 v78, v1, 4, 1
  v_lshlrev_b32 v78, 16, v78
  v_lshrrev_b32 v79, 5, v1
  v_lshl_add_u32 v78, v79, 8, v78
  ds_read_b64_tr_b16 v[150:151], v71 offset:25088
  ds_read_b64_tr_b16 v[152:153], v71 offset:25600
  ds_read_b64_tr_b16 v[154:155], v71 offset:26112
  v_mfma_f32_16x16x32_bf16 v[48:51], v[44:47], v[212:215], v[48:51]
  v_mfma_f32_32x32x16_bf16 v[96:111], v[216:219], v[208:211], v[96:111]
  v_and_b32 v79, 15, v1
  v_lshl_add_u32 v78, v79, 4, v78
  v_and_b32 v7, 124, v3
  s_xor_b32 s33, s12, 1
  s_mul_i32 s33, s33, 3072
  v_add_u32 v5, s33, v7
  ds_read_b64_tr_b16 v[156:157], v71 offset:26624
  ds_read_b64_tr_b16 v[158:159], v71 offset:27136
  v_mfma_f32_16x16x32_bf16 v[52:55], v[44:47], v[216:219], v[52:55]
  v_mfma_f32_32x32x16_bf16 v[112:127], v[208:211], v[220:223], v[112:127]
  s_xor_b32 s33, s12, 2
  s_mul_i32 s33, s33, 3072
  v_add_u32 v6, s33, v7
  v_add_u32 v4, s44, v3
  s_add_u32 s33, s44, 1024
  v_add_u32 v76, s33, v3
  ds_read_b128 v[160:163], v14 offset:24576
  ds_read_b64_tr_b16 v[164:165], v70 offset:36864
  v_mfma_f32_16x16x32_bf16 v[56:59], v[44:47], v[220:223], v[56:59]
  v_mfma_f32_32x32x16_bf16 v[80:95], v[228:231], v[224:227], v[80:95]
  v_lshrrev_b32 v77, 5, v1
  v_lshlrev_b32 v77, 4, v77
  v_add_u32 v77, s33, v77
  v_cmp_gt_u32 vcc, 32, v1
  s_lshl_b32 s42, s16, 6
  s_add_u32 s42, s42, s17
  ds_read_b64_tr_b16 v[166:167], v70 offset:37376
  ds_read_b64_tr_b16 v[168:169], v70 offset:37888
  v_mfma_f32_32x32x16_bf16 v[96:111], v[232:235], v[224:227], v[96:111]
  s_lshl_b32 s42, s42, 8
  s_add_u32 s42, s42, 42991616
  s_and_b32 s33, s15, 3
  s_mul_i32 s34, s33, 6144
  s_add_u32 s34, s34, 73728
  v_lshrrev_b32 v43, 5, v1
  ds_read_b64_tr_b16 v[170:171], v70 offset:38400
  ds_read_b64_tr_b16 v[172:173], v70 offset:38912
  v_mfma_f32_16x16x32_bf16 v[60:63], v[44:47], v[224:227], v[60:63]
  v_mfma_f32_32x32x16_bf16 v[112:127], v[224:227], v[236:239], v[112:127]
  v_mul_u32_u24 v64, 2560, v43
  s_mul_i32 s53, s25, 6144
  s_sub_u32 s34, s34, s53
  v_sub_u32 v43, v66, v64
  v_add_u32 v43, s34, v43
  s_add_u32 s53, s48, 7
  ds_read_b64_tr_b16 v[174:175], v70 offset:39424
  ds_read_b128 v[176:179], v15 offset:24576
  v_mfma_f32_32x32x16_bf16 v[80:95], v[244:247], v[240:243], v[80:95]
  s_and_b32 s53, s53, 7
  s_lshl_b32 s53, s53, 2
  s_add_u32 s53, s53, s33
  s_lshl_b32 s53, s53, 10
  s_mul_i32 s33, s16, 33792
  s_add_u32 s53, s53, s33
  ds_read_b64_tr_b16 v[180:181], v71 offset:36864
  ds_read_b64_tr_b16 v[182:183], v71 offset:37376
  v_mfma_f32_16x16x32_bf16 v[48:51], v[44:47], v[244:247], v[48:51]
  v_mfma_f32_32x32x16_bf16 v[96:111], v[248:251], v[240:243], v[96:111]
  s_add_u32 s53, s53, 37748736
  ds_read_b64_tr_b16 v[184:185], v71 offset:37888
  ds_read_b64_tr_b16 v[186:187], v71 offset:38400
  v_mfma_f32_16x16x32_bf16 v[52:55], v[44:47], v[248:251], v[52:55]
  v_mfma_f32_32x32x16_bf16 v[112:127], v[240:243], v[252:255], v[112:127]
  ds_read_b64_tr_b16 v[188:189], v71 offset:38912
  ds_read_b64_tr_b16 v[190:191], v71 offset:39424
  v_mfma_f32_16x16x32_bf16 v[56:59], v[44:47], v[252:255], v[56:59]
  v_dot2_f32_bf16 v32, v192, v192, v32
  v_dot2_f32_bf16 v33, v224, v224, v33
  v_dot2_f32_bf16 v32, v193, v193, v32
  v_dot2_f32_bf16 v33, v225, v225, v33
  v_dot2_f32_bf16 v32, v194, v194, v32
  v_dot2_f32_bf16 v33, v226, v226, v33
  v_dot2_f32_bf16 v32, v195, v195, v32
  v_dot2_f32_bf16 v33, v227, v227, v33
  s_waitcnt lgkmcnt(0)
  v_dot2_f32_bf16 v32, v128, v128, v32
  v_dot2_f32_bf16 v33, v160, v160, v33
  v_dot2_f32_bf16 v32, v129, v129, v32
  v_dot2_f32_bf16 v33, v161, v161, v33
  v_dot2_f32_bf16 v32, v130, v130, v32
  v_dot2_f32_bf16 v33, v162, v162, v33
  v_dot2_f32_bf16 v32, v131, v131, v32
  v_dot2_f32_bf16 v33, v163, v163, v33
  v_mfma_f32_16x16x32_bf16 v[60:63], v[44:47], v[128:131], v[60:63]
  v_mfma_f32_16x16x32_bf16 v[48:51], v[44:47], v[148:151], v[48:51]
  v_mfma_f32_16x16x32_bf16 v[52:55], v[44:47], v[152:155], v[52:55]
  v_mfma_f32_16x16x32_bf16 v[56:59], v[44:47], v[156:159], v[56:59]
  v_mfma_f32_16x16x32_bf16 v[60:63], v[44:47], v[160:163], v[60:63]
  v_mfma_f32_16x16x32_bf16 v[48:51], v[44:47], v[180:183], v[48:51]
  v_mfma_f32_16x16x32_bf16 v[52:55], v[44:47], v[184:187], v[52:55]
  v_mfma_f32_16x16x32_bf16 v[56:59], v[44:47], v[188:191], v[56:59]
  v_mfma_f32_32x32x16_bf16 v[80:95], v[132:135], v[128:131], v[80:95]
  v_mfma_f32_32x32x16_bf16 v[96:111], v[136:139], v[128:131], v[96:111]
  ds_read_b64_tr_b16 v[204:205], v43 offset:0
  ds_read_b64_tr_b16 v[206:207], v43 offset:3072
  ds_read_b64_tr_b16 v[208:209], v43 offset:1024
  ds_read_b64_tr_b16 v[210:211], v43 offset:4096
  ds_read_b64_tr_b16 v[212:213], v43 offset:2048
  ds_read_b64_tr_b16 v[214:215], v43 offset:5120
  v_add_f32 v32, v32, v33
  ds_write_b32 v4, v32 offset:512
  v_mfma_f32_32x32x16_bf16 v[112:127], v[128:131], v[140:143], v[112:127]
  s_mov_b64 exec, 0xffff
  ds_write2_b32 v4, v48, v49 offset0:0 offset1:16
  ds_write2_b32 v4, v52, v53 offset0:32 offset1:48
  ds_write2_b32 v4, v56, v57 offset0:64 offset1:80
  ds_write2_b32 v4, v60, v61 offset0:96 offset1:112
  s_mov_b64 exec, -1
  v_add_u32 v4, s44, v7
  v_mfma_f32_32x32x16_bf16 v[80:95], v[148:151], v[144:147], v[80:95]
  s_waitcnt lgkmcnt(0)
  s_barrier
  ds_read_b32 v16, v4 offset:384
  ds_read_b32 v18, v5 offset:384
  ds_read2_b32 v[20:21], v4 offset0:128 offset1:160
  ds_read2_b32 v[22:23], v5 offset0:128 offset1:160
  ds_read_b32 v34, v4 offset:0
  ds_read_b32 v48, v6 offset:0
  v_mfma_f32_32x32x16_bf16 v[96:111], v[152:155], v[144:147], v[96:111]
  ds_read_b32 v35, v4 offset:128
  ds_read_b32 v49, v6 offset:128
  ds_read_b32 v36, v4 offset:256
  ds_read_b32 v50, v6 offset:256
  v_mfma_f32_32x32x16_bf16 v[112:127], v[144:147], v[156:159], v[112:127]
  s_waitcnt lgkmcnt(6)
  v_add_f32 v16, v16, v18
  v_add_f32 v20, v20, v21
  v_add_f32 v22, v22, v23
  v_add_f32 v17, v20, v22
  v_mul_f32 v16, 0xbb000000, v16
  v_mul_f32 v17, 0x3b000000, v17
  v_fma_f32 v17, -v16, v16, v17
  v_mfma_f32_32x32x16_bf16 v[80:95], v[164:167], v[160:163], v[80:95]
  v_max_f32 v17, 0, v17
  v_add_f32 v17, 0x3727c5ac, v17
  v_rsq_f32 v68, v17
  v_and_b32 v18, 0xffff0000, v16
  v_sub_f32 v24, v16, v18
  v_and_b32 v19, 0xffff0000, v24
  v_sub_f32 v24, v24, v19
  v_and_b32 v20, 0xffff0000, v24
  v_mfma_f32_32x32x16_bf16 v[96:111], v[168:171], v[160:163], v[96:111]
  ds_write_b32 v76, v68
  v_lshrrev_b32 v72, 16, v18
  v_or_b32 v72, v72, v19
  v_lshrrev_b32 v73, 16, v20
  v_mov_b32 v74, 0
  v_lshrrev_b32 v75, 16, v18
  v_mul_f32 v69, 0x3eb8aa3b, v68
  ds_read_b128 v[16:19], v77 offset:0
  v_mfma_f32_32x32x16_bf16 v[112:127], v[160:163], v[172:175], v[112:127]
  ds_read_b128 v[20:23], v77 offset:32
  ds_read_b128 v[24:27], v77 offset:64
  ds_read_b128 v[28:31], v77 offset:96
  v_mfma_f32_32x32x16_bf16 v[80:95], v[180:183], v[176:179], v[80:95]
  s_waitcnt lgkmcnt(5)
  v_add_f32 v35, v35, v49
  v_and_b32 v44, 0xffff0000, v35
  v_sub_f32 v47, v35, v44
  v_and_b32 v45, 0xffff0000, v47
  v_sub_f32 v47, v47, v45
  v_and_b32 v46, 0xffff0000, v47
  v_lshrrev_b32 v197, 16, v44
  v_mfma_f32_32x32x16_bf16 v[96:111], v[184:187], v[176:179], v[96:111]
  v_or_b32 v196, v197, v44
  v_lshrrev_b32 v199, 16, v45
  v_lshrrev_b32 v47, 16, v46
  v_or_b32 v47, v47, v45
  v_cndmask_b32 v196, v47, v196, vcc
  v_cndmask_b32 v197, 0, v197, vcc
  v_mov_b32 v198, 0
  v_cndmask_b32 v199, 0, v199, vcc
  v_mfma_f32_32x32x16_bf16 v[112:127], v[176:179], v[188:191], v[112:127]
  v_add_f32 v36, v36, v50
  v_and_b32 v44, 0xffff0000, v36
  v_sub_f32 v47, v36, v44
  v_and_b32 v45, 0xffff0000, v47
  v_sub_f32 v47, v47, v45
  v_and_b32 v46, 0xffff0000, v47
  v_lshrrev_b32 v201, 16, v44
  v_or_b32 v200, v201, v44
  v_lshrrev_b32 v203, 16, v45
  v_lshrrev_b32 v47, 16, v46
  v_or_b32 v47, v47, v45
  v_cndmask_b32 v200, v47, v200, vcc
  v_cndmask_b32 v201, 0, v201, vcc
  v_mov_b32 v202, 0
  v_cndmask_b32 v203, 0, v203, vcc
  v_add_f32 v34, v34, v48
  v_and_b32 v44, 0xffff0000, v34
  v_sub_f32 v47, v34, v44
  v_and_b32 v45, 0xffff0000, v47
  v_sub_f32 v47, v47, v45
  v_and_b32 v46, 0xffff0000, v47
  v_lshrrev_b32 v193, 16, v44
  v_or_b32 v192, v193, v44
  v_lshrrev_b32 v195, 16, v45
  v_lshrrev_b32 v47, 16, v46
  v_or_b32 v47, v47, v45
  v_cndmask_b32 v192, v47, v192, vcc
  v_cndmask_b32 v193, 0, v193, vcc
  v_mov_b32 v194, 0
  v_cndmask_b32 v195, 0, v195, vcc
  s_branch p0_after
p0_clr0:
  s_cmp_lg_u32 s12, 0
  s_cbranch_scc1 p0_back0
  s_mov_b64 exec, 1
  v_mov_b32 v38, 1
  buffer_atomic_add v38, v3, s[20:23], 0 offen sc0 sc1
  s_mov_b64 exec, -1
  s_branch p0_back0
p0_clr3:
  s_cmp_lg_u32 s12, 0
  s_cbranch_scc1 p0_back3
  v_readfirstlane_b32 s33, v38
  s_cmp_lg_u32 s33, 31
  s_cbranch_scc1 p0_back3
  s_mov_b64 exec, 1
  v_mov_b32 v38, 1
  buffer_store_dword v38, v3, s[20:23], 0 offen offset:128 sc1
  s_mov_b64 exec, -1
  s_branch p0_back3
p0_after:
  v_mfma_f32_32x32x16_bf16 v[96:111], v[196:199], v[72:75], v[96:111]
  v_mfma_f32_32x32x16_bf16 v[112:127], v[72:75], v[200:203], v[112:127]
  v_mfma_f32_32x32x16_bf16 v[80:95], v[192:195], v[72:75], v[80:95]
  s_cmp_lg_u32 s19, 0
  s_cbranch_scc1 p0_nowe
  buffer_store_dwordx4 v[204:207], v2, s[4:7], s53 offen sc1
  s_add_u32 s53, s53, 540672
  buffer_store_dwordx4 v[208:211], v2, s[4:7], s53 offen sc1
  s_add_u32 s53, s53, 540672
  buffer_store_dwordx4 v[212:215], v2, s[4:7], s53 offen sc1
  s_cmp_lg_u32 s17, 0
  s_cbranch_scc1 p0_nowe
  s_mul_i32 s33, s16, 33792
  s_add_u32 s33, s33, 37781504
  buffer_store_dwordx4 v[192:195], v2, s[4:7], s33 offen sc1
  s_mul_i32 s33, s76, 33792
  s_add_u32 s33, s33, 38322176
  buffer_store_dwordx4 v[196:199], v2, s[4:7], s33 offen sc1
  s_mul_i32 s33, s77, 33792
  s_add_u32 s33, s33, 38862848
  buffer_store_dwordx4 v[200:203], v2, s[4:7], s33 offen sc1
p0_nowe:
  s_mov_b64 exec, 1
  buffer_load_dword v39, v3, s[20:23], 0 offen offset:128 sc1
  s_mov_b64 exec, -1
  s_waitcnt lgkmcnt(0)
  s_nop 3
  v_pk_mul_f32 v[96:97], v[96:97], v[68:69] op_sel:[0,0] op_sel_hi:[1,0]
  v_pk_mul_f32 v[98:99], v[98:99], v[68:69] op_sel:[0,0] op_sel_hi:[1,0]
  v_pk_mul_f32 v[100:101], v[100:101], v[68:69] op_sel:[0,0] op_sel_hi:[1,0]
  v_pk_mul_f32 v[102:103], v[102:103], v[68:69] op_sel:[0,0] op_sel_hi:[1,0]
  v_cvt_pk_bf16_f32 v96, v96, v97
  v_cvt_pk_bf16_f32 v97, v98, v99
  v_cvt_pk_bf16_f32 v98, v100, v101
  v_cvt_pk_bf16_f32 v99, v102, v103
  buffer_store_dwordx4 v[96:99], v2, s[4:7], s58 offen sc1
  v_pk_mul_f32 v[104:105], v[104:105], v[68:69] op_sel:[0,0] op_sel_hi:[1,0]
  v_pk_mul_f32 v[106:107], v[106:107], v[68:69] op_sel:[0,0] op_sel_hi:[1,0]
  v_pk_mul_f32 v[108:109], v[108:109], v[68:69] op_sel:[0,0] op_sel_hi:[1,0]
  v_pk_mul_f32 v[110:111], v[110:111], v[68:69] op_sel:[0,0] op_sel_hi:[1,0]
  v_cvt_pk_bf16_f32 v104, v104, v105
  v_cvt_pk_bf16_f32 v105, v106, v107
  v_cvt_pk_bf16_f32 v106, v108, v109
  v_cvt_pk_bf16_f32 v107, v110, v111
  buffer_store_dwordx4 v[104:107], v2, s[4:7], s59 offen sc1
  v_pk_mul_f32 v[112:113], v[112:113], v[16:17]
  v_pk_mul_f32 v[114:115], v[114:115], v[18:19]
  v_pk_mul_f32 v[116:117], v[116:117], v[20:21]
  v_pk_mul_f32 v[118:119], v[118:119], v[22:23]
  v_cvt_pk_bf16_f32 v112, v112, v113
  v_cvt_pk_bf16_f32 v113, v114, v115
  v_cvt_pk_bf16_f32 v114, v116, v117
  v_cvt_pk_bf16_f32 v115, v118, v119
  buffer_store_dwordx4 v[112:115], v78, s[4:7], s54 offen offset:0 sc1
  v_pk_mul_f32 v[120:121], v[120:121], v[24:25]
  v_pk_mul_f32 v[122:123], v[122:123], v[26:27]
  v_pk_mul_f32 v[124:125], v[124:125], v[28:29]
  v_pk_mul_f32 v[126:127], v[126:127], v[30:31]
  v_cvt_pk_bf16_f32 v120, v120, v121
  v_cvt_pk_bf16_f32 v121, v122, v123
  v_cvt_pk_bf16_f32 v122, v124, v125
  v_cvt_pk_bf16_f32 v123, v126, v127
  buffer_store_dwordx4 v[120:123], v78, s[4:7], s54 offen offset:512 sc1
  v_pk_mul_f32 v[80:81], v[80:81], v[68:69] op_sel:[0,1] op_sel_hi:[1,1]
  v_pk_mul_f32 v[82:83], v[82:83], v[68:69] op_sel:[0,1] op_sel_hi:[1,1]
  v_pk_mul_f32 v[84:85], v[84:85], v[68:69] op_sel:[0,1] op_sel_hi:[1,1]
  v_pk_mul_f32 v[86:87], v[86:87], v[68:69] op_sel:[0,1] op_sel_hi:[1,1]
  v_cvt_pk_bf16_f32 v80, v80, v81
  v_cvt_pk_bf16_f32 v81, v82, v83
  v_cvt_pk_bf16_f32 v82, v84, v85
  v_cvt_pk_bf16_f32 v83, v86, v87
  buffer_store_dwordx4 v[80:83], v2, s[4:7], s56 offen sc1
  v_pk_mul_f32 v[88:89], v[88:89], v[68:69] op_sel:[0,1] op_sel_hi:[1,1]
  v_pk_mul_f32 v[90:91], v[90:91], v[68:69] op_sel:[0,1] op_sel_hi:[1,1]
  v_pk_mul_f32 v[92:93], v[92:93], v[68:69] op_sel:[0,1] op_sel_hi:[1,1]
  v_pk_mul_f32 v[94:95], v[94:95], v[68:69] op_sel:[0,1] op_sel_hi:[1,1]
  v_cvt_pk_bf16_f32 v88, v88, v89
  v_cvt_pk_bf16_f32 v89, v90, v91
  v_cvt_pk_bf16_f32 v90, v92, v93
  v_cvt_pk_bf16_f32 v91, v94, v95
  buffer_store_dwordx4 v[88:91], v2, s[4:7], s57 offen sc1
  v_and_b32 v4, 27, v1
  v_cmp_eq_u32 vcc, 16, v4
  s_nop 1
  v_cndmask_b32 v96, 0, v37, vcc
  v_cndmask_b32 v97, 0, v37, vcc
  v_pk_mov_b32 v[98:99], v[96:97], v[96:97]
  v_pk_mov_b32 v[100:101], v[96:97], v[96:97]
  v_pk_mov_b32 v[102:103], v[96:97], v[96:97]
  v_pk_mov_b32 v[104:105], v[96:97], v[96:97]
  v_pk_mov_b32 v[106:107], v[96:97], v[96:97]
  v_pk_mov_b32 v[108:109], v[96:97], v[96:97]
  v_pk_mov_b32 v[110:111], v[96:97], v[96:97]
  v_pk_mov_b32 v[112:113], v[96:97], v[96:97]
  v_pk_mov_b32 v[114:115], v[96:97], v[96:97]
  v_pk_mov_b32 v[116:117], v[96:97], v[96:97]
  v_pk_mov_b32 v[118:119], v[96:97], v[96:97]
  v_pk_mov_b32 v[120:121], v[96:97], v[96:97]
  v_pk_mov_b32 v[122:123], v[96:97], v[96:97]
  v_pk_mov_b32 v[124:125], v[96:97], v[96:97]
  v_pk_mov_b32 v[126:127], v[96:97], v[96:97]
  v_pk_mov_b32 v[128:129], v[96:97], v[96:97]
  v_pk_mov_b32 v[130:131], v[96:97], v[96:97]
  v_pk_mov_b32 v[132:133], v[96:97], v[96:97]
  v_pk_mov_b32 v[134:135], v[96:97], v[96:97]
  v_pk_mov_b32 v[136:137], v[96:97], v[96:97]
  v_pk_mov_b32 v[138:139], v[96:97], v[96:97]
  v_pk_mov_b32 v[140:141], v[96:97], v[96:97]
  v_pk_mov_b32 v[142:143], v[96:97], v[96:97]
  v_pk_mov_b32 v[144:145], v[96:97], v[96:97]
  v_pk_mov_b32 v[146:147], v[96:97], v[96:97]
  v_pk_mov_b32 v[148:149], v[96:97], v[96:97]
  v_pk_mov_b32 v[150:151], v[96:97], v[96:97]
  v_pk_mov_b32 v[152:153], v[96:97], v[96:97]
  v_pk_mov_b32 v[154:155], v[96:97], v[96:97]
  v_pk_mov_b32 v[156:157], v[96:97], v[96:97]
  v_pk_mov_b32 v[158:159], v[96:97], v[96:97]
  v_pk_mov_b32 v[160:161], v[96:97], v[96:97]
  v_pk_mov_b32 v[162:163], v[96:97], v[96:97]
  v_pk_mov_b32 v[164:165], v[96:97], v[96:97]
  v_pk_mov_b32 v[166:167], v[96:97], v[96:97]
  v_pk_mov_b32 v[168:169], v[96:97], v[96:97]
  v_pk_mov_b32 v[170:171], v[96:97], v[96:97]
  v_pk_mov_b32 v[172:173], v[96:97], v[96:97]
  v_pk_mov_b32 v[174:175], v[96:97], v[96:97]
  v_pk_mov_b32 v[176:177], v[96:97], v[96:97]
  v_pk_mov_b32 v[178:179], v[96:97], v[96:97]
  v_pk_mov_b32 v[180:181], v[96:97], v[96:97]
  v_pk_mov_b32 v[182:183], v[96:97], v[96:97]
  v_pk_mov_b32 v[184:185], v[96:97], v[96:97]
  v_pk_mov_b32 v[186:187], v[96:97], v[96:97]
  v_pk_mov_b32 v[188:189], v[96:97], v[96:97]
  v_pk_mov_b32 v[190:191], v[96:97], v[96:97]
  v_pk_mov_b32 v[192:193], v[96:97], v[96:97]
  v_pk_mov_b32 v[194:195], v[96:97], v[96:97]
  v_pk_mov_b32 v[196:197], v[96:97], v[96:97]
  v_pk_mov_b32 v[198:199], v[96:97], v[96:97]
  v_pk_mov_b32 v[200:201], v[96:97], v[96:97]
  v_pk_mov_b32 v[202:203], v[96:97], v[96:97]
  v_pk_mov_b32 v[204:205], v[96:97], v[96:97]
  v_pk_mov_b32 v[206:207], v[96:97], v[96:97]
  v_pk_mov_b32 v[208:209], v[96:97], v[96:97]
  v_pk_mov_b32 v[210:211], v[96:97], v[96:97]
  v_pk_mov_b32 v[212:213], v[96:97], v[96:97]
  v_pk_mov_b32 v[214:215], v[96:97], v[96:97]
  v_pk_mov_b32 v[216:217], v[96:97], v[96:97]
  v_pk_mov_b32 v[218:219], v[96:97], v[96:97]
  v_pk_mov_b32 v[220:221], v[96:97], v[96:97]
  v_pk_mov_b32 v[222:223], v[96:97], v[96:97]
  s_waitcnt vmcnt(6)
  s_mov_b32 s34, 0
p0_clr_poll:
  v_readfirstlane_b32 s33, v39
  s_cmp_eq_u32 s33, 1
  s_cbranch_scc1 p0_clr_ok
  s_mov_b64 exec, 1
  buffer_load_dword v39, v3, s[20:23], 0 offen offset:128 sc1
  s_mov_b64 exec, -1
  s_add_u32 s34, s34, 1
  s_waitcnt vmcnt(0)
  s_cmp_lt_u32 s34, 2097152
  s_cbranch_scc1 p0_clr_poll
p0_clr_ok:
  s_waitcnt vmcnt(0)
  s_mov_b32 exec_hi, 0
  v_mov_b32 v38, 1
  buffer_store_dword v38, v3, s[4:7], s42 offen sc1
  s_mov_b64 exec, -1
  s_cmp_ge_u32 s26, 206
  s_cbranch_scc1 p0_rd3
  s_barrier
  s_cmp_eq_u32 s65, 0
  s_cbranch_scc1 p0_rd2
  ds_read_b64_tr_b16 v[224:225], v41 offset:0
  ds_read_b64_tr_b16 v[226:227], v41 offset:512
  ds_read_b64_tr_b16 v[228:229], v41 offset:1024
  ds_read_b64_tr_b16 v[230:231], v41 offset:1536
  ds_read_b64_tr_b16 v[232:233], v41 offset:2048
  ds_read_b64_tr_b16 v[234:235], v41 offset:2560
  ds_read_b64_tr_b16 v[236:237], v41 offset:3072
  ds_read_b64_tr_b16 v[238:239], v41 offset:3584
  s_branch p0_rd3
p0_rd2:
  ds_read_b64_tr_b16 v[224:225], v41 offset:0
  ds_read_b64_tr_b16 v[226:227], v41 offset:8192
  ds_read_b64_tr_b16 v[228:229], v41 offset:64
  ds_read_b64_tr_b16 v[230:231], v41 offset:8256
  ds_read_b64_tr_b16 v[232:233], v41 offset:128
  ds_read_b64_tr_b16 v[234:235], v41 offset:8320
  ds_read_b64_tr_b16 v[236:237], v41 offset:192
  ds_read_b64_tr_b16 v[238:239], v41 offset:8384
p0_rd3:
  s_cmp_ge_u32 s26, 206
  s_cbranch_scc1 p0_noside
  s_waitcnt lgkmcnt(0)
  buffer_store_dwordx4 v[224:227], v2, s[4:7], s66 offen sc1
  s_add_u32 s66, s66, s72
  buffer_store_dwordx4 v[228:231], v2, s[4:7], s66 offen sc1
  s_add_u32 s66, s66, s72
  buffer_store_dwordx4 v[232:235], v2, s[4:7], s66 offen sc1
  s_add_u32 s66, s66, s72
  buffer_store_dwordx4 v[236:239], v2, s[4:7], s66 offen sc1
  s_add_u32 s66, s66, s72
p0_noside:
  s_cmp_eq_u32 s65, 0
  s_cbranch_scc1 p0_nosum
  v_mov_b32 v32, 0
  v_mov_b32 v33, 0
  v_dot2_f32_bf16 v32, v224, v37, v32
  v_dot2_f32_bf16 v33, v225, v37, v33
  v_dot2_f32_bf16 v32, v226, v37, v32
  v_dot2_f32_bf16 v33, v227, v37, v33
  v_dot2_f32_bf16 v32, v228, v37, v32
  v_dot2_f32_bf16 v33, v229, v37, v33
  v_dot2_f32_bf16 v32, v230, v37, v32
  v_dot2_f32_bf16 v33, v231, v37, v33
  v_dot2_f32_bf16 v32, v232, v37, v32
  v_dot2_f32_bf16 v33, v233, v37, v33
  v_dot2_f32_bf16 v32, v234, v37, v32
  v_dot2_f32_bf16 v33, v235, v37, v33
  v_dot2_f32_bf16 v32, v236, v37, v32
  v_dot2_f32_bf16 v33, v237, v37, v33
  v_dot2_f32_bf16 v32, v238, v37, v32
  v_dot2_f32_bf16 v33, v239, v37, v33
  s_lshl_b32 s33, s12, 8
  s_add_u32 s33, s33, 16384
  v_add_u32 v4, s33, v3
  v_add_f32 v32, v32, v33
  ds_write_b32 v4, v32
  s_waitcnt lgkmcnt(0)
  s_barrier
p0_nosum:
  s_cmp_lg_u32 s12, 3
  s_cbranch_scc1 p0_done
  s_cmp_ge_u32 s26, 206
  s_cbranch_scc1 p0_done
  s_cmp_eq_u32 s65, 0
  s_cbranch_scc1 p0_wsig
  v_and_b32 v6, 31, v1
  v_lshlrev_b32 v6, 2, v6
  v_add_u32 v5, 16384, v6
  ds_read_b32 v48, v5 offset:0
  ds_read_b32 v49, v5 offset:128
  ds_read_b32 v50, v5 offset:256
  ds_read_b32 v51, v5 offset:384
  ds_read_b32 v52, v5 offset:512
  ds_read_b32 v53, v5 offset:640
  ds_read_b32 v54, v5 offset:768
  ds_read_b32 v55, v5 offset:896
  v_mov_b32 v61, 0
  s_cmp_lg_u32 s69, 0
  s_cbranch_scc1 p0_nobias
  s_mov_b32 s92, s90
  s_and_b32 s93, s91, 0xffff
  s_mov_b32 s94, 2752
  s_lshl_b32 s33, s68, 6
  v_lshrrev_b32 v7, 1, v6
  buffer_load_ushort v61, v7, s[92:95], s33 offen
  s_waitcnt vmcnt(0)
  v_lshlrev_b32 v61, 16, v61
p0_nobias:
  s_waitcnt lgkmcnt(0)
  v_add_f32 v48, v48, v49
  v_add_f32 v50, v50, v51
  v_add_f32 v52, v52, v53
  v_add_f32 v54, v54, v55
  v_add_f32 v48, v48, v50
  v_add_f32 v52, v52, v54
  v_add_f32 v48, v48, v52
  v_and_b32 v62, 0xffff0000, v48
  v_sub_f32 v65, v48, v62
  v_and_b32 v63, 0xffff0000, v65
  v_sub_f32 v65, v65, v63
  v_and_b32 v64, 0xffff0000, v65
  v_lshrrev_b32 v56, 16, v62
  v_or_b32 v56, v56, v62
  v_lshrrev_b32 v57, 16, v62
  v_or_b32 v57, v57, v61
  v_lshrrev_b32 v58, 16, v61
  v_or_b32 v58, v58, v61
  v_lshrrev_b32 v59, 16, v63
  v_or_b32 v59, v59, v64
  s_lshl_b32 s33, s69, 9
  s_add_u32 s33, s33, s70
  s_add_u32 s33, s33, 32768
  s_mov_b32 exec_hi, 0
  buffer_store_dwordx4 v[56:59], v2, s[4:7], s33 offen sc1
  s_mov_b64 exec, -1
p0_wsig:
  s_mov_b32 s96, 1
  s_branch p0_out
p0_done:
  s_mov_b32 s96, 0
p0_out:
  s_and_b32 s33, s26, 7
  s_mul_i32 s42, s33, 512
  s_add_u32 s42, s42, 45875200
  s_cmp_lt_u32 s33, 6
  s_cselect_b32 s69, 25, 24
  s_load_dwordx2 s[88:89], s[0:1], 56
  s_and_b32 s13, s2, 7
  s_lshr_b32 s14, s2, 3
  s_lshl_b32 s15, s13, 1
  s_and_b32 s29, s14, 1
  s_add_u32 s15, s15, s29
  s_lshr_b32 s16, s14, 1
  s_lshl_b32 s17, s15, 2
  s_and_b32 s29, s12, 1
  s_lshl_b32 s29, s29, 1
  s_add_u32 s17, s17, s29
  s_lshr_b32 s29, s12, 1
  s_add_u32 s17, s17, s29
  s_lshl_b32 s18, s13, 2
  s_and_b32 s29, s14, 3
  s_add_u32 s18, s18, s29
  s_lshr_b32 s19, s14, 2
  s_lshl_b32 s21, s18, 1
  s_lshr_b32 s29, s12, 1
  s_add_u32 s20, s21, s29
  s_lshl_b32 s22, s19, 1
  s_and_b32 s29, s12, 1
  s_add_u32 s22, s22, s29
  s_xor_b32 s23, s22, 1
  s_mov_b32 s24, s18
  s_mov_b32 s25, s19
  s_mov_b32 s26, 0
  s_mov_b32 s27, 0
  s_mov_b32 s28, 42991616
  s_mov_b32 s30, 0x0000ffff
  s_mov_b32 s31, 0x0000ffff
  s_lshl_b32 s32, s20, 5
  s_lshl_b32 s29, s22, 1
  s_add_u32 s32, s32, s29
  s_lshl_b32 s32, s32, 10
  s_mul_i32 s33, s12, 22
  s_mul_i32 s29, s12, 21
  s_add_u32 s29, s29, 1
  s_cmp_ge_u32 s12, 2
  s_cselect_b32 s33, s29, s33
  s_lshl_b32 s34, s16, 6
  s_add_u32 s34, s34, s17
  s_lshr_b32 s35, s24, 1
  s_lshl_b32 s35, s35, 6
  s_lshl_b32 s85, s17, 4
  s_add_u32 s36, s85, s16
  s_lshl_b32 s37, s25, 2
  s_add_u32 s37, s37, s12
  s_lshl_b32 s37, s37, 6
  s_add_u32 s37, s37, s24
  s_lshl_b32 s38, s18, 3
  s_add_u32 s38, s38, s12
  s_lshl_b32 s38, s38, 3
  s_lshl_b32 s84, s20, 4
  s_add_u32 s84, s84, s22
  s_lshl_b32 s86, s21, 4
  s_mov_b32 s94, -1
  s_mov_b32 s95, 0
  v_and_b32 v4, 31, v1
  v_lshlrev_b32 v4, 10, v4
  v_lshrrev_b32 v5, 5, v1
  v_lshl_add_u32 v4, v5, 4, v4
  s_lshl_b32 s53, s20, 15
  s_lshl_b32 s54, s22, 6
  s_add_u32 s53, s53, s54
  buffer_load_dwordx4 v[8:11], v4, s[8:11], s53 offen
  buffer_load_dwordx4 v[12:15], v4, s[8:11], s53 offen offset:32
  s_mov_b32 s41, s96
  s_mov_b32 s97, 2
  s_waitcnt lgkmcnt(0)
  s_mov_b32 s8, s88
  s_and_b32 s9, s89, 0xffff
  s_mov_b32 s10, 2097152
  s_mov_b32 s11, 0x00020000
  s_branch main_attpre2
main_layer:
  s_lshl_b32 s47, s17, 15
  s_lshl_b32 s29, s27, 1
  s_add_u32 s47, s47, s29
  s_add_u32 s47, s47, 28049408
  s_lshl_b32 s48, s17, 12
  s_mul_i32 s29, s26, 524288
  s_add_u32 s48, s48, s29
  s_add_u32 s48, s48, 36438016
  s_lshl_b32 s55, s12, 10
  s_add_u32 s55, s55, 159744
  v_add_u32 v64, s55, v2
  v_add_u32 v65, s55, v3
  v_add_u32 v70, 33792, v2
  v_add_u32 v71, 67584, v2
  s_lshl_b32 s56, s16, 17
  s_lshl_b32 s57, s17, 10
  s_add_u32 s56, s56, s57
  s_add_u32 s56, s56, s27
  s_add_u32 s57, s56, 0x10000
  s_add_u32 s58, s56, 4194304
  s_add_u32 s59, s57, 4194304
  s_add_u32 s54, s56, 8388608
  s_lshl_b32 s55, s12, 8
  s_add_u32 s55, s55, 158720
  v_add_u32 v76, s55, v3
  v_lshrrev_b32 v77, 5, v1
  v_lshlrev_b32 v77, 4, v77
  v_add_u32 v77, s55, v77
  v_bfe_u32 v78, v1, 4, 1
  v_lshlrev_b32 v78, 16, v78
  v_lshrrev_b32 v79, 5, v1
  v_lshl_add_u32 v78, v79, 8, v78
  v_and_b32 v79, 15, v1
  v_lshl_add_u32 v78, v79, 4, v78
  s_waitcnt vmcnt(0)
  s_mov_b64 exec, 65535
  v_cmp_ne_u32 vcc, 1, v5
  s_mov_b64 exec, -1
  s_cmp_eq_u64 vcc, 0
  s_cbranch_scc1 main_q_go
  s_mov_b32 s51, 0
poll_1:
  s_mov_b64 exec, 65535
  buffer_load_dword v5, v4, s[4:7], s50 offen offset:0 sc1
  s_mov_b64 exec, -1
  s_add_u32 s51, s51, 1
  s_waitcnt vmcnt(0)
  s_mov_b64 exec, 65535
  v_cmp_ne_u32 vcc, 1, v5
  s_mov_b64 exec, -1
  s_cmp_eq_u64 vcc, 0
  s_cbranch_scc1 main_q_go
  s_cmp_lt_u32 s51, 2097152
  s_cbranch_scc1 poll_1
main_q_go:
main_qkv:
  buffer_load_dwordx4 v[128:131], v2, s[4:7], s47 offen offset:0 sc1
  buffer_load_dwordx4 v[132:135], v2, s[4:7], s47 offen offset:1024 sc1
  buffer_load_dwordx4 v[136:139], v2, s[4:7], s47 offen offset:2048 sc1
  buffer_load_dwordx4 v[140:143], v2, s[4:7], s47 offen offset:3072 sc1
  s_add_u32 s47, s47, 4096
  buffer_load_dwordx4 v[144:147], v2, s[4:7], s47 offen offset:0 sc1
  buffer_load_dwordx4 v[148:151], v2, s[4:7], s47 offen offset:1024 sc1
  buffer_load_dwordx4 v[16:19], v2, s[4:7], s48 offen offset:0 sc1
  buffer_load_dwordx4 v[20:23], v2, s[4:7], s48 offen offset:1024 sc1
  buffer_load_dwordx4 v[24:27], v2, s[4:7], s48 offen offset:2048 sc1
  buffer_load_dwordx4 v[28:31], v2, s[4:7], s48 offen offset:3072 sc1
  buffer_load_dwordx4 v[152:155], v2, s[4:7], s47 offen offset:2048 sc1
  buffer_load_dwordx4 v[156:159], v2, s[4:7], s47 offen offset:3072 sc1
  s_add_u32 s47, s47, 4096
  buffer_load_dwordx4 v[160:163], v2, s[4:7], s47 offen offset:0 sc1
  buffer_load_dwordx4 v[164:167], v2, s[4:7], s47 offen offset:1024 sc1
  buffer_load_dwordx4 v[168:171], v2, s[4:7], s47 offen offset:2048 sc1
  buffer_load_dwordx4 v[172:175], v2, s[4:7], s47 offen offset:3072 sc1
  s_add_u32 s47, s47, 4096
  buffer_load_dwordx4 v[176:179], v2, s[4:7], s47 offen offset:0 sc1
  buffer_load_dwordx4 v[180:183], v2, s[4:7], s47 offen offset:1024 sc1
  buffer_load_dwordx4 v[184:187], v2, s[4:7], s47 offen offset:2048 sc1
  buffer_load_dwordx4 v[188:191], v2, s[4:7], s47 offen offset:3072 sc1
  s_add_u32 s47, s47, 4096
  ds_read_b128 v[32:35], v2 offset:0
  ds_read_b128 v[36:39], v2 offset:1024
  ds_read_b128 v[40:43], v2 offset:2048
  ds_read_b128 v[44:47], v70 offset:0
  ds_read_b128 v[48:51], v2 offset:3072
  ds_read_b128 v[52:55], v2 offset:4096
  s_waitcnt vmcnt(19) lgkmcnt(5)
  v_mfma_f32_32x32x16_bf16 v[96:111], v[32:35], v[128:131], 0
  ds_read_b128 v[56:59], v70 offset:1024
  buffer_load_dwordx4 v[192:195], v2, s[4:7], s47 offen offset:0 sc1
  s_waitcnt vmcnt(19) lgkmcnt(5)
  v_mfma_f32_32x32x16_bf16 v[96:111], v[36:39], v[132:135], v[96:111]
  ds_read_b128 v[60:63], v2 offset:5120
  buffer_load_dwordx4 v[196:199], v2, s[4:7], s47 offen offset:1024 sc1
  s_waitcnt vmcnt(19) lgkmcnt(5)
  v_mfma_f32_32x32x16_bf16 v[96:111], v[40:43], v[136:139], v[96:111]
  ds_read_b128 v[32:35], v2 offset:6144
  buffer_load_dwordx4 v[200:203], v2, s[4:7], s47 offen offset:2048 sc1
  s_waitcnt lgkmcnt(5)
  v_mfma_f32_32x32x16_bf16 v[112:127], v[128:131], v[44:47], 0
  ds_read_b128 v[36:39], v70 offset:2048
  s_waitcnt vmcnt(19) lgkmcnt(5)
  v_mfma_f32_32x32x16_bf16 v[96:111], v[48:51], v[140:143], v[96:111]
  ds_read_b128 v[40:43], v2 offset:7168
  buffer_load_dwordx4 v[204:207], v2, s[4:7], s47 offen offset:3072 sc1
  s_add_u32 s47, s47, 4096
  s_waitcnt vmcnt(19) lgkmcnt(5)
  v_mfma_f32_32x32x16_bf16 v[96:111], v[52:55], v[144:147], v[96:111]
  ds_read_b128 v[44:47], v2 offset:8192
  buffer_load_dwordx4 v[208:211], v2, s[4:7], s47 offen offset:0 sc1
  s_waitcnt lgkmcnt(5)
  v_mfma_f32_32x32x16_bf16 v[112:127], v[132:135], v[56:59], v[112:127]
  ds_read_b128 v[48:51], v70 offset:3072
  s_waitcnt vmcnt(19) lgkmcnt(5)
  v_mfma_f32_32x32x16_bf16 v[96:111], v[60:63], v[148:151], v[96:111]
  ds_read_b128 v[52:55], v2 offset:9216
  buffer_load_dwordx4 v[212:215], v2, s[4:7], s47 offen offset:1024 sc1
  s_waitcnt vmcnt(15) lgkmcnt(5)
  v_mfma_f32_32x32x16_bf16 v[96:111], v[32:35], v[152:155], v[96:111]
  ds_read_b128 v[56:59], v2 offset:10240
  buffer_load_dwordx4 v[216:219], v2, s[4:7], s47 offen offset:2048 sc1
  v_add_f32 v16, v16, v24
  v_add_f32 v17, v17, v25
  s_waitcnt lgkmcnt(5)
  v_mfma_f32_32x32x16_bf16 v[112:127], v[136:139], v[36:39], v[112:127]
  ds_read_b128 v[60:63], v70 offset:4096
  v_add_f32 v18, v18, v26
  v_add_f32 v19, v19, v27
  v_add_f32 v20, v20, v28
  v_add_f32 v21, v21, v29
  s_waitcnt vmcnt(15) lgkmcnt(5)
  v_mfma_f32_32x32x16_bf16 v[96:111], v[40:43], v[156:159], v[96:111]
  ds_read_b128 v[32:35], v2 offset:11264
  buffer_load_dwordx4 v[220:223], v2, s[4:7], s47 offen offset:3072 sc1
  s_add_u32 s47, s47, 4096
  v_add_f32 v22, v22, v30
  v_add_f32 v23, v23, v31
  s_waitcnt vmcnt(15) lgkmcnt(5)
  v_mfma_f32_32x32x16_bf16 v[96:111], v[44:47], v[160:163], v[96:111]
  ds_read_b128 v[36:39], v2 offset:12288
  buffer_load_dwordx4 v[224:227], v2, s[4:7], s47 offen offset:0 sc1
  v_add_f32 v16, v16, v20
  v_add_f32 v17, v17, v21
  s_waitcnt lgkmcnt(5)
  v_mfma_f32_32x32x16_bf16 v[112:127], v[140:143], v[48:51], v[112:127]
  ds_read_b128 v[40:43], v70 offset:5120
  v_add_f32 v18, v18, v22
  v_add_f32 v19, v19, v23
  ds_write_b128 v64, v[16:19]
  ds_read2_b32 v[20:21], v65 offset0:0 offset1:64
  s_waitcnt vmcnt(15) lgkmcnt(7)
  v_mfma_f32_32x32x16_bf16 v[96:111], v[52:55], v[164:167], v[96:111]
  ds_read_b128 v[44:47], v2 offset:13312
  buffer_load_dwordx4 v[228:231], v2, s[4:7], s47 offen offset:1024 sc1
  ds_read2_b32 v[22:23], v65 offset0:128 offset1:192
  s_waitcnt vmcnt(15) lgkmcnt(8)
  v_mfma_f32_32x32x16_bf16 v[96:111], v[56:59], v[168:171], v[96:111]
  ds_read_b128 v[48:51], v2 offset:14336
  buffer_load_dwordx4 v[232:235], v2, s[4:7], s47 offen offset:2048 sc1
  s_waitcnt lgkmcnt(8)
  v_mfma_f32_32x32x16_bf16 v[112:127], v[144:147], v[60:63], v[112:127]
  ds_read_b128 v[52:55], v70 offset:6144
  s_waitcnt vmcnt(15) lgkmcnt(8)
  v_mfma_f32_32x32x16_bf16 v[96:111], v[32:35], v[172:175], v[96:111]
  ds_read_b128 v[56:59], v2 offset:15360
  buffer_load_dwordx4 v[236:239], v2, s[4:7], s47 offen offset:3072 sc1
  s_add_u32 s47, s47, 4096
  s_waitcnt vmcnt(15) lgkmcnt(8)
  v_mfma_f32_32x32x16_bf16 v[96:111], v[36:39], v[176:179], v[96:111]
  ds_read_b128 v[60:63], v2 offset:16384
  buffer_load_dwordx4 v[240:243], v2, s[4:7], s47 offen offset:0 sc1
  s_waitcnt lgkmcnt(8)
  v_mfma_f32_32x32x16_bf16 v[112:127], v[148:151], v[40:43], v[112:127]
  ds_read_b128 v[32:35], v70 offset:7168
  s_waitcnt vmcnt(15) lgkmcnt(6)
  v_mfma_f32_32x32x16_bf16 v[96:111], v[44:47], v[180:183], v[96:111]
  ds_read_b128 v[36:39], v2 offset:17408
  buffer_load_dwordx4 v[244:247], v2, s[4:7], s47 offen offset:1024 sc1
  s_waitcnt vmcnt(15) lgkmcnt(5)
  v_mfma_f32_32x32x16_bf16 v[96:111], v[48:51], v[184:187], v[96:111]
  ds_read_b128 v[40:43], v2 offset:18432
  buffer_load_dwordx4 v[248:251], v2, s[4:7], s47 offen offset:2048 sc1
  v_add_f32 v20, v20, v21
  v_add_f32 v22, v22, v23
  s_waitcnt lgkmcnt(5)
  v_mfma_f32_32x32x16_bf16 v[112:127], v[152:155], v[52:55], v[112:127]
  ds_read_b128 v[44:47], v70 offset:8192
  v_add_f32 v16, v20, v22
  v_mov_b32 v17, v16
  s_nop 1
  v_permlane32_swap_b32 v16, v17
  v_mul_f32 v16, 0xbb000000, v16
  s_waitcnt vmcnt(15) lgkmcnt(5)
  v_mfma_f32_32x32x16_bf16 v[96:111], v[56:59], v[188:191], v[96:111]
  ds_read_b128 v[48:51], v2 offset:19456
  buffer_load_dwordx4 v[252:255], v2, s[4:7], s47 offen offset:3072 sc1
  s_add_u32 s47, s47, 4096
  v_mul_f32 v17, 0x3b000000, v17
  v_fma_f32 v17, -v16, v16, v17
  s_waitcnt vmcnt(15) lgkmcnt(5)
  v_mfma_f32_32x32x16_bf16 v[96:111], v[60:63], v[192:195], v[96:111]
  ds_read_b128 v[52:55], v2 offset:20480
  v_max_f32 v17, 0, v17
  v_add_f32 v17, 0x3727c5ac, v17
  v_rsq_f32 v68, v17
  s_waitcnt lgkmcnt(5)
  v_mfma_f32_32x32x16_bf16 v[112:127], v[156:159], v[32:35], v[112:127]
  ds_read_b128 v[56:59], v70 offset:9216
  v_mul_f32 v17, v17, v68
  v_and_b32 v18, 0xffff0000, v16
  v_sub_f32 v24, v16, v18
  v_and_b32 v19, 0xffff0000, v24
  s_waitcnt vmcnt(14) lgkmcnt(5)
  v_mfma_f32_32x32x16_bf16 v[96:111], v[36:39], v[196:199], v[96:111]
  ds_read_b128 v[60:63], v2 offset:21504
  v_sub_f32 v24, v24, v19
  v_and_b32 v20, 0xffff0000, v24
  v_and_b32 v21, 0xffff0000, v17
  v_sub_f32 v24, v17, v21
  s_waitcnt vmcnt(13) lgkmcnt(5)
  v_mfma_f32_32x32x16_bf16 v[96:111], v[40:43], v[200:203], v[96:111]
  ds_read_b128 v[32:35], v2 offset:22528
  v_and_b32 v22, 0xffff0000, v24
  v_sub_f32 v24, v24, v22
  v_and_b32 v23, 0xffff0000, v24
  v_lshrrev_b32 v72, 16, v18
  s_waitcnt lgkmcnt(5)
  v_mfma_f32_32x32x16_bf16 v[112:127], v[160:163], v[44:47], v[112:127]
  ds_read_b128 v[36:39], v70 offset:10240
  v_or_b32 v72, v72, v19
  v_lshrrev_b32 v73, 16, v20
  v_or_b32 v73, v73, v21
  v_lshrrev_b32 v74, 16, v22
  s_waitcnt vmcnt(12) lgkmcnt(5)
  v_mfma_f32_32x32x16_bf16 v[96:111], v[48:51], v[204:207], v[96:111]
  ds_read_b128 v[40:43], v2 offset:23552
  v_or_b32 v74, v74, v23
  v_lshrrev_b32 v75, 16, v18
  v_or_b32 v75, v75, v18
  v_mul_f32 v69, 0x3eb8aa3b, v68
  s_waitcnt vmcnt(11) lgkmcnt(5)
  v_mfma_f32_32x32x16_bf16 v[96:111], v[52:55], v[208:211], v[96:111]
  ds_read_b128 v[44:47], v2 offset:24576
  ds_write_b32 v76, v68
  ds_read_b128 v[16:19], v77 offset:0
  ds_read_b128 v[20:23], v77 offset:32
  ds_read_b128 v[24:27], v77 offset:64
  s_waitcnt lgkmcnt(9)
  v_mfma_f32_32x32x16_bf16 v[112:127], v[164:167], v[56:59], v[112:127]
  ds_read_b128 v[48:51], v70 offset:11264
  ds_read_b128 v[28:31], v77 offset:96
  s_waitcnt vmcnt(10) lgkmcnt(10)
  v_mfma_f32_32x32x16_bf16 v[96:111], v[60:63], v[212:215], v[96:111]
  ds_read_b128 v[52:55], v2 offset:25600
  s_waitcnt vmcnt(9) lgkmcnt(10)
  v_mfma_f32_32x32x16_bf16 v[96:111], v[32:35], v[216:219], v[96:111]
  ds_read_b128 v[56:59], v2 offset:26624
  s_waitcnt lgkmcnt(10)
  v_mfma_f32_32x32x16_bf16 v[112:127], v[168:171], v[36:39], v[112:127]
  ds_read_b128 v[60:63], v70 offset:12288
  s_waitcnt vmcnt(8) lgkmcnt(10)
  v_mfma_f32_32x32x16_bf16 v[96:111], v[40:43], v[220:223], v[96:111]
  ds_read_b128 v[32:35], v2 offset:27648
  s_waitcnt vmcnt(7) lgkmcnt(10)
  v_mfma_f32_32x32x16_bf16 v[96:111], v[44:47], v[224:227], v[96:111]
  ds_read_b128 v[36:39], v2 offset:28672
  s_waitcnt lgkmcnt(6)
  v_mfma_f32_32x32x16_bf16 v[112:127], v[172:175], v[48:51], v[112:127]
  ds_read_b128 v[40:43], v70 offset:13312
  s_waitcnt vmcnt(6) lgkmcnt(5)
  v_mfma_f32_32x32x16_bf16 v[96:111], v[52:55], v[228:231], v[96:111]
  ds_read_b128 v[44:47], v2 offset:29696
  s_waitcnt vmcnt(5) lgkmcnt(5)
  v_mfma_f32_32x32x16_bf16 v[96:111], v[56:59], v[232:235], v[96:111]
  ds_read_b128 v[48:51], v2 offset:30720
  s_waitcnt lgkmcnt(5)
  v_mfma_f32_32x32x16_bf16 v[112:127], v[176:179], v[60:63], v[112:127]
  ds_read_b128 v[52:55], v70 offset:14336
  s_waitcnt vmcnt(4) lgkmcnt(5)
  v_mfma_f32_32x32x16_bf16 v[96:111], v[32:35], v[236:239], v[96:111]
  ds_read_b128 v[56:59], v2 offset:31744
  s_waitcnt vmcnt(3) lgkmcnt(5)
  v_mfma_f32_32x32x16_bf16 v[96:111], v[36:39], v[240:243], v[96:111]
  ds_read_b128 v[60:63], v2 offset:32768
  s_waitcnt lgkmcnt(5)
  v_mfma_f32_32x32x16_bf16 v[112:127], v[180:183], v[40:43], v[112:127]
  ds_read_b128 v[32:35], v70 offset:15360
  s_waitcnt vmcnt(2) lgkmcnt(5)
  v_mfma_f32_32x32x16_bf16 v[96:111], v[44:47], v[244:247], v[96:111]
  ds_read_b128 v[36:39], v70 offset:16384
  s_waitcnt vmcnt(1) lgkmcnt(5)
  v_mfma_f32_32x32x16_bf16 v[96:111], v[48:51], v[248:251], v[96:111]
  ds_read_b128 v[40:43], v70 offset:17408
  s_waitcnt lgkmcnt(5)
  v_mfma_f32_32x32x16_bf16 v[112:127], v[184:187], v[52:55], v[112:127]
  ds_read_b128 v[44:47], v70 offset:18432
  s_waitcnt vmcnt(0) lgkmcnt(5)
  v_mfma_f32_32x32x16_bf16 v[96:111], v[56:59], v[252:255], v[96:111]
  ds_read_b128 v[48:51], v70 offset:19456
  s_waitcnt lgkmcnt(5)
  v_mfma_f32_32x32x16_bf16 v[96:111], v[60:63], v[72:75], v[96:111]
  ds_read_b128 v[52:55], v70 offset:20480
  s_waitcnt lgkmcnt(4)
  v_mfma_f32_32x32x16_bf16 v[112:127], v[188:191], v[32:35], v[112:127]
  ds_read_b128 v[56:59], v70 offset:21504
  v_mfma_f32_32x32x16_bf16 v[112:127], v[192:195], v[36:39], v[112:127]
  ds_read_b128 v[60:63], v70 offset:22528
  s_waitcnt lgkmcnt(4)
  v_mfma_f32_32x32x16_bf16 v[112:127], v[196:199], v[40:43], v[112:127]
  ds_read_b128 v[32:35], v70 offset:23552
  s_nop 2
  v_mul_f32 v96, v68, v96
  v_mul_f32 v97, v68, v97
  v_mul_f32 v98, v68, v98
  v_mul_f32 v99, v68, v99
  v_mul_f32 v100, v68, v100
  v_mul_f32 v101, v68, v101
  v_mfma_f32_32x32x16_bf16 v[112:127], v[200:203], v[44:47], v[112:127]
  ds_read_b128 v[36:39], v70 offset:24576
  v_mul_f32 v102, v68, v102
  v_mul_f32 v103, v68, v103
  v_cvt_pk_bf16_f32 v96, v96, v97
  v_cvt_pk_bf16_f32 v97, v98, v99
  v_cvt_pk_bf16_f32 v98, v100, v101
  v_cvt_pk_bf16_f32 v99, v102, v103
  s_waitcnt lgkmcnt(4)
  v_mfma_f32_32x32x16_bf16 v[112:127], v[204:207], v[48:51], v[112:127]
  ds_read_b128 v[40:43], v70 offset:25600
  buffer_store_dwordx4 v[96:99], v2, s[4:7], s58 offen sc1
  v_mfma_f32_32x32x16_bf16 v[112:127], v[208:211], v[52:55], v[112:127]
  ds_read_b128 v[44:47], v70 offset:26624
  v_mul_f32 v104, v68, v104
  v_mul_f32 v105, v68, v105
  v_mul_f32 v106, v68, v106
  v_mul_f32 v107, v68, v107
  v_mul_f32 v108, v68, v108
  v_mul_f32 v109, v68, v109
  s_waitcnt lgkmcnt(4)
  v_mfma_f32_32x32x16_bf16 v[112:127], v[212:215], v[56:59], v[112:127]
  ds_read_b128 v[48:51], v70 offset:27648
  v_mul_f32 v110, v68, v110
  v_mul_f32 v111, v68, v111
  v_cvt_pk_bf16_f32 v104, v104, v105
  v_cvt_pk_bf16_f32 v105, v106, v107
  v_cvt_pk_bf16_f32 v106, v108, v109
  v_cvt_pk_bf16_f32 v107, v110, v111
  v_mfma_f32_32x32x16_bf16 v[112:127], v[216:219], v[60:63], v[112:127]
  ds_read_b128 v[52:55], v70 offset:28672
  buffer_store_dwordx4 v[104:107], v2, s[4:7], s59 offen sc1
  s_waitcnt lgkmcnt(4)
  v_mfma_f32_32x32x16_bf16 v[112:127], v[220:223], v[32:35], v[112:127]
  ds_read_b128 v[56:59], v70 offset:29696
  v_mfma_f32_32x32x16_bf16 v[112:127], v[224:227], v[36:39], v[112:127]
  ds_read_b128 v[60:63], v70 offset:30720
  s_waitcnt lgkmcnt(4)
  v_mfma_f32_32x32x16_bf16 v[112:127], v[228:231], v[40:43], v[112:127]
  ds_read_b128 v[32:35], v70 offset:31744
  v_mfma_f32_32x32x16_bf16 v[112:127], v[232:235], v[44:47], v[112:127]
  ds_read_b128 v[36:39], v70 offset:32768
  s_waitcnt lgkmcnt(4)
  v_mfma_f32_32x32x16_bf16 v[112:127], v[236:239], v[48:51], v[112:127]
  v_mov_b32 v66, 157696
  s_mov_b32 s51, 0
qspin_2:
  ds_read_b32 v67, v66 offset:8
  s_add_u32 s51, s51, 1
  s_waitcnt lgkmcnt(0)
  v_readfirstlane_b32 s52, v67
  s_cmp_ge_u32 s52, 2
  s_cbranch_scc1 qok_3
  s_cmp_lt_u32 s51, 16777216
  s_cbranch_scc1 qspin_2
qok_3:
  ds_read_b128 v[40:43], v71 offset:0
  v_mfma_f32_32x32x16_bf16 v[112:127], v[240:243], v[52:55], v[112:127]
  ds_read_b128 v[44:47], v71 offset:1024
  s_waitcnt lgkmcnt(4)
  v_mfma_f32_32x32x16_bf16 v[112:127], v[244:247], v[56:59], v[112:127]
  ds_read_b128 v[48:51], v71 offset:2048
  v_mfma_f32_32x32x16_bf16 v[112:127], v[248:251], v[60:63], v[112:127]
  ds_read_b128 v[52:55], v71 offset:3072
  s_waitcnt lgkmcnt(4)
  v_mfma_f32_32x32x16_bf16 v[112:127], v[252:255], v[32:35], v[112:127]
  ds_read_b128 v[56:59], v71 offset:4096
  v_mfma_f32_32x32x16_bf16 v[112:127], v[72:75], v[36:39], v[112:127]
  ds_read_b128 v[60:63], v71 offset:5120
  s_waitcnt lgkmcnt(4)
  v_mfma_f32_32x32x16_bf16 v[80:95], v[40:43], v[128:131], 0
  ds_read_b128 v[32:35], v71 offset:6144
  v_mfma_f32_32x32x16_bf16 v[80:95], v[44:47], v[132:135], v[80:95]
  ds_read_b128 v[36:39], v71 offset:7168
  s_waitcnt lgkmcnt(4)
  v_mfma_f32_32x32x16_bf16 v[80:95], v[48:51], v[136:139], v[80:95]
  ds_read_b128 v[40:43], v71 offset:8192
  s_nop 2
  v_mul_f32 v112, v16, v112
  v_mul_f32 v113, v17, v113
  v_mul_f32 v114, v18, v114
  v_mul_f32 v115, v19, v115
  v_mul_f32 v116, v20, v116
  v_mul_f32 v117, v21, v117
  v_mfma_f32_32x32x16_bf16 v[80:95], v[52:55], v[140:143], v[80:95]
  ds_read_b128 v[44:47], v71 offset:9216
  v_mul_f32 v118, v22, v118
  v_mul_f32 v119, v23, v119
  v_cvt_pk_bf16_f32 v112, v112, v113
  v_cvt_pk_bf16_f32 v113, v114, v115
  v_cvt_pk_bf16_f32 v114, v116, v117
  v_cvt_pk_bf16_f32 v115, v118, v119
  s_waitcnt lgkmcnt(4)
  v_mfma_f32_32x32x16_bf16 v[80:95], v[56:59], v[144:147], v[80:95]
  ds_read_b128 v[48:51], v71 offset:10240
  buffer_store_dwordx4 v[112:115], v78, s[4:7], s54 offen offset:0 sc1
  v_mfma_f32_32x32x16_bf16 v[80:95], v[60:63], v[148:151], v[80:95]
  ds_read_b128 v[52:55], v71 offset:11264
  v_mul_f32 v120, v24, v120
  v_mul_f32 v121, v25, v121
  v_mul_f32 v122, v26, v122
  v_mul_f32 v123, v27, v123
  v_mul_f32 v124, v28, v124
  v_mul_f32 v125, v29, v125
  s_waitcnt lgkmcnt(4)
  v_mfma_f32_32x32x16_bf16 v[80:95], v[32:35], v[152:155], v[80:95]
  ds_read_b128 v[56:59], v71 offset:12288
  v_mul_f32 v126, v30, v126
  v_mul_f32 v127, v31, v127
  v_cvt_pk_bf16_f32 v120, v120, v121
  v_cvt_pk_bf16_f32 v121, v122, v123
  v_cvt_pk_bf16_f32 v122, v124, v125
  v_cvt_pk_bf16_f32 v123, v126, v127
  v_mfma_f32_32x32x16_bf16 v[80:95], v[36:39], v[156:159], v[80:95]
  ds_read_b128 v[60:63], v71 offset:13312
  buffer_store_dwordx4 v[120:123], v78, s[4:7], s54 offen offset:512 sc1
  s_waitcnt lgkmcnt(4)
  v_mfma_f32_32x32x16_bf16 v[80:95], v[40:43], v[160:163], v[80:95]
  ds_read_b128 v[32:35], v71 offset:14336
  v_mfma_f32_32x32x16_bf16 v[80:95], v[44:47], v[164:167], v[80:95]
  ds_read_b128 v[36:39], v71 offset:15360
  s_waitcnt lgkmcnt(4)
  v_mfma_f32_32x32x16_bf16 v[80:95], v[48:51], v[168:171], v[80:95]
  ds_read_b128 v[40:43], v71 offset:16384
  v_mfma_f32_32x32x16_bf16 v[80:95], v[52:55], v[172:175], v[80:95]
  ds_read_b128 v[44:47], v71 offset:17408
  s_waitcnt lgkmcnt(4)
  v_mfma_f32_32x32x16_bf16 v[80:95], v[56:59], v[176:179], v[80:95]
  ds_read_b128 v[48:51], v71 offset:18432
  v_mfma_f32_32x32x16_bf16 v[80:95], v[60:63], v[180:183], v[80:95]
  ds_read_b128 v[52:55], v71 offset:19456
  s_waitcnt lgkmcnt(4)
  v_mfma_f32_32x32x16_bf16 v[80:95], v[32:35], v[184:187], v[80:95]
  ds_read_b128 v[56:59], v71 offset:20480
  v_mfma_f32_32x32x16_bf16 v[80:95], v[36:39], v[188:191], v[80:95]
  ds_read_b128 v[60:63], v71 offset:21504
  s_waitcnt lgkmcnt(4)
  v_mfma_f32_32x32x16_bf16 v[80:95], v[40:43], v[192:195], v[80:95]
  ds_read_b128 v[32:35], v71 offset:22528
  v_mfma_f32_32x32x16_bf16 v[80:95], v[44:47], v[196:199], v[80:95]
  ds_read_b128 v[36:39], v71 offset:23552
  s_waitcnt lgkmcnt(4)
  v_mfma_f32_32x32x16_bf16 v[80:95], v[48:51], v[200:203], v[80:95]
  ds_read_b128 v[40:43], v71 offset:24576
  v_mfma_f32_32x32x16_bf16 v[80:95], v[52:55], v[204:207], v[80:95]
  ds_read_b128 v[44:47], v71 offset:25600
  s_waitcnt lgkmcnt(4)
  v_mfma_f32_32x32x16_bf16 v[80:95], v[56:59], v[208:211], v[80:95]
  ds_read_b128 v[48:51], v71 offset:26624
  v_mfma_f32_32x32x16_bf16 v[80:95], v[60:63], v[212:215], v[80:95]
  ds_read_b128 v[52:55], v71 offset:27648
  s_waitcnt lgkmcnt(4)
  v_mfma_f32_32x32x16_bf16 v[80:95], v[32:35], v[216:219], v[80:95]
  ds_read_b128 v[56:59], v71 offset:28672
  v_mfma_f32_32x32x16_bf16 v[80:95], v[36:39], v[220:223], v[80:95]
  ds_read_b128 v[60:63], v71 offset:29696
  s_waitcnt lgkmcnt(4)
  v_mfma_f32_32x32x16_bf16 v[80:95], v[40:43], v[224:227], v[80:95]
  ds_read_b128 v[32:35], v71 offset:30720
  v_mfma_f32_32x32x16_bf16 v[80:95], v[44:47], v[228:231], v[80:95]
  ds_read_b128 v[36:39], v71 offset:31744
  s_waitcnt lgkmcnt(4)
  v_mfma_f32_32x32x16_bf16 v[80:95], v[48:51], v[232:235], v[80:95]
  ds_read_b128 v[40:43], v71 offset:32768
  v_mfma_f32_32x32x16_bf16 v[80:95], v[52:55], v[236:239], v[80:95]
  s_waitcnt lgkmcnt(3)
  v_mfma_f32_32x32x16_bf16 v[80:95], v[56:59], v[240:243], v[80:95]
  v_mfma_f32_32x32x16_bf16 v[80:95], v[60:63], v[244:247], v[80:95]
  s_waitcnt lgkmcnt(1)
  v_mfma_f32_32x32x16_bf16 v[80:95], v[32:35], v[248:251], v[80:95]
  v_mfma_f32_32x32x16_bf16 v[80:95], v[36:39], v[252:255], v[80:95]
  s_waitcnt lgkmcnt(0)
  v_mfma_f32_32x32x16_bf16 v[80:95], v[40:43], v[72:75], v[80:95]
  s_nop 11
  v_pk_mul_f32 v[80:81], v[80:81], v[68:69] op_sel:[0,1] op_sel_hi:[1,1]
  v_pk_mul_f32 v[82:83], v[82:83], v[68:69] op_sel:[0,1] op_sel_hi:[1,1]
  v_pk_mul_f32 v[84:85], v[84:85], v[68:69] op_sel:[0,1] op_sel_hi:[1,1]
  v_pk_mul_f32 v[86:87], v[86:87], v[68:69] op_sel:[0,1] op_sel_hi:[1,1]
  v_cvt_pk_bf16_f32 v80, v80, v81
  v_cvt_pk_bf16_f32 v81, v82, v83
  v_cvt_pk_bf16_f32 v82, v84, v85
  v_cvt_pk_bf16_f32 v83, v86, v87
  buffer_store_dwordx4 v[80:83], v2, s[4:7], s56 offen sc1
  v_pk_mul_f32 v[88:89], v[88:89], v[68:69] op_sel:[0,1] op_sel_hi:[1,1]
  v_pk_mul_f32 v[90:91], v[90:91], v[68:69] op_sel:[0,1] op_sel_hi:[1,1]
  v_pk_mul_f32 v[92:93], v[92:93], v[68:69] op_sel:[0,1] op_sel_hi:[1,1]
  v_pk_mul_f32 v[94:95], v[94:95], v[68:69] op_sel:[0,1] op_sel_hi:[1,1]
  v_cvt_pk_bf16_f32 v88, v88, v89
  v_cvt_pk_bf16_f32 v89, v90, v91
  v_cvt_pk_bf16_f32 v90, v92, v93
  v_cvt_pk_bf16_f32 v91, v94, v95
  buffer_store_dwordx4 v[88:91], v2, s[4:7], s57 offen sc1
  s_lshl_b32 s42, s34, 8
  s_add_u32 s42, s42, s28
  s_add_u32 s42, s42, 0
  s_mov_b32 s69, -1
  s_mov_b32 s97, 0
  s_mov_b32 s41, 1
main_attpre:
  v_and_b32 v4, 27, v1
  v_cmp_eq_u32 vcc, 16, v4
  v_mov_b32 v5, 0x3f803f80
  s_nop 0
  v_cndmask_b32 v96, 0, v5, vcc
  v_cndmask_b32 v97, 0, v5, vcc
  v_pk_mov_b32 v[98:99], v[96:97], v[96:97]
  v_pk_mov_b32 v[100:101], v[96:97], v[96:97]
  v_pk_mov_b32 v[102:103], v[96:97], v[96:97]
  v_pk_mov_b32 v[104:105], v[96:97], v[96:97]
  v_pk_mov_b32 v[106:107], v[96:97], v[96:97]
  v_pk_mov_b32 v[108:109], v[96:97], v[96:97]
  v_pk_mov_b32 v[110:111], v[96:97], v[96:97]
  v_pk_mov_b32 v[112:113], v[96:97], v[96:97]
  v_pk_mov_b32 v[114:115], v[96:97], v[96:97]
  v_pk_mov_b32 v[116:117], v[96:97], v[96:97]
  v_pk_mov_b32 v[118:119], v[96:97], v[96:97]
  v_pk_mov_b32 v[120:121], v[96:97], v[96:97]
  v_pk_mov_b32 v[122:123], v[96:97], v[96:97]
  v_pk_mov_b32 v[124:125], v[96:97], v[96:97]
  v_pk_mov_b32 v[126:127], v[96:97], v[96:97]
  v_pk_mov_b32 v[128:129], v[96:97], v[96:97]
  v_pk_mov_b32 v[130:131], v[96:97], v[96:97]
  v_pk_mov_b32 v[132:133], v[96:97], v[96:97]
  v_pk_mov_b32 v[134:135], v[96:97], v[96:97]
  v_pk_mov_b32 v[136:137], v[96:97], v[96:97]
  v_pk_mov_b32 v[138:139], v[96:97], v[96:97]
  v_pk_mov_b32 v[140:141], v[96:97], v[96:97]
  v_pk_mov_b32 v[142:143], v[96:97], v[96:97]
  v_pk_mov_b32 v[144:145], v[96:97], v[96:97]
  v_pk_mov_b32 v[146:147], v[96:97], v[96:97]
  v_pk_mov_b32 v[148:149], v[96:97], v[96:97]
  v_pk_mov_b32 v[150:151], v[96:97], v[96:97]
  v_pk_mov_b32 v[152:153], v[96:97], v[96:97]
  v_pk_mov_b32 v[154:155], v[96:97], v[96:97]
  v_pk_mov_b32 v[156:157], v[96:97], v[96:97]
  v_pk_mov_b32 v[158:159], v[96:97], v[96:97]
  v_pk_mov_b32 v[160:161], v[96:97], v[96:97]
  v_pk_mov_b32 v[162:163], v[96:97], v[96:97]
  v_pk_mov_b32 v[164:165], v[96:97], v[96:97]
  v_pk_mov_b32 v[166:167], v[96:97], v[96:97]
  v_pk_mov_b32 v[168:169], v[96:97], v[96:97]
  v_pk_mov_b32 v[170:171], v[96:97], v[96:97]
  v_pk_mov_b32 v[172:173], v[96:97], v[96:97]
  v_pk_mov_b32 v[174:175], v[96:97], v[96:97]
  v_pk_mov_b32 v[176:177], v[96:97], v[96:97]
  v_pk_mov_b32 v[178:179], v[96:97], v[96:97]
  v_pk_mov_b32 v[180:181], v[96:97], v[96:97]
  v_pk_mov_b32 v[182:183], v[96:97], v[96:97]
  v_pk_mov_b32 v[184:185], v[96:97], v[96:97]
  v_pk_mov_b32 v[186:187], v[96:97], v[96:97]
  v_pk_mov_b32 v[188:189], v[96:97], v[96:97]
  v_pk_mov_b32 v[190:191], v[96:97], v[96:97]
  v_pk_mov_b32 v[192:193], v[96:97], v[96:97]
  v_pk_mov_b32 v[194:195], v[96:97], v[96:97]
  v_pk_mov_b32 v[196:197], v[96:97], v[96:97]
  v_pk_mov_b32 v[198:199], v[96:97], v[96:97]
  v_pk_mov_b32 v[200:201], v[96:97], v[96:97]
  v_pk_mov_b32 v[202:203], v[96:97], v[96:97]
  v_pk_mov_b32 v[204:205], v[96:97], v[96:97]
  v_pk_mov_b32 v[206:207], v[96:97], v[96:97]
  v_pk_mov_b32 v[208:209], v[96:97], v[96:97]
  v_pk_mov_b32 v[210:211], v[96:97], v[96:97]
  v_pk_mov_b32 v[212:213], v[96:97], v[96:97]
  v_pk_mov_b32 v[214:215], v[96:97], v[96:97]
  v_pk_mov_b32 v[216:217], v[96:97], v[96:97]
  v_pk_mov_b32 v[218:219], v[96:97], v[96:97]
  v_pk_mov_b32 v[220:221], v[96:97], v[96:97]
  v_pk_mov_b32 v[222:223], v[96:97], v[96:97]
main_attpre2:
  v_and_b32 v5, 15, v1
  v_lshlrev_b32 v5, 4, v5
  v_lshrrev_b32 v6, 5, v1
  v_lshl_add_u32 v6, v6, 8, v5
  s_lshl_b32 s44, s24, 16
  s_add_u32 s44, s44, s27
  s_lshl_b32 s45, s12, 14
  s_add_u32 s45, s45, s44
  s_add_u32 s46, s45, 4194304
  s_add_u32 s47, s45, 8388608
  s_lshl_b32 s48, s25, 13
  s_add_u32 s48, s48, s44
  s_add_u32 s49, s48, 1024
  s_add_u32 s53, s12, 1
  s_and_b32 s53, s53, 3
  s_lshl_b32 s53, s53, 11
  s_add_u32 s53, s53, s48
  s_add_u32 s54, s12, 2
  s_and_b32 s54, s54, 3
  s_lshl_b32 s54, s54, 11
  s_add_u32 s54, s54, s48
  s_lshl_b32 s39, s25, 2
  s_add_u32 s39, s39, s12
  s_lshl_b32 s39, s39, 16
  s_lshl_b32 s55, s24, 10
  s_add_u32 s39, s39, s55
  s_add_u32 s39, s39, s27
  s_add_u32 s39, s39, 12582912
  s_mov_b32 s56, 0x12800000
  s_mov_b32 s57, 0x7b800000
  s_mov_b32 s40, 0
  s_add_u32 s76, s46, 0
  s_add_u32 s80, s47, 0
  s_add_u32 s77, s46, 4096
  s_add_u32 s81, s47, 4096
  s_add_u32 s78, s46, 8192
  s_add_u32 s82, s47, 8192
  s_add_u32 s79, s46, 12288
  s_add_u32 s83, s47, 12288
  s_cmp_eq_u32 s26, 1
  s_cbranch_scc1 main_nores
  s_waitcnt vmcnt(0)
  v_permlane32_swap_b32 v8, v10
  v_permlane32_swap_b32 v9, v11
  v_permlane32_swap_b32 v12, v14
  v_permlane32_swap_b32 v13, v15
main_nores:
  s_cmp_ge_u32 s12, 2
  s_cbranch_scc1 main_att_bar
  s_cmp_lg_u32 s41, 1
  s_cbranch_scc1 sge_4
  s_waitcnt vmcnt(0)
  s_mov_b64 exec, 1
  v_mov_b32 v0, 1
  s_cmp_eq_u32 s69, -1
  s_cbranch_scc0 sa_5
  s_mov_b64 exec, s[94:95]
  v_mov_b32 v0, 1
  buffer_store_dword v0, v3, s[4:7], s42 offen sc1
  s_branch sb_6
sa_5:
  buffer_atomic_add v0, v3, s[4:7], s42 offen sc0 sc1
sb_6:
  s_mov_b64 exec, -1
  s_mov_b32 s41, s97
sge_4:
  s_cmp_lg_u32 s41, 2
  s_cbranch_scc1 sge_7
  s_waitcnt vmcnt(0)
  v_readfirstlane_b32 s52, v0
  s_cmp_lg_u32 s52, s69
  s_cbranch_scc1 notlast_8
  s_mov_b64 exec, 1
  v_mov_b32 v0, 1
  buffer_store_dword v0, v3, s[4:7], s42 offen offset:256 sc1
  s_mov_b64 exec, -1
notlast_8:
  s_mov_b32 s41, 0
sge_7:
  s_lshl_b32 s50, s35, 8
  s_add_u32 s50, s50, s28
  s_add_u32 s50, s50, 0
  v_lshlrev_b32 v4, 9, v1
  s_mov_b32 s51, 0
poll_10:
  s_mov_b64 exec, s[94:95]
  buffer_load_dword v5, v4, s[4:7], s50 offen offset:0 sc1
  s_mov_b64 exec, -1
  s_add_u32 s51, s51, 1
  s_waitcnt vmcnt(0)
  s_mov_b64 exec, s[94:95]
  v_cmp_ne_u32 vcc, 1, v5
  s_mov_b64 exec, -1
  s_cmp_eq_u64 vcc, 0
  s_cbranch_scc1 go_9
  s_cmp_lt_u32 s51, 2097152
  s_cbranch_scc1 poll_10
go_9:
main_att_bar:
  s_barrier
main_att_go:
  buffer_load_dwordx4 v[88:91], v2, s[4:7], s53 offen sc1
  buffer_load_dwordx4 v[224:227], v2, s[4:7], s76 offen offset:0 sc1
  buffer_load_dwordx4 v[232:235], v2, s[4:7], s76 offen offset:2048 sc1
  s_mov_b64 exec, s[30:31]
  buffer_load_dwordx4 v[96:99], v6, s[4:7], s80 offen offset:0 sc1
  buffer_load_dwordx4 v[100:103], v6, s[4:7], s80 offen offset:512 sc1
  s_mov_b64 exec, -1
  s_cmp_lg_u32 s41, 1
  s_cbranch_scc1 sge_11
  s_waitcnt vmcnt(5)
  s_mov_b64 exec, 1
  v_mov_b32 v0, 1
  s_cmp_eq_u32 s69, -1
  s_cbranch_scc0 sa_12
  s_mov_b64 exec, s[94:95]
  v_mov_b32 v0, 1
  buffer_store_dword v0, v3, s[4:7], s42 offen sc1
  s_branch sb_13
sa_12:
  buffer_atomic_add v0, v3, s[4:7], s42 offen sc0 sc1
sb_13:
  s_mov_b64 exec, -1
  s_mov_b32 s41, s97
sge_11:
  buffer_load_dwordx4 a[208:211], v2, s[4:7], s77 offen offset:0 sc1
  s_mov_b64 exec, s[30:31]
  buffer_load_dwordx4 v[112:115], v6, s[4:7], s80 offen offset:2048 sc1
  buffer_load_dwordx4 v[116:119], v6, s[4:7], s80 offen offset:2560 sc1
  s_mov_b64 exec, -1
  buffer_load_dwordx4 a[216:219], v2, s[4:7], s77 offen offset:2048 sc1
  s_mov_b64 exec, s[30:31]
  buffer_load_dwordx4 v[128:131], v6, s[4:7], s81 offen offset:0 sc1
  buffer_load_dwordx4 v[132:135], v6, s[4:7], s81 offen offset:512 sc1
  s_mov_b64 exec, -1
  s_waitcnt vmcnt(9)
  v_mfma_f32_32x32x16_bf16 v[16:31], v[224:227], v[88:91], 0
  buffer_load_dwordx4 a[224:227], v2, s[4:7], s78 offen offset:0 sc1
  s_mov_b64 exec, s[30:31]
  buffer_load_dwordx4 v[144:147], v6, s[4:7], s81 offen offset:2048 sc1
  buffer_load_dwordx4 v[148:151], v6, s[4:7], s81 offen offset:2560 sc1
  s_mov_b64 exec, -1
  s_waitcnt vmcnt(11)
  v_mfma_f32_32x32x16_bf16 v[32:47], v[232:235], v[88:91], 0
  buffer_load_dwordx4 a[232:235], v2, s[4:7], s78 offen offset:2048 sc1
  s_mov_b64 exec, s[30:31]
  buffer_load_dwordx4 v[160:163], v6, s[4:7], s82 offen offset:0 sc1
  buffer_load_dwordx4 v[164:167], v6, s[4:7], s82 offen offset:512 sc1
  s_mov_b64 exec, -1
  v_exp_f32 v16, v16
  v_exp_f32 v17, v17
  v_exp_f32 v18, v18
  v_exp_f32 v19, v19
  v_cvt_pk_bf16_f32 v48, v16, v17
  v_cvt_pk_bf16_f32 v49, v18, v19
  v_exp_f32 v20, v20
  v_exp_f32 v21, v21
  v_exp_f32 v22, v22
  v_exp_f32 v23, v23
  v_cvt_pk_bf16_f32 v50, v20, v21
  v_cvt_pk_bf16_f32 v51, v22, v23
  v_exp_f32 v24, v24
  v_exp_f32 v25, v25
  v_exp_f32 v26, v26
  s_waitcnt vmcnt(12)
  v_mfma_f32_32x32x16_bf16 v[56:71], v[96:99], v[48:51], 0
  v_exp_f32 v27, v27
  v_cvt_pk_bf16_f32 v52, v24, v25
  v_cvt_pk_bf16_f32 v53, v26, v27
  v_exp_f32 v28, v28
  v_exp_f32 v29, v29
  v_exp_f32 v30, v30
  v_exp_f32 v31, v31
  v_cvt_pk_bf16_f32 v54, v28, v29
  v_cvt_pk_bf16_f32 v55, v30, v31
  s_waitcnt vmcnt(11)
  v_mfma_f32_32x32x16_bf16 v[16:31], a[208:211], v[88:91], 0
  buffer_load_dwordx4 a[240:243], v2, s[4:7], s79 offen offset:0 sc1
  s_mov_b64 exec, s[30:31]
  buffer_load_dwordx4 v[176:179], v6, s[4:7], s82 offen offset:2048 sc1
  buffer_load_dwordx4 v[180:183], v6, s[4:7], s82 offen offset:2560 sc1
  s_mov_b64 exec, -1
  v_exp_f32 v32, v32
  v_exp_f32 v33, v33
  v_exp_f32 v34, v34
  v_exp_f32 v35, v35
  v_cvt_pk_bf16_f32 v48, v32, v33
  v_cvt_pk_bf16_f32 v49, v34, v35
  v_exp_f32 v36, v36
  v_mfma_f32_32x32x16_bf16 v[56:71], v[100:103], v[52:55], v[56:71]
  v_exp_f32 v37, v37
  v_exp_f32 v38, v38
  v_exp_f32 v39, v39
  v_cvt_pk_bf16_f32 v50, v36, v37
  v_cvt_pk_bf16_f32 v51, v38, v39
  v_exp_f32 v40, v40
  v_exp_f32 v41, v41
  v_exp_f32 v42, v42
  s_waitcnt vmcnt(12)
  v_mfma_f32_32x32x16_bf16 v[56:71], v[112:115], v[48:51], v[56:71]
  v_exp_f32 v43, v43
  v_cvt_pk_bf16_f32 v52, v40, v41
  v_cvt_pk_bf16_f32 v53, v42, v43
  v_exp_f32 v44, v44
  v_exp_f32 v45, v45
  v_exp_f32 v46, v46
  v_exp_f32 v47, v47
  v_cvt_pk_bf16_f32 v54, v44, v45
  v_cvt_pk_bf16_f32 v55, v46, v47
  s_waitcnt vmcnt(11)
  v_mfma_f32_32x32x16_bf16 v[32:47], a[216:219], v[88:91], 0
  s_cmp_lg_u32 s41, 2
  s_cbranch_scc1 sge_14
  s_waitcnt vmcnt(15)
  v_readfirstlane_b32 s52, v0
  s_cmp_lg_u32 s52, s69
  s_cbranch_scc1 notlast_15
  s_mov_b64 exec, 1
  v_mov_b32 v0, 1
  buffer_store_dword v0, v3, s[4:7], s42 offen offset:256 sc1
  s_mov_b64 exec, -1
notlast_15:
  s_mov_b32 s41, 0
sge_14:
  buffer_load_dwordx4 a[248:251], v2, s[4:7], s79 offen offset:2048 sc1
  s_mov_b64 exec, s[30:31]
  buffer_load_dwordx4 v[192:195], v6, s[4:7], s83 offen offset:0 sc1
  buffer_load_dwordx4 v[196:199], v6, s[4:7], s83 offen offset:512 sc1
  s_mov_b64 exec, -1
  v_exp_f32 v16, v16
  v_exp_f32 v17, v17
  v_exp_f32 v18, v18
  v_exp_f32 v19, v19
  v_cvt_pk_bf16_f32 v48, v16, v17
  v_cvt_pk_bf16_f32 v49, v18, v19
  v_exp_f32 v20, v20
  v_mfma_f32_32x32x16_bf16 v[56:71], v[116:119], v[52:55], v[56:71]
  v_exp_f32 v21, v21
  v_exp_f32 v22, v22
  v_exp_f32 v23, v23
  v_cvt_pk_bf16_f32 v50, v20, v21
  v_cvt_pk_bf16_f32 v51, v22, v23
  v_exp_f32 v24, v24
  v_exp_f32 v25, v25
  v_exp_f32 v26, v26
  s_waitcnt vmcnt(12)
  v_mfma_f32_32x32x16_bf16 v[56:71], v[128:131], v[48:51], v[56:71]
  v_exp_f32 v27, v27
  v_cvt_pk_bf16_f32 v52, v24, v25
  v_cvt_pk_bf16_f32 v53, v26, v27
  v_exp_f32 v28, v28
  v_exp_f32 v29, v29
  v_exp_f32 v30, v30
  v_exp_f32 v31, v31
  v_cvt_pk_bf16_f32 v54, v28, v29
  v_cvt_pk_bf16_f32 v55, v30, v31
  s_waitcnt vmcnt(11)
  v_mfma_f32_32x32x16_bf16 v[16:31], a[224:227], v[88:91], 0
  buffer_load_dwordx4 v[92:95], v2, s[4:7], s54 offen sc1
  s_mov_b64 exec, s[30:31]
  buffer_load_dwordx4 v[208:211], v6, s[4:7], s83 offen offset:2048 sc1
  buffer_load_dwordx4 v[212:215], v6, s[4:7], s83 offen offset:2560 sc1
  s_mov_b64 exec, -1
  v_exp_f32 v32, v32
  v_exp_f32 v33, v33
  v_exp_f32 v34, v34
  v_exp_f32 v35, v35
  v_cvt_pk_bf16_f32 v48, v32, v33
  v_cvt_pk_bf16_f32 v49, v34, v35
  v_exp_f32 v36, v36
  v_mfma_f32_32x32x16_bf16 v[56:71], v[132:135], v[52:55], v[56:71]
  v_exp_f32 v37, v37
  v_exp_f32 v38, v38
  v_exp_f32 v39, v39
  v_cvt_pk_bf16_f32 v50, v36, v37
  v_cvt_pk_bf16_f32 v51, v38, v39
  v_exp_f32 v40, v40
  v_exp_f32 v41, v41
  v_exp_f32 v42, v42
  s_waitcnt vmcnt(12)
  v_mfma_f32_32x32x16_bf16 v[56:71], v[144:147], v[48:51], v[56:71]
  v_exp_f32 v43, v43
  v_cvt_pk_bf16_f32 v52, v40, v41
  v_cvt_pk_bf16_f32 v53, v42, v43
  v_exp_f32 v44, v44
  v_exp_f32 v45, v45
  v_exp_f32 v46, v46
  v_exp_f32 v47, v47
  v_cvt_pk_bf16_f32 v54, v44, v45
  v_cvt_pk_bf16_f32 v55, v46, v47
  s_waitcnt vmcnt(11)
  v_mfma_f32_32x32x16_bf16 v[32:47], a[232:235], v[88:91], 0
  v_exp_f32 v16, v16
  v_exp_f32 v17, v17
  v_exp_f32 v18, v18
  v_exp_f32 v19, v19
  v_cvt_pk_bf16_f32 v48, v16, v17
  v_cvt_pk_bf16_f32 v49, v18, v19
  v_exp_f32 v20, v20
  v_mfma_f32_32x32x16_bf16 v[56:71], v[148:151], v[52:55], v[56:71]
  v_exp_f32 v21, v21
  v_exp_f32 v22, v22
  v_exp_f32 v23, v23
  v_cvt_pk_bf16_f32 v50, v20, v21
  v_cvt_pk_bf16_f32 v51, v22, v23
  v_exp_f32 v24, v24
  v_exp_f32 v25, v25
  v_exp_f32 v26, v26
  s_waitcnt vmcnt(9)
  v_mfma_f32_32x32x16_bf16 v[56:71], v[160:163], v[48:51], v[56:71]
  v_exp_f32 v27, v27
  v_cvt_pk_bf16_f32 v52, v24, v25
  v_cvt_pk_bf16_f32 v53, v26, v27
  v_exp_f32 v28, v28
  v_exp_f32 v29, v29
  v_exp_f32 v30, v30
  v_exp_f32 v31, v31
  v_cvt_pk_bf16_f32 v54, v28, v29
  v_cvt_pk_bf16_f32 v55, v30, v31
  s_waitcnt vmcnt(8)
  v_mfma_f32_32x32x16_bf16 v[16:31], a[240:243], v[88:91], 0
  v_exp_f32 v32, v32
  v_exp_f32 v33, v33
  v_exp_f32 v34, v34
  v_exp_f32 v35, v35
  v_cvt_pk_bf16_f32 v48, v32, v33
  v_cvt_pk_bf16_f32 v49, v34, v35
  v_exp_f32 v36, v36
  v_mfma_f32_32x32x16_bf16 v[56:71], v[164:167], v[52:55], v[56:71]
  v_exp_f32 v37, v37
  v_exp_f32 v38, v38
  v_exp_f32 v39, v39
  v_cvt_pk_bf16_f32 v50, v36, v37
  v_cvt_pk_bf16_f32 v51, v38, v39
  v_exp_f32 v40, v40
  v_exp_f32 v41, v41
  v_exp_f32 v42, v42
  s_waitcnt vmcnt(6)
  v_mfma_f32_32x32x16_bf16 v[56:71], v[176:179], v[48:51], v[56:71]
  v_exp_f32 v43, v43
  v_cvt_pk_bf16_f32 v52, v40, v41
  v_cvt_pk_bf16_f32 v53, v42, v43
  v_exp_f32 v44, v44
  v_exp_f32 v45, v45
  v_exp_f32 v46, v46
  v_exp_f32 v47, v47
  v_cvt_pk_bf16_f32 v54, v44, v45
  v_cvt_pk_bf16_f32 v55, v46, v47
  s_waitcnt vmcnt(5)
  v_mfma_f32_32x32x16_bf16 v[32:47], a[248:251], v[88:91], 0
  s_lshl_b32 s50, s35, 8
  s_add_u32 s50, s50, s28
  s_add_u32 s50, s50, 256
  v_lshlrev_b32 v4, 9, v1
  s_mov_b64 exec, s[94:95]
  buffer_load_dword v5, v4, s[4:7], s50 offen offset:0 sc1
  s_mov_b64 exec, -1
  v_exp_f32 v16, v16
  v_exp_f32 v17, v17
  v_exp_f32 v18, v18
  v_exp_f32 v19, v19
  v_cvt_pk_bf16_f32 v48, v16, v17
  v_cvt_pk_bf16_f32 v49, v18, v19
  v_exp_f32 v20, v20
  v_mfma_f32_32x32x16_bf16 v[56:71], v[180:183], v[52:55], v[56:71]
  v_exp_f32 v21, v21
  v_exp_f32 v22, v22
  v_exp_f32 v23, v23
  v_cvt_pk_bf16_f32 v50, v20, v21
  v_cvt_pk_bf16_f32 v51, v22, v23
  v_exp_f32 v24, v24
  v_exp_f32 v25, v25
  v_exp_f32 v26, v26
  s_waitcnt vmcnt(4)
  v_mfma_f32_32x32x16_bf16 v[56:71], v[192:195], v[48:51], v[56:71]
  v_exp_f32 v27, v27
  v_cvt_pk_bf16_f32 v52, v24, v25
  v_cvt_pk_bf16_f32 v53, v26, v27
  v_exp_f32 v28, v28
  v_exp_f32 v29, v29
  v_exp_f32 v30, v30
  v_exp_f32 v31, v31
  v_cvt_pk_bf16_f32 v54, v28, v29
  v_cvt_pk_bf16_f32 v55, v30, v31
  s_waitcnt vmcnt(3)
  v_mfma_f32_32x32x16_bf16 v[16:31], v[224:227], v[92:95], 0
  v_exp_f32 v32, v32
  v_exp_f32 v33, v33
  v_exp_f32 v34, v34
  v_exp_f32 v35, v35
  v_cvt_pk_bf16_f32 v48, v32, v33
  v_cvt_pk_bf16_f32 v49, v34, v35
  v_exp_f32 v36, v36
  v_mfma_f32_32x32x16_bf16 v[56:71], v[196:199], v[52:55], v[56:71]
  v_exp_f32 v37, v37
  v_exp_f32 v38, v38
  v_exp_f32 v39, v39
  v_cvt_pk_bf16_f32 v50, v36, v37
  v_cvt_pk_bf16_f32 v51, v38, v39
  v_exp_f32 v40, v40
  v_exp_f32 v41, v41
  v_exp_f32 v42, v42
  s_waitcnt vmcnt(1)
  v_mfma_f32_32x32x16_bf16 v[56:71], v[208:211], v[48:51], v[56:71]
  v_exp_f32 v43, v43
  v_cvt_pk_bf16_f32 v52, v40, v41
  v_cvt_pk_bf16_f32 v53, v42, v43
  v_exp_f32 v44, v44
  v_exp_f32 v45, v45
  v_exp_f32 v46, v46
  v_exp_f32 v47, v47
  v_cvt_pk_bf16_f32 v54, v44, v45
  v_cvt_pk_bf16_f32 v55, v46, v47
  v_mfma_f32_32x32x16_bf16 v[32:47], v[232:235], v[92:95], 0
  v_exp_f32 v16, v16
  v_exp_f32 v17, v17
  v_exp_f32 v18, v18
  v_exp_f32 v19, v19
  v_cvt_pk_bf16_f32 v48, v16, v17
  v_cvt_pk_bf16_f32 v49, v18, v19
  v_exp_f32 v20, v20
  v_mfma_f32_32x32x16_bf16 v[56:71], v[212:215], v[52:55], v[56:71]
  v_exp_f32 v21, v21
  v_exp_f32 v22, v22
  v_exp_f32 v23, v23
  v_cvt_pk_bf16_f32 v50, v20, v21
  v_cvt_pk_bf16_f32 v51, v22, v23
  v_exp_f32 v24, v24
  v_exp_f32 v25, v25
  v_exp_f32 v26, v26
  v_mfma_f32_32x32x16_bf16 v[72:87], v[96:99], v[48:51], 0
  v_exp_f32 v27, v27
  v_cvt_pk_bf16_f32 v52, v24, v25
  v_cvt_pk_bf16_f32 v53, v26, v27
  v_exp_f32 v28, v28
  v_exp_f32 v29, v29
  v_exp_f32 v30, v30
  v_exp_f32 v31, v31
  v_cvt_pk_bf16_f32 v54, v28, v29
  v_cvt_pk_bf16_f32 v55, v30, v31
  v_mfma_f32_32x32x16_bf16 v[16:31], a[208:211], v[92:95], 0
  v_exp_f32 v32, v32
  v_exp_f32 v33, v33
  v_exp_f32 v34, v34
  v_exp_f32 v35, v35
  v_cvt_pk_bf16_f32 v48, v32, v33
  v_cvt_pk_bf16_f32 v49, v34, v35
  v_exp_f32 v36, v36
  v_mfma_f32_32x32x16_bf16 v[72:87], v[100:103], v[52:55], v[72:87]
  v_exp_f32 v37, v37
  v_exp_f32 v38, v38
  v_exp_f32 v39, v39
  v_cvt_pk_bf16_f32 v50, v36, v37
  v_cvt_pk_bf16_f32 v51, v38, v39
  v_exp_f32 v40, v40
  v_exp_f32 v41, v41
  v_exp_f32 v42, v42
  v_mfma_f32_32x32x16_bf16 v[72:87], v[112:115], v[48:51], v[72:87]
  v_exp_f32 v43, v43
  v_cvt_pk_bf16_f32 v52, v40, v41
  v_cvt_pk_bf16_f32 v53, v42, v43
  v_exp_f32 v44, v44
  v_exp_f32 v45, v45
  v_exp_f32 v46, v46
  v_exp_f32 v47, v47
  v_cvt_pk_bf16_f32 v54, v44, v45
  v_cvt_pk_bf16_f32 v55, v46, v47
  v_mfma_f32_32x32x16_bf16 v[32:47], a[216:219], v[92:95], 0
  v_exp_f32 v16, v16
  v_exp_f32 v17, v17
  v_exp_f32 v18, v18
  v_exp_f32 v19, v19
  v_cvt_pk_bf16_f32 v48, v16, v17
  v_cvt_pk_bf16_f32 v49, v18, v19
  v_exp_f32 v20, v20
  v_mfma_f32_32x32x16_bf16 v[72:87], v[116:119], v[52:55], v[72:87]
  v_exp_f32 v21, v21
  v_exp_f32 v22, v22
  v_exp_f32 v23, v23
  v_cvt_pk_bf16_f32 v50, v20, v21
  v_cvt_pk_bf16_f32 v51, v22, v23
  v_exp_f32 v24, v24
  v_exp_f32 v25, v25
  v_exp_f32 v26, v26
  v_mfma_f32_32x32x16_bf16 v[72:87], v[128:131], v[48:51], v[72:87]
  v_exp_f32 v27, v27
  v_cvt_pk_bf16_f32 v52, v24, v25
  v_cvt_pk_bf16_f32 v53, v26, v27
  v_exp_f32 v28, v28
  v_exp_f32 v29, v29
  v_exp_f32 v30, v30
  v_exp_f32 v31, v31
  v_cvt_pk_bf16_f32 v54, v28, v29
  v_cvt_pk_bf16_f32 v55, v30, v31
  v_mfma_f32_32x32x16_bf16 v[16:31], a[224:227], v[92:95], 0
  s_waitcnt vmcnt(0)
  s_mov_b64 exec, s[94:95]
  v_cmp_ne_u32 vcc, 1, v5
  s_mov_b64 exec, -1
  s_cmp_eq_u64 vcc, 0
  s_cbranch_scc1 bgo_16
  s_mov_b32 s51, 0
poll_17:
  s_mov_b64 exec, s[94:95]
  buffer_load_dword v5, v4, s[4:7], s50 offen offset:0 sc1
  s_mov_b64 exec, -1
  s_add_u32 s51, s51, 1
  s_waitcnt vmcnt(0)
  s_mov_b64 exec, s[94:95]
  v_cmp_ne_u32 vcc, 1, v5
  s_mov_b64 exec, -1
  s_cmp_eq_u64 vcc, 0
  s_cbranch_scc1 bgo_16
  s_cmp_lt_u32 s51, 2097152
  s_cbranch_scc1 poll_17
bgo_16:
  buffer_load_dwordx4 v[228:231], v2, s[4:7], s76 offen offset:1024 sc1
  buffer_load_dwordx4 v[236:239], v2, s[4:7], s76 offen offset:3072 sc1
  s_mov_b64 exec, s[30:31]
  buffer_load_dwordx4 v[104:107], v6, s[4:7], s80 offen offset:1024 sc1
  buffer_load_dwordx4 v[108:111], v6, s[4:7], s80 offen offset:1536 sc1
  s_mov_b64 exec, -1
  v_exp_f32 v32, v32
  v_exp_f32 v33, v33
  v_exp_f32 v34, v34
  v_exp_f32 v35, v35
  v_cvt_pk_bf16_f32 v48, v32, v33
  v_cvt_pk_bf16_f32 v49, v34, v35
  v_exp_f32 v36, v36
  v_mfma_f32_32x32x16_bf16 v[72:87], v[132:135], v[52:55], v[72:87]
  v_exp_f32 v37, v37
  v_exp_f32 v38, v38
  v_exp_f32 v39, v39
  v_cvt_pk_bf16_f32 v50, v36, v37
  v_cvt_pk_bf16_f32 v51, v38, v39
  v_exp_f32 v40, v40
  v_exp_f32 v41, v41
  v_exp_f32 v42, v42
  v_mfma_f32_32x32x16_bf16 v[72:87], v[144:147], v[48:51], v[72:87]
  v_exp_f32 v43, v43
  v_cvt_pk_bf16_f32 v52, v40, v41
  v_cvt_pk_bf16_f32 v53, v42, v43
  v_exp_f32 v44, v44
  v_exp_f32 v45, v45
  v_exp_f32 v46, v46
  v_exp_f32 v47, v47
  v_cvt_pk_bf16_f32 v54, v44, v45
  v_cvt_pk_bf16_f32 v55, v46, v47
  v_mfma_f32_32x32x16_bf16 v[32:47], a[232:235], v[92:95], 0
  buffer_load_dwordx4 a[212:215], v2, s[4:7], s77 offen offset:1024 sc1
  s_mov_b64 exec, s[30:31]
  buffer_load_dwordx4 v[120:123], v6, s[4:7], s80 offen offset:3072 sc1
  buffer_load_dwordx4 v[124:127], v6, s[4:7], s80 offen offset:3584 sc1
  s_mov_b64 exec, -1
  v_exp_f32 v16, v16
  v_exp_f32 v17, v17
  v_exp_f32 v18, v18
  v_exp_f32 v19, v19
  v_cvt_pk_bf16_f32 v48, v16, v17
  v_cvt_pk_bf16_f32 v49, v18, v19
  v_exp_f32 v20, v20
  v_mfma_f32_32x32x16_bf16 v[72:87], v[148:151], v[52:55], v[72:87]
  v_exp_f32 v21, v21
  v_exp_f32 v22, v22
  v_exp_f32 v23, v23
  v_cvt_pk_bf16_f32 v50, v20, v21
  v_cvt_pk_bf16_f32 v51, v22, v23
  v_exp_f32 v24, v24
  v_exp_f32 v25, v25
  v_exp_f32 v26, v26
  v_mfma_f32_32x32x16_bf16 v[72:87], v[160:163], v[48:51], v[72:87]
  v_exp_f32 v27, v27
  v_cvt_pk_bf16_f32 v52, v24, v25
  v_cvt_pk_bf16_f32 v53, v26, v27
  v_exp_f32 v28, v28
  v_exp_f32 v29, v29
  v_exp_f32 v30, v30
  v_exp_f32 v31, v31
  v_cvt_pk_bf16_f32 v54, v28, v29
  v_cvt_pk_bf16_f32 v55, v30, v31
  v_mfma_f32_32x32x16_bf16 v[16:31], a[240:243], v[92:95], 0
  buffer_load_dwordx4 a[220:223], v2, s[4:7], s77 offen offset:3072 sc1
  s_mov_b64 exec, s[30:31]
  buffer_load_dwordx4 v[136:139], v6, s[4:7], s81 offen offset:1024 sc1
  buffer_load_dwordx4 v[140:143], v6, s[4:7], s81 offen offset:1536 sc1
  s_mov_b64 exec, -1
  v_exp_f32 v32, v32
  v_exp_f32 v33, v33
  v_exp_f32 v34, v34
  v_exp_f32 v35, v35
  v_cvt_pk_bf16_f32 v48, v32, v33
  v_cvt_pk_bf16_f32 v49, v34, v35
  v_exp_f32 v36, v36
  v_mfma_f32_32x32x16_bf16 v[72:87], v[164:167], v[52:55], v[72:87]
  v_exp_f32 v37, v37
  v_exp_f32 v38, v38
  v_exp_f32 v39, v39
  v_cvt_pk_bf16_f32 v50, v36, v37
  v_cvt_pk_bf16_f32 v51, v38, v39
  v_exp_f32 v40, v40
  v_exp_f32 v41, v41
  v_exp_f32 v42, v42
  v_mfma_f32_32x32x16_bf16 v[72:87], v[176:179], v[48:51], v[72:87]
  v_exp_f32 v43, v43
  v_cvt_pk_bf16_f32 v52, v40, v41
  v_cvt_pk_bf16_f32 v53, v42, v43
  v_exp_f32 v44, v44
  v_exp_f32 v45, v45
  v_exp_f32 v46, v46
  v_exp_f32 v47, v47
  v_cvt_pk_bf16_f32 v54, v44, v45
  v_cvt_pk_bf16_f32 v55, v46, v47
  v_mfma_f32_32x32x16_bf16 v[32:47], a[248:251], v[92:95], 0
  buffer_load_dwordx4 a[228:231], v2, s[4:7], s78 offen offset:1024 sc1
  s_mov_b64 exec, s[30:31]
  buffer_load_dwordx4 v[152:155], v6, s[4:7], s81 offen offset:3072 sc1
  buffer_load_dwordx4 v[156:159], v6, s[4:7], s81 offen offset:3584 sc1
  s_mov_b64 exec, -1
  v_exp_f32 v16, v16
  v_exp_f32 v17, v17
  v_exp_f32 v18, v18
  v_exp_f32 v19, v19
  v_cvt_pk_bf16_f32 v48, v16, v17
  v_cvt_pk_bf16_f32 v49, v18, v19
  v_exp_f32 v20, v20
  v_mfma_f32_32x32x16_bf16 v[72:87], v[180:183], v[52:55], v[72:87]
  v_exp_f32 v21, v21
  v_exp_f32 v22, v22
  v_exp_f32 v23, v23
  v_cvt_pk_bf16_f32 v50, v20, v21
  v_cvt_pk_bf16_f32 v51, v22, v23
  v_exp_f32 v24, v24
  v_exp_f32 v25, v25
  v_exp_f32 v26, v26
  v_mfma_f32_32x32x16_bf16 v[72:87], v[192:195], v[48:51], v[72:87]
  v_exp_f32 v27, v27
  v_cvt_pk_bf16_f32 v52, v24, v25
  v_cvt_pk_bf16_f32 v53, v26, v27
  v_exp_f32 v28, v28
  v_exp_f32 v29, v29
  v_exp_f32 v30, v30
  v_exp_f32 v31, v31
  v_cvt_pk_bf16_f32 v54, v28, v29
  v_cvt_pk_bf16_f32 v55, v30, v31
  s_waitcnt vmcnt(12)
  v_mfma_f32_32x32x16_bf16 v[16:31], v[228:231], v[88:91], 0
  buffer_load_dwordx4 a[236:239], v2, s[4:7], s78 offen offset:3072 sc1
  s_mov_b64 exec, s[30:31]
  buffer_load_dwordx4 v[168:171], v6, s[4:7], s82 offen offset:1024 sc1
  buffer_load_dwordx4 v[172:175], v6, s[4:7], s82 offen offset:1536 sc1
  s_mov_b64 exec, -1
  v_exp_f32 v32, v32
  v_exp_f32 v33, v33
  v_exp_f32 v34, v34
  v_exp_f32 v35, v35
  v_cvt_pk_bf16_f32 v48, v32, v33
  v_cvt_pk_bf16_f32 v49, v34, v35
  v_exp_f32 v36, v36
  v_mfma_f32_32x32x16_bf16 v[72:87], v[196:199], v[52:55], v[72:87]
  v_exp_f32 v37, v37
  v_exp_f32 v38, v38
  v_exp_f32 v39, v39
  v_cvt_pk_bf16_f32 v50, v36, v37
  v_cvt_pk_bf16_f32 v51, v38, v39
  v_exp_f32 v40, v40
  v_exp_f32 v41, v41
  v_exp_f32 v42, v42
  v_mfma_f32_32x32x16_bf16 v[72:87], v[208:211], v[48:51], v[72:87]
  v_exp_f32 v43, v43
  v_cvt_pk_bf16_f32 v52, v40, v41
  v_cvt_pk_bf16_f32 v53, v42, v43
  v_exp_f32 v44, v44
  v_exp_f32 v45, v45
  v_exp_f32 v46, v46
  v_exp_f32 v47, v47
  v_cvt_pk_bf16_f32 v54, v44, v45
  v_cvt_pk_bf16_f32 v55, v46, v47
  s_waitcnt vmcnt(14)
  v_mfma_f32_32x32x16_bf16 v[32:47], v[236:239], v[88:91], 0
  buffer_load_dwordx4 a[244:247], v2, s[4:7], s79 offen offset:1024 sc1
  s_mov_b64 exec, s[30:31]
  buffer_load_dwordx4 v[184:187], v6, s[4:7], s82 offen offset:3072 sc1
  buffer_load_dwordx4 v[188:191], v6, s[4:7], s82 offen offset:3584 sc1
  s_mov_b64 exec, -1
  v_exp_f32 v16, v16
  v_exp_f32 v17, v17
  v_exp_f32 v18, v18
  v_exp_f32 v19, v19
  v_cvt_pk_bf16_f32 v48, v16, v17
  v_cvt_pk_bf16_f32 v49, v18, v19
  v_exp_f32 v20, v20
  v_mfma_f32_32x32x16_bf16 v[72:87], v[212:215], v[52:55], v[72:87]
  v_exp_f32 v21, v21
  v_exp_f32 v22, v22
  v_exp_f32 v23, v23
  v_cvt_pk_bf16_f32 v50, v20, v21
  v_cvt_pk_bf16_f32 v51, v22, v23
  v_exp_f32 v24, v24
  v_exp_f32 v25, v25
  v_exp_f32 v26, v26
  s_waitcnt vmcnt(15)
  v_mfma_f32_32x32x16_bf16 v[56:71], v[104:107], v[48:51], v[56:71]
  v_exp_f32 v27, v27
  v_cvt_pk_bf16_f32 v52, v24, v25
  v_cvt_pk_bf16_f32 v53, v26, v27
  v_exp_f32 v28, v28
  v_exp_f32 v29, v29
  v_exp_f32 v30, v30
  v_exp_f32 v31, v31
  v_cvt_pk_bf16_f32 v54, v28, v29
  v_cvt_pk_bf16_f32 v55, v30, v31
  s_waitcnt vmcnt(14)
  v_mfma_f32_32x32x16_bf16 v[16:31], a[212:215], v[88:91], 0
  buffer_load_dwordx4 a[252:255], v2, s[4:7], s79 offen offset:3072 sc1
  s_mov_b64 exec, s[30:31]
  buffer_load_dwordx4 v[200:203], v6, s[4:7], s83 offen offset:1024 sc1
  buffer_load_dwordx4 v[204:207], v6, s[4:7], s83 offen offset:1536 sc1
  s_mov_b64 exec, -1
  v_exp_f32 v32, v32
  v_exp_f32 v33, v33
  v_exp_f32 v34, v34
  v_exp_f32 v35, v35
  v_cvt_pk_bf16_f32 v48, v32, v33
  v_cvt_pk_bf16_f32 v49, v34, v35
  v_exp_f32 v36, v36
  v_mfma_f32_32x32x16_bf16 v[56:71], v[108:111], v[52:55], v[56:71]
  v_exp_f32 v37, v37
  v_exp_f32 v38, v38
  v_exp_f32 v39, v39
  v_cvt_pk_bf16_f32 v50, v36, v37
  v_cvt_pk_bf16_f32 v51, v38, v39
  v_exp_f32 v40, v40
  v_exp_f32 v41, v41
  v_exp_f32 v42, v42
  s_waitcnt vmcnt(15)
  v_mfma_f32_32x32x16_bf16 v[56:71], v[120:123], v[48:51], v[56:71]
  v_exp_f32 v43, v43
  v_cvt_pk_bf16_f32 v52, v40, v41
  v_cvt_pk_bf16_f32 v53, v42, v43
  v_exp_f32 v44, v44
  v_exp_f32 v45, v45
  v_exp_f32 v46, v46
  v_exp_f32 v47, v47
  v_cvt_pk_bf16_f32 v54, v44, v45
  v_cvt_pk_bf16_f32 v55, v46, v47
  s_waitcnt vmcnt(14)
  v_mfma_f32_32x32x16_bf16 v[32:47], a[220:223], v[88:91], 0
  s_mov_b64 exec, s[30:31]
  buffer_load_dwordx4 v[216:219], v6, s[4:7], s83 offen offset:3072 sc1
  buffer_load_dwordx4 v[220:223], v6, s[4:7], s83 offen offset:3584 sc1
  s_mov_b64 exec, -1
  v_exp_f32 v16, v16
  v_exp_f32 v17, v17
  v_exp_f32 v18, v18
  v_exp_f32 v19, v19
  v_cvt_pk_bf16_f32 v48, v16, v17
  v_cvt_pk_bf16_f32 v49, v18, v19
  v_exp_f32 v20, v20
  v_mfma_f32_32x32x16_bf16 v[56:71], v[124:127], v[52:55], v[56:71]
  v_exp_f32 v21, v21
  v_exp_f32 v22, v22
  v_exp_f32 v23, v23
  v_cvt_pk_bf16_f32 v50, v20, v21
  v_cvt_pk_bf16_f32 v51, v22, v23
  v_exp_f32 v24, v24
  v_exp_f32 v25, v25
  v_exp_f32 v26, v26
  s_waitcnt vmcnt(14)
  v_mfma_f32_32x32x16_bf16 v[56:71], v[136:139], v[48:51], v[56:71]
  v_exp_f32 v27, v27
  v_cvt_pk_bf16_f32 v52, v24, v25
  v_cvt_pk_bf16_f32 v53, v26, v27
  v_exp_f32 v28, v28
  v_exp_f32 v29, v29
  v_exp_f32 v30, v30
  v_exp_f32 v31, v31
  v_cvt_pk_bf16_f32 v54, v28, v29
  v_cvt_pk_bf16_f32 v55, v30, v31
  s_waitcnt vmcnt(13)
  v_mfma_f32_32x32x16_bf16 v[16:31], a[228:231], v[88:91], 0
  v_exp_f32 v32, v32
  v_exp_f32 v33, v33
  v_exp_f32 v34, v34
  v_exp_f32 v35, v35
  v_cvt_pk_bf16_f32 v48, v32, v33
  v_cvt_pk_bf16_f32 v49, v34, v35
  v_exp_f32 v36, v36
  v_mfma_f32_32x32x16_bf16 v[56:71], v[140:143], v[52:55], v[56:71]
  v_exp_f32 v37, v37
  v_exp_f32 v38, v38
  v_exp_f32 v39, v39
  v_cvt_pk_bf16_f32 v50, v36, v37
  v_cvt_pk_bf16_f32 v51, v38, v39
  v_exp_f32 v40, v40
  v_exp_f32 v41, v41
  v_exp_f32 v42, v42
  s_waitcnt vmcnt(11)
  v_mfma_f32_32x32x16_bf16 v[56:71], v[152:155], v[48:51], v[56:71]
  v_exp_f32 v43, v43
  v_cvt_pk_bf16_f32 v52, v40, v41
  v_cvt_pk_bf16_f32 v53, v42, v43
  v_exp_f32 v44, v44
  v_exp_f32 v45, v45
  v_exp_f32 v46, v46
  v_exp_f32 v47, v47
  v_cvt_pk_bf16_f32 v54, v44, v45
  v_cvt_pk_bf16_f32 v55, v46, v47
  s_waitcnt vmcnt(10)
  v_mfma_f32_32x32x16_bf16 v[32:47], a[236:239], v[88:91], 0
  s_mov_b32 s50, 45875200
  v_mul_u32_u24 v4, 512, v1
  s_mov_b64 exec, 255
  buffer_load_dword v5, v4, s[4:7], s50 offen offset:256 sc1
  s_mov_b64 exec, -1
  v_exp_f32 v16, v16
  v_exp_f32 v17, v17
  v_exp_f32 v18, v18
  v_exp_f32 v19, v19
  v_cvt_pk_bf16_f32 v48, v16, v17
  v_cvt_pk_bf16_f32 v49, v18, v19
  v_exp_f32 v20, v20
  v_mfma_f32_32x32x16_bf16 v[56:71], v[156:159], v[52:55], v[56:71]
  v_exp_f32 v21, v21
  v_exp_f32 v22, v22
  v_exp_f32 v23, v23
  v_cvt_pk_bf16_f32 v50, v20, v21
  v_cvt_pk_bf16_f32 v51, v22, v23
  v_exp_f32 v24, v24
  v_exp_f32 v25, v25
  v_exp_f32 v26, v26
  s_waitcnt vmcnt(9)
  v_mfma_f32_32x32x16_bf16 v[56:71], v[168:171], v[48:51], v[56:71]
  v_exp_f32 v27, v27
  v_cvt_pk_bf16_f32 v52, v24, v25
  v_cvt_pk_bf16_f32 v53, v26, v27
  v_exp_f32 v28, v28
  v_exp_f32 v29, v29
  v_exp_f32 v30, v30
  v_exp_f32 v31, v31
  v_cvt_pk_bf16_f32 v54, v28, v29
  v_cvt_pk_bf16_f32 v55, v30, v31
  s_waitcnt vmcnt(8)
  v_mfma_f32_32x32x16_bf16 v[16:31], a[244:247], v[88:91], 0
  v_exp_f32 v32, v32
  v_exp_f32 v33, v33
  v_exp_f32 v34, v34
  v_exp_f32 v35, v35
  v_cvt_pk_bf16_f32 v48, v32, v33
  v_cvt_pk_bf16_f32 v49, v34, v35
  v_exp_f32 v36, v36
  v_mfma_f32_32x32x16_bf16 v[56:71], v[172:175], v[52:55], v[56:71]
  v_exp_f32 v37, v37
  v_exp_f32 v38, v38
  v_exp_f32 v39, v39
  v_cvt_pk_bf16_f32 v50, v36, v37
  v_cvt_pk_bf16_f32 v51, v38, v39
  v_exp_f32 v40, v40
  v_exp_f32 v41, v41
  v_exp_f32 v42, v42
  s_waitcnt vmcnt(6)
  v_mfma_f32_32x32x16_bf16 v[56:71], v[184:187], v[48:51], v[56:71]
  v_exp_f32 v43, v43
  v_cvt_pk_bf16_f32 v52, v40, v41
  v_cvt_pk_bf16_f32 v53, v42, v43
  v_exp_f32 v44, v44
  v_exp_f32 v45, v45
  v_exp_f32 v46, v46
  v_exp_f32 v47, v47
  v_cvt_pk_bf16_f32 v54, v44, v45
  v_cvt_pk_bf16_f32 v55, v46, v47
  s_waitcnt vmcnt(5)
  v_mfma_f32_32x32x16_bf16 v[32:47], a[252:255], v[88:91], 0
  s_add_u32 s53, s12, 3
  v_exp_f32 v16, v16
  v_exp_f32 v17, v17
  v_exp_f32 v18, v18
  v_exp_f32 v19, v19
  v_cvt_pk_bf16_f32 v48, v16, v17
  v_cvt_pk_bf16_f32 v49, v18, v19
  v_exp_f32 v20, v20
  v_mfma_f32_32x32x16_bf16 v[56:71], v[188:191], v[52:55], v[56:71]
  s_and_b32 s53, s53, 3
  v_exp_f32 v21, v21
  v_exp_f32 v22, v22
  v_exp_f32 v23, v23
  v_cvt_pk_bf16_f32 v50, v20, v21
  v_cvt_pk_bf16_f32 v51, v22, v23
  v_exp_f32 v24, v24
  v_exp_f32 v25, v25
  v_exp_f32 v26, v26
  s_waitcnt vmcnt(3)
  v_mfma_f32_32x32x16_bf16 v[56:71], v[200:203], v[48:51], v[56:71]
  s_lshl_b32 s53, s53, 11
  v_exp_f32 v27, v27
  v_cvt_pk_bf16_f32 v52, v24, v25
  v_cvt_pk_bf16_f32 v53, v26, v27
  v_exp_f32 v28, v28
  v_exp_f32 v29, v29
  v_exp_f32 v30, v30
  v_exp_f32 v31, v31
  v_cvt_pk_bf16_f32 v54, v28, v29
  v_cvt_pk_bf16_f32 v55, v30, v31
  v_mfma_f32_32x32x16_bf16 v[16:31], v[228:231], v[92:95], 0
  s_add_u32 s53, s53, s48
  v_exp_f32 v32, v32
  v_exp_f32 v33, v33
  v_exp_f32 v34, v34
  v_exp_f32 v35, v35
  v_cvt_pk_bf16_f32 v48, v32, v33
  v_cvt_pk_bf16_f32 v49, v34, v35
  v_exp_f32 v36, v36
  v_mfma_f32_32x32x16_bf16 v[56:71], v[204:207], v[52:55], v[56:71]
  v_exp_f32 v37, v37
  v_exp_f32 v38, v38
  v_exp_f32 v39, v39
  v_cvt_pk_bf16_f32 v50, v36, v37
  v_cvt_pk_bf16_f32 v51, v38, v39
  v_exp_f32 v40, v40
  v_exp_f32 v41, v41
  v_exp_f32 v42, v42
  s_waitcnt vmcnt(1)
  v_mfma_f32_32x32x16_bf16 v[56:71], v[216:219], v[48:51], v[56:71]
  v_exp_f32 v43, v43
  v_cvt_pk_bf16_f32 v52, v40, v41
  v_cvt_pk_bf16_f32 v53, v42, v43
  v_exp_f32 v44, v44
  v_exp_f32 v45, v45
  v_exp_f32 v46, v46
  v_exp_f32 v47, v47
  v_cvt_pk_bf16_f32 v54, v44, v45
  v_cvt_pk_bf16_f32 v55, v46, v47
  v_mfma_f32_32x32x16_bf16 v[32:47], v[236:239], v[92:95], 0
  buffer_load_dwordx4 v[88:91], v2, s[4:7], s53 offen sc1
  v_exp_f32 v16, v16
  v_exp_f32 v17, v17
  v_exp_f32 v18, v18
  v_exp_f32 v19, v19
  v_cvt_pk_bf16_f32 v48, v16, v17
  v_cvt_pk_bf16_f32 v49, v18, v19
  v_exp_f32 v20, v20
  v_mfma_f32_32x32x16_bf16 v[56:71], v[220:223], v[52:55], v[56:71]
  v_exp_f32 v21, v21
  v_exp_f32 v22, v22
  v_exp_f32 v23, v23
  v_cvt_pk_bf16_f32 v50, v20, v21
  v_cvt_pk_bf16_f32 v51, v22, v23
  v_exp_f32 v24, v24
  v_exp_f32 v25, v25
  v_exp_f32 v26, v26
  v_mfma_f32_32x32x16_bf16 v[72:87], v[104:107], v[48:51], v[72:87]
  v_exp_f32 v27, v27
  v_cvt_pk_bf16_f32 v52, v24, v25
  v_cvt_pk_bf16_f32 v53, v26, v27
  v_exp_f32 v28, v28
  v_exp_f32 v29, v29
  v_exp_f32 v30, v30
  v_exp_f32 v31, v31
  v_cvt_pk_bf16_f32 v54, v28, v29
  v_cvt_pk_bf16_f32 v55, v30, v31
  v_mfma_f32_32x32x16_bf16 v[16:31], a[212:215], v[92:95], 0
  s_add_u32 s53, s12, 1
  v_exp_f32 v32, v32
  v_exp_f32 v33, v33
  v_exp_f32 v34, v34
  v_exp_f32 v35, v35
  v_cvt_pk_bf16_f32 v48, v32, v33
  v_cvt_pk_bf16_f32 v49, v34, v35
  v_exp_f32 v36, v36
  v_mfma_f32_32x32x16_bf16 v[72:87], v[108:111], v[52:55], v[72:87]
  s_and_b32 s53, s53, 3
  v_exp_f32 v37, v37
  v_exp_f32 v38, v38
  v_exp_f32 v39, v39
  v_cvt_pk_bf16_f32 v50, v36, v37
  v_cvt_pk_bf16_f32 v51, v38, v39
  v_exp_f32 v40, v40
  v_exp_f32 v41, v41
  v_exp_f32 v42, v42
  v_mfma_f32_32x32x16_bf16 v[72:87], v[120:123], v[48:51], v[72:87]
  s_mul_i32 s53, s53, 13824
  v_exp_f32 v43, v43
  v_cvt_pk_bf16_f32 v52, v40, v41
  v_cvt_pk_bf16_f32 v53, v42, v43
  v_exp_f32 v44, v44
  v_exp_f32 v45, v45
  v_exp_f32 v46, v46
  v_exp_f32 v47, v47
  v_cvt_pk_bf16_f32 v54, v44, v45
  v_cvt_pk_bf16_f32 v55, v46, v47
  v_mfma_f32_32x32x16_bf16 v[32:47], a[220:223], v[92:95], 0
  s_add_u32 s53, s53, 105984
  s_waitcnt vmcnt(1)
  s_mov_b64 exec, 255
  v_cmp_ne_u32 vcc, 1, v5
  s_mov_b64 exec, -1
  s_cmp_eq_u64 vcc, 0
  s_cbranch_scc1 wgo_18
  s_mov_b32 s51, 0
poll_19:
  s_mov_b64 exec, 255
  buffer_load_dword v5, v4, s[4:7], s50 offen offset:256 sc1
  s_mov_b64 exec, -1
  s_add_u32 s51, s51, 1
  s_waitcnt vmcnt(0)
  s_mov_b64 exec, 255
  v_cmp_ne_u32 vcc, 1, v5
  s_mov_b64 exec, -1
  s_cmp_eq_u64 vcc, 0
  s_cbranch_scc1 wgo_18
  s_cmp_lt_u32 s51, 2097152
  s_cbranch_scc1 poll_19
wgo_18:
  v_exp_f32 v16, v16
  v_exp_f32 v17, v17
  v_exp_f32 v18, v18
  v_exp_f32 v19, v19
  v_cvt_pk_bf16_f32 v48, v16, v17
  v_cvt_pk_bf16_f32 v49, v18, v19
  v_exp_f32 v20, v20
  v_mfma_f32_32x32x16_bf16 v[72:87], v[124:127], v[52:55], v[72:87]
  v_exp_f32 v21, v21
  v_exp_f32 v22, v22
  v_exp_f32 v23, v23
  v_cvt_pk_bf16_f32 v50, v20, v21
  v_cvt_pk_bf16_f32 v51, v22, v23
  v_exp_f32 v24, v24
  v_exp_f32 v25, v25
  v_exp_f32 v26, v26
  v_mfma_f32_32x32x16_bf16 v[72:87], v[136:139], v[48:51], v[72:87]
  v_exp_f32 v27, v27
  v_cvt_pk_bf16_f32 v52, v24, v25
  v_cvt_pk_bf16_f32 v53, v26, v27
  v_exp_f32 v28, v28
  v_exp_f32 v29, v29
  v_exp_f32 v30, v30
  v_exp_f32 v31, v31
  v_cvt_pk_bf16_f32 v54, v28, v29
  v_cvt_pk_bf16_f32 v55, v30, v31
  v_mfma_f32_32x32x16_bf16 v[16:31], a[228:231], v[92:95], 0
  v_exp_f32 v32, v32
  v_exp_f32 v33, v33
  v_exp_f32 v34, v34
  v_exp_f32 v35, v35
  v_cvt_pk_bf16_f32 v48, v32, v33
  v_cvt_pk_bf16_f32 v49, v34, v35
  v_exp_f32 v36, v36
  v_mfma_f32_32x32x16_bf16 v[72:87], v[140:143], v[52:55], v[72:87]
  v_exp_f32 v37, v37
  v_exp_f32 v38, v38
  v_exp_f32 v39, v39
  v_cvt_pk_bf16_f32 v50, v36, v37
  v_cvt_pk_bf16_f32 v51, v38, v39
  v_exp_f32 v40, v40
  v_exp_f32 v41, v41
  v_exp_f32 v42, v42
  v_mfma_f32_32x32x16_bf16 v[72:87], v[152:155], v[48:51], v[72:87]
  v_exp_f32 v43, v43
  v_cvt_pk_bf16_f32 v52, v40, v41
  v_cvt_pk_bf16_f32 v53, v42, v43
  v_exp_f32 v44, v44
  v_exp_f32 v45, v45
  v_add_u32 v7, s53, v2
  v_add_u32 v252, s53, v3
  ds_write_b128 v7, v[56:59]
  ds_write_b128 v7, v[60:63] offset:1024
  ds_write_b32 v252, v64 offset:2048
  v_exp_f32 v46, v46
  v_exp_f32 v47, v47
  v_cvt_pk_bf16_f32 v54, v44, v45
  v_cvt_pk_bf16_f32 v55, v46, v47
  v_mfma_f32_32x32x16_bf16 v[32:47], a[236:239], v[92:95], 0
  v_exp_f32 v16, v16
  v_exp_f32 v17, v17
  v_exp_f32 v18, v18
  v_exp_f32 v19, v19
  v_cvt_pk_bf16_f32 v48, v16, v17
  v_cvt_pk_bf16_f32 v49, v18, v19
  v_exp_f32 v20, v20
  v_mfma_f32_32x32x16_bf16 v[72:87], v[156:159], v[52:55], v[72:87]
  s_lshl_b32 s60, s2, 2
  s_add_u32 s60, s60, s12
  s_mul_i32 s60, s60, 2816
  s_add_u32 s60, s60, 42991616
  v_lshlrev_b32 v4, 8, v1
  s_mov_b64 exec, 0x7ff
  buffer_load_dword v5, v4, s[4:7], s60 offen sc1
  s_mov_b64 exec, -1
  v_exp_f32 v21, v21
  v_exp_f32 v22, v22
  v_exp_f32 v23, v23
  v_cvt_pk_bf16_f32 v50, v20, v21
  v_cvt_pk_bf16_f32 v51, v22, v23
  v_exp_f32 v24, v24
  v_exp_f32 v25, v25
  v_exp_f32 v26, v26
  v_mfma_f32_32x32x16_bf16 v[72:87], v[168:171], v[48:51], v[72:87]
  v_exp_f32 v27, v27
  v_cvt_pk_bf16_f32 v52, v24, v25
  v_cvt_pk_bf16_f32 v53, v26, v27
  v_exp_f32 v28, v28
  v_exp_f32 v29, v29
  v_exp_f32 v30, v30
  v_exp_f32 v31, v31
  v_cvt_pk_bf16_f32 v54, v28, v29
  v_cvt_pk_bf16_f32 v55, v30, v31
  v_mfma_f32_32x32x16_bf16 v[16:31], a[244:247], v[92:95], 0
  v_exp_f32 v32, v32
  v_exp_f32 v33, v33
  v_exp_f32 v34, v34
  v_exp_f32 v35, v35
  v_cvt_pk_bf16_f32 v48, v32, v33
  v_cvt_pk_bf16_f32 v49, v34, v35
  v_exp_f32 v36, v36
  v_mfma_f32_32x32x16_bf16 v[72:87], v[172:175], v[52:55], v[72:87]
  s_mul_i32 s60, s16, 101376
  s_add_u32 s60, s60, 39370752
  s_lshl_b32 s64, s12, 12
  s_add_u32 s61, s60, s64
  s_min_u32 s65, s12, 2
  s_mul_i32 s66, s65, 33792
  s_add_u32 s66, s66, s60
  s_add_u32 s66, s66, 32768
  s_mul_i32 s65, s65, 33792
  v_exp_f32 v37, v37
  v_exp_f32 v38, v38
  v_exp_f32 v39, v39
  v_cvt_pk_bf16_f32 v50, v36, v37
  v_cvt_pk_bf16_f32 v51, v38, v39
  v_exp_f32 v40, v40
  v_exp_f32 v41, v41
  v_exp_f32 v42, v42
  v_mfma_f32_32x32x16_bf16 v[72:87], v[184:187], v[48:51], v[72:87]
  v_exp_f32 v43, v43
  v_cvt_pk_bf16_f32 v52, v40, v41
  v_cvt_pk_bf16_f32 v53, v42, v43
  v_exp_f32 v44, v44
  v_exp_f32 v45, v45
  v_exp_f32 v46, v46
  v_exp_f32 v47, v47
  v_cvt_pk_bf16_f32 v54, v44, v45
  v_cvt_pk_bf16_f32 v55, v46, v47
  v_mfma_f32_32x32x16_bf16 v[32:47], a[252:255], v[92:95], 0
  s_add_u32 s53, s12, 4
  v_exp_f32 v16, v16
  v_exp_f32 v17, v17
  v_exp_f32 v18, v18
  v_exp_f32 v19, v19
  v_cvt_pk_bf16_f32 v48, v16, v17
  v_cvt_pk_bf16_f32 v49, v18, v19
  v_exp_f32 v20, v20
  v_mfma_f32_32x32x16_bf16 v[72:87], v[188:191], v[52:55], v[72:87]
  s_and_b32 s53, s53, 3
  s_add_u32 m0, s64, 0
  s_add_u32 s62, s61, 0
  buffer_load_dwordx4 v2, s[4:7], s62 offen offset:0 sc1 lds
  buffer_load_dwordx4 v2, s[4:7], s62 offen offset:1024 sc1 lds
  buffer_load_dwordx4 v2, s[4:7], s62 offen offset:2048 sc1 lds
  v_exp_f32 v21, v21
  v_exp_f32 v22, v22
  v_exp_f32 v23, v23
  v_cvt_pk_bf16_f32 v50, v20, v21
  v_cvt_pk_bf16_f32 v51, v22, v23
  v_exp_f32 v24, v24
  v_exp_f32 v25, v25
  v_exp_f32 v26, v26
  v_mfma_f32_32x32x16_bf16 v[72:87], v[200:203], v[48:51], v[72:87]
  s_lshl_b32 s53, s53, 11
  v_exp_f32 v27, v27
  v_cvt_pk_bf16_f32 v52, v24, v25
  v_cvt_pk_bf16_f32 v53, v26, v27
  v_exp_f32 v28, v28
  v_exp_f32 v29, v29
  v_exp_f32 v30, v30
  v_exp_f32 v31, v31
  v_cvt_pk_bf16_f32 v54, v28, v29
  v_cvt_pk_bf16_f32 v55, v30, v31
  s_waitcnt vmcnt(4)
  v_mfma_f32_32x32x16_bf16 v[16:31], v[224:227], v[88:91], 0
  s_add_u32 s53, s53, s48
  v_exp_f32 v32, v32
  v_exp_f32 v33, v33
  v_exp_f32 v34, v34
  v_exp_f32 v35, v35
  v_cvt_pk_bf16_f32 v48, v32, v33
  v_cvt_pk_bf16_f32 v49, v34, v35
  v_exp_f32 v36, v36
  v_mfma_f32_32x32x16_bf16 v[72:87], v[204:207], v[52:55], v[72:87]
  buffer_load_dwordx4 v2, s[4:7], s62 offen offset:3072 sc1 lds
  v_exp_f32 v37, v37
  v_exp_f32 v38, v38
  v_exp_f32 v39, v39
  v_cvt_pk_bf16_f32 v50, v36, v37
  v_cvt_pk_bf16_f32 v51, v38, v39
  v_exp_f32 v40, v40
  v_exp_f32 v41, v41
  v_exp_f32 v42, v42
  v_mfma_f32_32x32x16_bf16 v[72:87], v[216:219], v[48:51], v[72:87]
  v_exp_f32 v43, v43
  v_cvt_pk_bf16_f32 v52, v40, v41
  v_cvt_pk_bf16_f32 v53, v42, v43
  v_exp_f32 v44, v44
  v_exp_f32 v45, v45
  v_exp_f32 v46, v46
  v_exp_f32 v47, v47
  v_cvt_pk_bf16_f32 v54, v44, v45
  v_cvt_pk_bf16_f32 v55, v46, v47
  v_mfma_f32_32x32x16_bf16 v[32:47], v[228:231], v[88:91], 0
  buffer_load_dwordx4 v[92:95], v2, s[4:7], s53 offen sc1
  v_exp_f32 v16, v16
  v_exp_f32 v17, v17
  v_exp_f32 v18, v18
  v_exp_f32 v19, v19
  v_cvt_pk_bf16_f32 v48, v16, v17
  v_cvt_pk_bf16_f32 v49, v18, v19
  v_exp_f32 v20, v20
  v_mfma_f32_32x32x16_bf16 v[72:87], v[220:223], v[52:55], v[72:87]
  v_exp_f32 v21, v21
  v_exp_f32 v22, v22
  v_exp_f32 v23, v23
  v_cvt_pk_bf16_f32 v50, v20, v21
  v_cvt_pk_bf16_f32 v51, v22, v23
  v_exp_f32 v24, v24
  v_exp_f32 v25, v25
  v_exp_f32 v26, v26
  v_mfma_f32_32x32x16_bf16 v[56:71], v[96:99], v[48:51], 0
  v_exp_f32 v27, v27
  v_cvt_pk_bf16_f32 v52, v24, v25
  v_cvt_pk_bf16_f32 v53, v26, v27
  v_exp_f32 v28, v28
  v_exp_f32 v29, v29
  v_exp_f32 v30, v30
  v_exp_f32 v31, v31
  v_cvt_pk_bf16_f32 v54, v28, v29
  v_cvt_pk_bf16_f32 v55, v30, v31
  v_mfma_f32_32x32x16_bf16 v[16:31], v[232:235], v[88:91], 0
  s_add_u32 s53, s12, 2
  v_exp_f32 v32, v32
  v_exp_f32 v33, v33
  v_exp_f32 v34, v34
  v_exp_f32 v35, v35
  v_cvt_pk_bf16_f32 v48, v32, v33
  v_cvt_pk_bf16_f32 v49, v34, v35
  v_exp_f32 v36, v36
  v_mfma_f32_32x32x16_bf16 v[56:71], v[100:103], v[52:55], v[56:71]
  s_and_b32 s53, s53, 3
  s_add_u32 m0, s64, 33792
  s_add_u32 s62, s61, 33792
  buffer_load_dwordx4 v2, s[4:7], s62 offen offset:0 sc1 lds
  buffer_load_dwordx4 v2, s[4:7], s62 offen offset:1024 sc1 lds
  buffer_load_dwordx4 v2, s[4:7], s62 offen offset:2048 sc1 lds
  v_exp_f32 v37, v37
  v_exp_f32 v38, v38
  v_exp_f32 v39, v39
  v_cvt_pk_bf16_f32 v50, v36, v37
  v_cvt_pk_bf16_f32 v51, v38, v39
  v_exp_f32 v40, v40
  v_exp_f32 v41, v41
  v_exp_f32 v42, v42
  v_mfma_f32_32x32x16_bf16 v[56:71], v[104:107], v[48:51], v[56:71]
  s_mul_i32 s53, s53, 13824
  v_exp_f32 v43, v43
  v_cvt_pk_bf16_f32 v52, v40, v41
  v_cvt_pk_bf16_f32 v53, v42, v43
  v_exp_f32 v44, v44
  v_exp_f32 v45, v45
  v_exp_f32 v46, v46
  v_exp_f32 v47, v47
  v_cvt_pk_bf16_f32 v54, v44, v45
  v_cvt_pk_bf16_f32 v55, v46, v47
  v_mfma_f32_32x32x16_bf16 v[32:47], v[236:239], v[88:91], 0
  s_add_u32 s53, s53, 103680
  v_exp_f32 v16, v16
  v_exp_f32 v17, v17
  v_exp_f32 v18, v18
  v_exp_f32 v19, v19
  v_cvt_pk_bf16_f32 v48, v16, v17
  v_cvt_pk_bf16_f32 v49, v18, v19
  v_exp_f32 v20, v20
  v_mfma_f32_32x32x16_bf16 v[56:71], v[108:111], v[52:55], v[56:71]
  buffer_load_dwordx4 v2, s[4:7], s62 offen offset:3072 sc1 lds
  v_exp_f32 v21, v21
  v_exp_f32 v22, v22
  v_exp_f32 v23, v23
  v_cvt_pk_bf16_f32 v50, v20, v21
  v_cvt_pk_bf16_f32 v51, v22, v23
  v_exp_f32 v24, v24
  v_exp_f32 v25, v25
  v_exp_f32 v26, v26
  v_mfma_f32_32x32x16_bf16 v[56:71], v[112:115], v[48:51], v[56:71]
  v_exp_f32 v27, v27
  v_cvt_pk_bf16_f32 v52, v24, v25
  v_cvt_pk_bf16_f32 v53, v26, v27
  v_exp_f32 v28, v28
  v_exp_f32 v29, v29
  v_exp_f32 v30, v30
  v_exp_f32 v31, v31
  v_cvt_pk_bf16_f32 v54, v28, v29
  v_cvt_pk_bf16_f32 v55, v30, v31
  v_mfma_f32_32x32x16_bf16 v[16:31], a[208:211], v[88:91], 0
  v_exp_f32 v32, v32
  v_exp_f32 v33, v33
  v_exp_f32 v34, v34
  v_exp_f32 v35, v35
  v_cvt_pk_bf16_f32 v48, v32, v33
  v_cvt_pk_bf16_f32 v49, v34, v35
  v_exp_f32 v36, v36
  v_mfma_f32_32x32x16_bf16 v[56:71], v[116:119], v[52:55], v[56:71]
  v_exp_f32 v37, v37
  v_exp_f32 v38, v38
  v_exp_f32 v39, v39
  v_cvt_pk_bf16_f32 v50, v36, v37
  v_cvt_pk_bf16_f32 v51, v38, v39
  v_exp_f32 v40, v40
  v_exp_f32 v41, v41
  v_exp_f32 v42, v42
  v_mfma_f32_32x32x16_bf16 v[56:71], v[120:123], v[48:51], v[56:71]
  v_exp_f32 v43, v43
  v_cvt_pk_bf16_f32 v52, v40, v41
  v_cvt_pk_bf16_f32 v53, v42, v43
  v_exp_f32 v44, v44
  v_exp_f32 v45, v45
  v_add_u32 v7, s53, v2
  v_add_u32 v252, s53, v3
  ds_write_b128 v7, v[72:75]
  ds_write_b128 v7, v[76:79] offset:1024
  ds_write_b32 v252, v80 offset:2048
  v_exp_f32 v46, v46
  v_exp_f32 v47, v47
  v_cvt_pk_bf16_f32 v54, v44, v45
  v_cvt_pk_bf16_f32 v55, v46, v47
  v_mfma_f32_32x32x16_bf16 v[32:47], a[212:215], v[88:91], 0
  v_exp_f32 v16, v16
  v_exp_f32 v17, v17
  v_exp_f32 v18, v18
  v_exp_f32 v19, v19
  v_cvt_pk_bf16_f32 v48, v16, v17
  v_cvt_pk_bf16_f32 v49, v18, v19
  v_exp_f32 v20, v20
  v_mfma_f32_32x32x16_bf16 v[56:71], v[124:127], v[52:55], v[56:71]
  s_add_u32 m0, s64, 67584
  s_add_u32 s62, s61, 67584
  buffer_load_dwordx4 v2, s[4:7], s62 offen offset:0 sc1 lds
  buffer_load_dwordx4 v2, s[4:7], s62 offen offset:1024 sc1 lds
  buffer_load_dwordx4 v2, s[4:7], s62 offen offset:2048 sc1 lds
  v_exp_f32 v21, v21
  v_exp_f32 v22, v22
  v_exp_f32 v23, v23
  v_cvt_pk_bf16_f32 v50, v20, v21
  v_cvt_pk_bf16_f32 v51, v22, v23
  v_exp_f32 v24, v24
  v_exp_f32 v25, v25
  v_exp_f32 v26, v26
  v_mfma_f32_32x32x16_bf16 v[56:71], v[128:131], v[48:51], v[56:71]
  v_exp_f32 v27, v27
  v_cvt_pk_bf16_f32 v52, v24, v25
  v_cvt_pk_bf16_f32 v53, v26, v27
  v_exp_f32 v28, v28
  v_exp_f32 v29, v29
  v_exp_f32 v30, v30
  v_exp_f32 v31, v31
  v_cvt_pk_bf16_f32 v54, v28, v29
  v_cvt_pk_bf16_f32 v55, v30, v31
  v_mfma_f32_32x32x16_bf16 v[16:31], a[216:219], v[88:91], 0
  v_exp_f32 v32, v32
  v_exp_f32 v33, v33
  v_exp_f32 v34, v34
  v_exp_f32 v35, v35
  v_cvt_pk_bf16_f32 v48, v32, v33
  v_cvt_pk_bf16_f32 v49, v34, v35
  v_exp_f32 v36, v36
  v_mfma_f32_32x32x16_bf16 v[56:71], v[132:135], v[52:55], v[56:71]
  buffer_load_dwordx4 v2, s[4:7], s62 offen offset:3072 sc1 lds
  v_exp_f32 v37, v37
  v_exp_f32 v38, v38
  v_exp_f32 v39, v39
  v_cvt_pk_bf16_f32 v50, v36, v37
  v_cvt_pk_bf16_f32 v51, v38, v39
  v_exp_f32 v40, v40
  v_exp_f32 v41, v41
  v_exp_f32 v42, v42
  v_mfma_f32_32x32x16_bf16 v[56:71], v[136:139], v[48:51], v[56:71]
  v_exp_f32 v43, v43
  v_cvt_pk_bf16_f32 v52, v40, v41
  v_cvt_pk_bf16_f32 v53, v42, v43
  v_exp_f32 v44, v44
  v_exp_f32 v45, v45
  v_exp_f32 v46, v46
  v_exp_f32 v47, v47
  v_cvt_pk_bf16_f32 v54, v44, v45
  v_cvt_pk_bf16_f32 v55, v46, v47
  v_mfma_f32_32x32x16_bf16 v[32:47], a[220:223], v[88:91], 0
  v_exp_f32 v16, v16
  v_exp_f32 v17, v17
  v_exp_f32 v18, v18
  v_exp_f32 v19, v19
  v_cvt_pk_bf16_f32 v48, v16, v17
  v_cvt_pk_bf16_f32 v49, v18, v19
  v_exp_f32 v20, v20
  v_mfma_f32_32x32x16_bf16 v[56:71], v[140:143], v[52:55], v[56:71]
  s_add_u32 m0, s64, 16384
  s_add_u32 s62, s61, 16384
  buffer_load_dwordx4 v2, s[4:7], s62 offen offset:0 sc1 lds
  buffer_load_dwordx4 v2, s[4:7], s62 offen offset:1024 sc1 lds
  buffer_load_dwordx4 v2, s[4:7], s62 offen offset:2048 sc1 lds
  v_exp_f32 v21, v21
  v_exp_f32 v22, v22
  v_exp_f32 v23, v23
  v_cvt_pk_bf16_f32 v50, v20, v21
  v_cvt_pk_bf16_f32 v51, v22, v23
  v_exp_f32 v24, v24
  v_exp_f32 v25, v25
  v_exp_f32 v26, v26
  v_mfma_f32_32x32x16_bf16 v[56:71], v[144:147], v[48:51], v[56:71]
  v_exp_f32 v27, v27
  v_cvt_pk_bf16_f32 v52, v24, v25
  v_cvt_pk_bf16_f32 v53, v26, v27
  v_exp_f32 v28, v28
  v_exp_f32 v29, v29
  v_exp_f32 v30, v30
  v_exp_f32 v31, v31
  v_cvt_pk_bf16_f32 v54, v28, v29
  v_cvt_pk_bf16_f32 v55, v30, v31
  v_mfma_f32_32x32x16_bf16 v[16:31], a[224:227], v[88:91], 0
  v_exp_f32 v32, v32
  v_exp_f32 v33, v33
  v_exp_f32 v34, v34
  v_exp_f32 v35, v35
  v_cvt_pk_bf16_f32 v48, v32, v33
  v_cvt_pk_bf16_f32 v49, v34, v35
  v_exp_f32 v36, v36
  v_mfma_f32_32x32x16_bf16 v[56:71], v[148:151], v[52:55], v[56:71]
  buffer_load_dwordx4 v2, s[4:7], s62 offen offset:3072 sc1 lds
  v_exp_f32 v37, v37
  v_exp_f32 v38, v38
  v_exp_f32 v39, v39
  v_cvt_pk_bf16_f32 v50, v36, v37
  v_cvt_pk_bf16_f32 v51, v38, v39
  v_exp_f32 v40, v40
  v_exp_f32 v41, v41
  v_exp_f32 v42, v42
  v_mfma_f32_32x32x16_bf16 v[56:71], v[152:155], v[48:51], v[56:71]
  v_exp_f32 v43, v43
  v_cvt_pk_bf16_f32 v52, v40, v41
  v_cvt_pk_bf16_f32 v53, v42, v43
  v_exp_f32 v44, v44
  v_exp_f32 v45, v45
  v_exp_f32 v46, v46
  v_exp_f32 v47, v47
  v_cvt_pk_bf16_f32 v54, v44, v45
  v_cvt_pk_bf16_f32 v55, v46, v47
  v_mfma_f32_32x32x16_bf16 v[32:47], a[228:231], v[88:91], 0
  v_exp_f32 v16, v16
  v_exp_f32 v17, v17
  v_exp_f32 v18, v18
  v_exp_f32 v19, v19
  v_cvt_pk_bf16_f32 v48, v16, v17
  v_cvt_pk_bf16_f32 v49, v18, v19
  v_exp_f32 v20, v20
  v_mfma_f32_32x32x16_bf16 v[56:71], v[156:159], v[52:55], v[56:71]
  s_add_u32 m0, s64, 50176
  s_add_u32 s62, s61, 50176
  buffer_load_dwordx4 v2, s[4:7], s62 offen offset:0 sc1 lds
  buffer_load_dwordx4 v2, s[4:7], s62 offen offset:1024 sc1 lds
  buffer_load_dwordx4 v2, s[4:7], s62 offen offset:2048 sc1 lds
  v_exp_f32 v21, v21
  v_exp_f32 v22, v22
  v_exp_f32 v23, v23
  v_cvt_pk_bf16_f32 v50, v20, v21
  v_cvt_pk_bf16_f32 v51, v22, v23
  v_exp_f32 v24, v24
  v_exp_f32 v25, v25
  v_exp_f32 v26, v26
  v_mfma_f32_32x32x16_bf16 v[56:71], v[160:163], v[48:51], v[56:71]
  v_exp_f32 v27, v27
  v_cvt_pk_bf16_f32 v52, v24, v25
  v_cvt_pk_bf16_f32 v53, v26, v27
  v_exp_f32 v28, v28
  v_exp_f32 v29, v29
  v_exp_f32 v30, v30
  v_exp_f32 v31, v31
  v_cvt_pk_bf16_f32 v54, v28, v29
  v_cvt_pk_bf16_f32 v55, v30, v31
  v_mfma_f32_32x32x16_bf16 v[16:31], a[232:235], v[88:91], 0
  v_exp_f32 v32, v32
  v_exp_f32 v33, v33
  v_exp_f32 v34, v34
  v_exp_f32 v35, v35
  v_cvt_pk_bf16_f32 v48, v32, v33
  v_cvt_pk_bf16_f32 v49, v34, v35
  v_exp_f32 v36, v36
  v_mfma_f32_32x32x16_bf16 v[56:71], v[164:167], v[52:55], v[56:71]
  buffer_load_dwordx4 v2, s[4:7], s62 offen offset:3072 sc1 lds
  v_exp_f32 v37, v37
  v_exp_f32 v38, v38
  v_exp_f32 v39, v39
  v_cvt_pk_bf16_f32 v50, v36, v37
  v_cvt_pk_bf16_f32 v51, v38, v39
  v_exp_f32 v40, v40
  v_exp_f32 v41, v41
  v_exp_f32 v42, v42
  v_mfma_f32_32x32x16_bf16 v[56:71], v[168:171], v[48:51], v[56:71]
  v_exp_f32 v43, v43
  v_cvt_pk_bf16_f32 v52, v40, v41
  v_cvt_pk_bf16_f32 v53, v42, v43
  v_exp_f32 v44, v44
  v_exp_f32 v45, v45
  v_exp_f32 v46, v46
  v_exp_f32 v47, v47
  v_cvt_pk_bf16_f32 v54, v44, v45
  v_cvt_pk_bf16_f32 v55, v46, v47
  v_mfma_f32_32x32x16_bf16 v[32:47], a[236:239], v[88:91], 0
  v_exp_f32 v16, v16
  v_exp_f32 v17, v17
  v_exp_f32 v18, v18
  v_exp_f32 v19, v19
  v_cvt_pk_bf16_f32 v48, v16, v17
  v_cvt_pk_bf16_f32 v49, v18, v19
  v_exp_f32 v20, v20
  v_mfma_f32_32x32x16_bf16 v[56:71], v[172:175], v[52:55], v[56:71]
  s_add_u32 m0, s64, 83968
  s_add_u32 s62, s61, 83968
  buffer_load_dwordx4 v2, s[4:7], s62 offen offset:0 sc1 lds
  buffer_load_dwordx4 v2, s[4:7], s62 offen offset:1024 sc1 lds
  buffer_load_dwordx4 v2, s[4:7], s62 offen offset:2048 sc1 lds
  v_exp_f32 v21, v21
  v_exp_f32 v22, v22
  v_exp_f32 v23, v23
  v_cvt_pk_bf16_f32 v50, v20, v21
  v_cvt_pk_bf16_f32 v51, v22, v23
  v_exp_f32 v24, v24
  v_exp_f32 v25, v25
  v_exp_f32 v26, v26
  v_mfma_f32_32x32x16_bf16 v[56:71], v[176:179], v[48:51], v[56:71]
  v_exp_f32 v27, v27
  v_cvt_pk_bf16_f32 v52, v24, v25
  v_cvt_pk_bf16_f32 v53, v26, v27
  v_exp_f32 v28, v28
  v_exp_f32 v29, v29
  v_exp_f32 v30, v30
  v_exp_f32 v31, v31
  v_cvt_pk_bf16_f32 v54, v28, v29
  v_cvt_pk_bf16_f32 v55, v30, v31
  v_mfma_f32_32x32x16_bf16 v[16:31], a[240:243], v[88:91], 0
  v_exp_f32 v32, v32
  v_exp_f32 v33, v33
  v_exp_f32 v34, v34
  v_exp_f32 v35, v35
  v_cvt_pk_bf16_f32 v48, v32, v33
  v_cvt_pk_bf16_f32 v49, v34, v35
  v_exp_f32 v36, v36
  v_mfma_f32_32x32x16_bf16 v[56:71], v[180:183], v[52:55], v[56:71]
  buffer_load_dwordx4 v2, s[4:7], s62 offen offset:3072 sc1 lds
  v_exp_f32 v37, v37
  v_exp_f32 v38, v38
  v_exp_f32 v39, v39
  v_cvt_pk_bf16_f32 v50, v36, v37
  v_cvt_pk_bf16_f32 v51, v38, v39
  v_exp_f32 v40, v40
  v_exp_f32 v41, v41
  v_exp_f32 v42, v42
  v_mfma_f32_32x32x16_bf16 v[56:71], v[184:187], v[48:51], v[56:71]
  v_exp_f32 v43, v43
  v_cvt_pk_bf16_f32 v52, v40, v41
  v_cvt_pk_bf16_f32 v53, v42, v43
  v_exp_f32 v44, v44
  v_exp_f32 v45, v45
  v_exp_f32 v46, v46
  v_exp_f32 v47, v47
  v_cvt_pk_bf16_f32 v54, v44, v45
  v_cvt_pk_bf16_f32 v55, v46, v47
  v_mfma_f32_32x32x16_bf16 v[32:47], a[244:247], v[88:91], 0
  v_exp_f32 v16, v16
  v_exp_f32 v17, v17
  v_exp_f32 v18, v18
  v_exp_f32 v19, v19
  v_cvt_pk_bf16_f32 v48, v16, v17
  v_cvt_pk_bf16_f32 v49, v18, v19
  v_exp_f32 v20, v20
  v_mfma_f32_32x32x16_bf16 v[56:71], v[188:191], v[52:55], v[56:71]
  s_add_u32 m0, s65, 32768
  s_nop 0
  buffer_load_dwordx4 v2, s[4:7], s66 offen sc1 lds
  v_exp_f32 v21, v21
  v_exp_f32 v22, v22
  v_exp_f32 v23, v23
  v_cvt_pk_bf16_f32 v50, v20, v21
  v_cvt_pk_bf16_f32 v51, v22, v23
  v_exp_f32 v24, v24
  v_exp_f32 v25, v25
  v_exp_f32 v26, v26
  v_mfma_f32_32x32x16_bf16 v[56:71], v[192:195], v[48:51], v[56:71]
  v_exp_f32 v27, v27
  v_cvt_pk_bf16_f32 v52, v24, v25
  v_cvt_pk_bf16_f32 v53, v26, v27
  v_exp_f32 v28, v28
  v_exp_f32 v29, v29
  v_exp_f32 v30, v30
  v_exp_f32 v31, v31
  v_cvt_pk_bf16_f32 v54, v28, v29
  v_cvt_pk_bf16_f32 v55, v30, v31
  v_mfma_f32_32x32x16_bf16 v[16:31], a[248:251], v[88:91], 0
  v_exp_f32 v32, v32
  v_exp_f32 v33, v33
  v_exp_f32 v34, v34
  v_exp_f32 v35, v35
  v_cvt_pk_bf16_f32 v48, v32, v33
  v_cvt_pk_bf16_f32 v49, v34, v35
  v_exp_f32 v36, v36
  v_mfma_f32_32x32x16_bf16 v[56:71], v[196:199], v[52:55], v[56:71]
  s_mul_i32 s67, s22, 32
  s_lshl_b32 s29, s12, 3
  s_add_u32 s67, s67, s29
  s_lshl_b32 s67, s67, 10
  s_add_u32 s67, s67, 40894464
  s_mul_i32 s68, s23, 32
  s_lshl_b32 s29, s12, 3
  s_add_u32 s68, s68, s29
  s_lshl_b32 s68, s68, 10
  s_add_u32 s68, s68, 40894464
  v_exp_f32 v37, v37
  v_exp_f32 v38, v38
  v_exp_f32 v39, v39
  v_cvt_pk_bf16_f32 v50, v36, v37
  v_cvt_pk_bf16_f32 v51, v38, v39
  v_exp_f32 v40, v40
  v_exp_f32 v41, v41
  v_exp_f32 v42, v42
  v_mfma_f32_32x32x16_bf16 v[56:71], v[200:203], v[48:51], v[56:71]
  v_exp_f32 v43, v43
  v_cvt_pk_bf16_f32 v52, v40, v41
  v_cvt_pk_bf16_f32 v53, v42, v43
  v_exp_f32 v44, v44
  v_exp_f32 v45, v45
  v_exp_f32 v46, v46
  v_exp_f32 v47, v47
  v_cvt_pk_bf16_f32 v54, v44, v45
  v_cvt_pk_bf16_f32 v55, v46, v47
  v_mfma_f32_32x32x16_bf16 v[32:47], a[252:255], v[88:91], 0
  s_add_u32 s53, s12, 5
  v_exp_f32 v16, v16
  v_exp_f32 v17, v17
  v_exp_f32 v18, v18
  v_exp_f32 v19, v19
  v_cvt_pk_bf16_f32 v48, v16, v17
  v_cvt_pk_bf16_f32 v49, v18, v19
  v_exp_f32 v20, v20
  v_mfma_f32_32x32x16_bf16 v[56:71], v[204:207], v[52:55], v[56:71]
  s_and_b32 s53, s53, 3
  buffer_load_dwordx4 a[0:3], v2, s[4:7], s67 offen offset:0 sc1
  buffer_load_dwordx4 a[8:11], v2, s[4:7], s67 offen offset:1024 sc1
  buffer_load_dwordx4 a[16:19], v2, s[4:7], s67 offen offset:2048 sc1
  v_exp_f32 v21, v21
  v_exp_f32 v22, v22
  v_exp_f32 v23, v23
  v_cvt_pk_bf16_f32 v50, v20, v21
  v_cvt_pk_bf16_f32 v51, v22, v23
  v_exp_f32 v24, v24
  v_exp_f32 v25, v25
  v_exp_f32 v26, v26
  v_mfma_f32_32x32x16_bf16 v[56:71], v[208:211], v[48:51], v[56:71]
  s_lshl_b32 s53, s53, 11
  v_exp_f32 v27, v27
  v_cvt_pk_bf16_f32 v52, v24, v25
  v_cvt_pk_bf16_f32 v53, v26, v27
  v_exp_f32 v28, v28
  v_exp_f32 v29, v29
  v_exp_f32 v30, v30
  v_exp_f32 v31, v31
  v_cvt_pk_bf16_f32 v54, v28, v29
  v_cvt_pk_bf16_f32 v55, v30, v31
  s_waitcnt vmcnt(24)
  v_mfma_f32_32x32x16_bf16 v[16:31], v[224:227], v[92:95], 0
  s_add_u32 s53, s53, s49
  v_exp_f32 v32, v32
  v_exp_f32 v33, v33
  v_exp_f32 v34, v34
  v_exp_f32 v35, v35
  v_cvt_pk_bf16_f32 v48, v32, v33
  v_cvt_pk_bf16_f32 v49, v34, v35
  v_exp_f32 v36, v36
  v_mfma_f32_32x32x16_bf16 v[56:71], v[212:215], v[52:55], v[56:71]
  buffer_load_dwordx4 a[24:27], v2, s[4:7], s67 offen offset:3072 sc1
  s_add_u32 s67, s67, 4096
  v_exp_f32 v37, v37
  v_exp_f32 v38, v38
  v_exp_f32 v39, v39
  v_cvt_pk_bf16_f32 v50, v36, v37
  v_cvt_pk_bf16_f32 v51, v38, v39
  v_exp_f32 v40, v40
  v_exp_f32 v41, v41
  v_exp_f32 v42, v42
  v_mfma_f32_32x32x16_bf16 v[56:71], v[216:219], v[48:51], v[56:71]
  v_exp_f32 v43, v43
  v_cvt_pk_bf16_f32 v52, v40, v41
  v_cvt_pk_bf16_f32 v53, v42, v43
  v_exp_f32 v44, v44
  v_exp_f32 v45, v45
  v_exp_f32 v46, v46
  v_exp_f32 v47, v47
  v_cvt_pk_bf16_f32 v54, v44, v45
  v_cvt_pk_bf16_f32 v55, v46, v47
  v_mfma_f32_32x32x16_bf16 v[32:47], v[228:231], v[92:95], 0
  buffer_load_dwordx4 v[88:91], v2, s[4:7], s53 offen sc1
  v_exp_f32 v16, v16
  v_exp_f32 v17, v17
  v_exp_f32 v18, v18
  v_exp_f32 v19, v19
  v_cvt_pk_bf16_f32 v48, v16, v17
  v_cvt_pk_bf16_f32 v49, v18, v19
  v_exp_f32 v20, v20
  v_mfma_f32_32x32x16_bf16 v[56:71], v[220:223], v[52:55], v[56:71]
  v_exp_f32 v21, v21
  v_exp_f32 v22, v22
  v_exp_f32 v23, v23
  v_cvt_pk_bf16_f32 v50, v20, v21
  v_cvt_pk_bf16_f32 v51, v22, v23
  v_exp_f32 v24, v24
  v_exp_f32 v25, v25
  v_exp_f32 v26, v26
  v_mfma_f32_32x32x16_bf16 v[72:87], v[96:99], v[48:51], 0
  v_exp_f32 v27, v27
  v_cvt_pk_bf16_f32 v52, v24, v25
  v_cvt_pk_bf16_f32 v53, v26, v27
  v_exp_f32 v28, v28
  v_exp_f32 v29, v29
  v_exp_f32 v30, v30
  v_exp_f32 v31, v31
  v_cvt_pk_bf16_f32 v54, v28, v29
  v_cvt_pk_bf16_f32 v55, v30, v31
  v_mfma_f32_32x32x16_bf16 v[16:31], v[232:235], v[92:95], 0
  s_add_u32 s53, s12, 3
  v_exp_f32 v32, v32
  v_exp_f32 v33, v33
  v_exp_f32 v34, v34
  v_exp_f32 v35, v35
  v_cvt_pk_bf16_f32 v48, v32, v33
  v_cvt_pk_bf16_f32 v49, v34, v35
  v_exp_f32 v36, v36
  v_mfma_f32_32x32x16_bf16 v[72:87], v[100:103], v[52:55], v[72:87]
  s_and_b32 s53, s53, 3
  buffer_load_dwordx4 a[4:7], v2, s[4:7], s68 offen offset:0 sc1
  buffer_load_dwordx4 a[12:15], v2, s[4:7], s68 offen offset:1024 sc1
  buffer_load_dwordx4 a[20:23], v2, s[4:7], s68 offen offset:2048 sc1
  v_exp_f32 v37, v37
  v_exp_f32 v38, v38
  v_exp_f32 v39, v39
  v_cvt_pk_bf16_f32 v50, v36, v37
  v_cvt_pk_bf16_f32 v51, v38, v39
  v_exp_f32 v40, v40
  v_exp_f32 v41, v41
  v_exp_f32 v42, v42
  v_mfma_f32_32x32x16_bf16 v[72:87], v[104:107], v[48:51], v[72:87]
  s_mul_i32 s53, s53, 13824
  v_exp_f32 v43, v43
  v_cvt_pk_bf16_f32 v52, v40, v41
  v_cvt_pk_bf16_f32 v53, v42, v43
  v_exp_f32 v44, v44
  v_exp_f32 v45, v45
  v_exp_f32 v46, v46
  v_exp_f32 v47, v47
  v_cvt_pk_bf16_f32 v54, v44, v45
  v_cvt_pk_bf16_f32 v55, v46, v47
  v_mfma_f32_32x32x16_bf16 v[32:47], v[236:239], v[92:95], 0
  s_add_u32 s53, s53, 101376
  v_exp_f32 v16, v16
  v_exp_f32 v17, v17
  v_exp_f32 v18, v18
  v_exp_f32 v19, v19
  v_cvt_pk_bf16_f32 v48, v16, v17
  v_cvt_pk_bf16_f32 v49, v18, v19
  v_exp_f32 v20, v20
  v_mfma_f32_32x32x16_bf16 v[72:87], v[108:111], v[52:55], v[72:87]
  buffer_load_dwordx4 a[28:31], v2, s[4:7], s68 offen offset:3072 sc1
  s_add_u32 s68, s68, 4096
  v_exp_f32 v21, v21
  v_exp_f32 v22, v22
  v_exp_f32 v23, v23
  v_cvt_pk_bf16_f32 v50, v20, v21
  v_cvt_pk_bf16_f32 v51, v22, v23
  v_exp_f32 v24, v24
  v_exp_f32 v25, v25
  v_exp_f32 v26, v26
  v_mfma_f32_32x32x16_bf16 v[72:87], v[112:115], v[48:51], v[72:87]
  v_exp_f32 v27, v27
  v_cvt_pk_bf16_f32 v52, v24, v25
  v_cvt_pk_bf16_f32 v53, v26, v27
  v_exp_f32 v28, v28
  v_exp_f32 v29, v29
  v_exp_f32 v30, v30
  v_exp_f32 v31, v31
  v_cvt_pk_bf16_f32 v54, v28, v29
  v_cvt_pk_bf16_f32 v55, v30, v31
  v_mfma_f32_32x32x16_bf16 v[16:31], a[208:211], v[92:95], 0
  v_exp_f32 v32, v32
  v_exp_f32 v33, v33
  v_exp_f32 v34, v34
  v_exp_f32 v35, v35
  v_cvt_pk_bf16_f32 v48, v32, v33
  v_cvt_pk_bf16_f32 v49, v34, v35
  v_exp_f32 v36, v36
  v_mfma_f32_32x32x16_bf16 v[72:87], v[116:119], v[52:55], v[72:87]
  v_exp_f32 v37, v37
  v_exp_f32 v38, v38
  v_exp_f32 v39, v39
  v_cvt_pk_bf16_f32 v50, v36, v37
  v_cvt_pk_bf16_f32 v51, v38, v39
  v_exp_f32 v40, v40
  v_exp_f32 v41, v41
  v_exp_f32 v42, v42
  v_mfma_f32_32x32x16_bf16 v[72:87], v[120:123], v[48:51], v[72:87]
  v_exp_f32 v43, v43
  v_cvt_pk_bf16_f32 v52, v40, v41
  v_cvt_pk_bf16_f32 v53, v42, v43
  v_exp_f32 v44, v44
  v_exp_f32 v45, v45
  v_add_u32 v7, s53, v2
  v_add_u32 v252, s53, v3
  ds_write_b128 v7, v[56:59]
  ds_write_b128 v7, v[60:63] offset:1024
  ds_write_b32 v252, v64 offset:2048
  v_exp_f32 v46, v46
  v_exp_f32 v47, v47
  v_cvt_pk_bf16_f32 v54, v44, v45
  v_cvt_pk_bf16_f32 v55, v46, v47
  v_mfma_f32_32x32x16_bf16 v[32:47], a[212:215], v[92:95], 0
  v_exp_f32 v16, v16
  v_exp_f32 v17, v17
  v_exp_f32 v18, v18
  v_exp_f32 v19, v19
  v_cvt_pk_bf16_f32 v48, v16, v17
  v_cvt_pk_bf16_f32 v49, v18, v19
  v_exp_f32 v20, v20
  v_mfma_f32_32x32x16_bf16 v[72:87], v[124:127], v[52:55], v[72:87]
  buffer_load_dwordx4 a[32:35], v2, s[4:7], s67 offen offset:0 sc1
  buffer_load_dwordx4 a[40:43], v2, s[4:7], s67 offen offset:1024 sc1
  buffer_load_dwordx4 a[48:51], v2, s[4:7], s67 offen offset:2048 sc1
  v_exp_f32 v21, v21
  v_exp_f32 v22, v22
  v_exp_f32 v23, v23
  v_cvt_pk_bf16_f32 v50, v20, v21
  v_cvt_pk_bf16_f32 v51, v22, v23
  v_exp_f32 v24, v24
  v_exp_f32 v25, v25
  v_exp_f32 v26, v26
  v_mfma_f32_32x32x16_bf16 v[72:87], v[128:131], v[48:51], v[72:87]
  v_exp_f32 v27, v27
  v_cvt_pk_bf16_f32 v52, v24, v25
  v_cvt_pk_bf16_f32 v53, v26, v27
  v_exp_f32 v28, v28
  v_exp_f32 v29, v29
  v_exp_f32 v30, v30
  v_exp_f32 v31, v31
  v_cvt_pk_bf16_f32 v54, v28, v29
  v_cvt_pk_bf16_f32 v55, v30, v31
  v_mfma_f32_32x32x16_bf16 v[16:31], a[216:219], v[92:95], 0
  v_exp_f32 v32, v32
  v_exp_f32 v33, v33
  v_exp_f32 v34, v34
  v_exp_f32 v35, v35
  v_cvt_pk_bf16_f32 v48, v32, v33
  v_cvt_pk_bf16_f32 v49, v34, v35
  v_exp_f32 v36, v36
  v_mfma_f32_32x32x16_bf16 v[72:87], v[132:135], v[52:55], v[72:87]
  buffer_load_dwordx4 a[56:59], v2, s[4:7], s67 offen offset:3072 sc1
  s_add_u32 s67, s67, 4096
  v_exp_f32 v37, v37
  v_exp_f32 v38, v38
  v_exp_f32 v39, v39
  v_cvt_pk_bf16_f32 v50, v36, v37
  v_cvt_pk_bf16_f32 v51, v38, v39
  v_exp_f32 v40, v40
  v_exp_f32 v41, v41
  v_exp_f32 v42, v42
  v_mfma_f32_32x32x16_bf16 v[72:87], v[136:139], v[48:51], v[72:87]
  v_exp_f32 v43, v43
  v_cvt_pk_bf16_f32 v52, v40, v41
  v_cvt_pk_bf16_f32 v53, v42, v43
  v_exp_f32 v44, v44
  v_exp_f32 v45, v45
  v_exp_f32 v46, v46
  v_exp_f32 v47, v47
  v_cvt_pk_bf16_f32 v54, v44, v45
  v_cvt_pk_bf16_f32 v55, v46, v47
  v_mfma_f32_32x32x16_bf16 v[32:47], a[220:223], v[92:95], 0
  v_exp_f32 v16, v16
  v_exp_f32 v17, v17
  v_exp_f32 v18, v18
  v_exp_f32 v19, v19
  v_cvt_pk_bf16_f32 v48, v16, v17
  v_cvt_pk_bf16_f32 v49, v18, v19
  v_exp_f32 v20, v20
  v_mfma_f32_32x32x16_bf16 v[72:87], v[140:143], v[52:55], v[72:87]
  buffer_load_dwordx4 a[36:39], v2, s[4:7], s68 offen offset:0 sc1
  buffer_load_dwordx4 a[44:47], v2, s[4:7], s68 offen offset:1024 sc1
  buffer_load_dwordx4 a[52:55], v2, s[4:7], s68 offen offset:2048 sc1
  v_exp_f32 v21, v21
  v_exp_f32 v22, v22
  v_exp_f32 v23, v23
  v_cvt_pk_bf16_f32 v50, v20, v21
  v_cvt_pk_bf16_f32 v51, v22, v23
  v_exp_f32 v24, v24
  v_exp_f32 v25, v25
  v_exp_f32 v26, v26
  v_mfma_f32_32x32x16_bf16 v[72:87], v[144:147], v[48:51], v[72:87]
  v_exp_f32 v27, v27
  v_cvt_pk_bf16_f32 v52, v24, v25
  v_cvt_pk_bf16_f32 v53, v26, v27
  v_exp_f32 v28, v28
  v_exp_f32 v29, v29
  v_exp_f32 v30, v30
  v_exp_f32 v31, v31
  v_cvt_pk_bf16_f32 v54, v28, v29
  v_cvt_pk_bf16_f32 v55, v30, v31
  v_mfma_f32_32x32x16_bf16 v[16:31], a[224:227], v[92:95], 0
  v_exp_f32 v32, v32
  v_exp_f32 v33, v33
  v_exp_f32 v34, v34
  v_exp_f32 v35, v35
  v_cvt_pk_bf16_f32 v48, v32, v33
  v_cvt_pk_bf16_f32 v49, v34, v35
  v_exp_f32 v36, v36
  v_mfma_f32_32x32x16_bf16 v[72:87], v[148:151], v[52:55], v[72:87]
  buffer_load_dwordx4 a[60:63], v2, s[4:7], s68 offen offset:3072 sc1
  s_add_u32 s68, s68, 4096
  v_exp_f32 v37, v37
  v_exp_f32 v38, v38
  v_exp_f32 v39, v39
  v_cvt_pk_bf16_f32 v50, v36, v37
  v_cvt_pk_bf16_f32 v51, v38, v39
  v_exp_f32 v40, v40
  v_exp_f32 v41, v41
  v_exp_f32 v42, v42
  v_mfma_f32_32x32x16_bf16 v[72:87], v[152:155], v[48:51], v[72:87]
  v_exp_f32 v43, v43
  v_cvt_pk_bf16_f32 v52, v40, v41
  v_cvt_pk_bf16_f32 v53, v42, v43
  v_exp_f32 v44, v44
  v_exp_f32 v45, v45
  v_exp_f32 v46, v46
  v_exp_f32 v47, v47
  v_cvt_pk_bf16_f32 v54, v44, v45
  v_cvt_pk_bf16_f32 v55, v46, v47
  v_mfma_f32_32x32x16_bf16 v[32:47], a[228:231], v[92:95], 0
  v_exp_f32 v16, v16
  v_exp_f32 v17, v17
  v_exp_f32 v18, v18
  v_exp_f32 v19, v19
  v_cvt_pk_bf16_f32 v48, v16, v17
  v_cvt_pk_bf16_f32 v49, v18, v19
  v_exp_f32 v20, v20
  v_mfma_f32_32x32x16_bf16 v[72:87], v[156:159], v[52:55], v[72:87]
  s_mul_i32 s67, s22, 96
  s_add_u32 s67, s67, s33
  s_lshl_b32 s67, s67, 10
  s_add_u32 s67, s67, 41418752
  s_mul_i32 s68, s23, 96
  s_add_u32 s68, s68, s33
  s_lshl_b32 s68, s68, 10
  s_add_u32 s68, s68, 41418752
  v_exp_f32 v21, v21
  v_exp_f32 v22, v22
  v_exp_f32 v23, v23
  v_cvt_pk_bf16_f32 v50, v20, v21
  v_cvt_pk_bf16_f32 v51, v22, v23
  v_exp_f32 v24, v24
  v_exp_f32 v25, v25
  v_exp_f32 v26, v26
  v_mfma_f32_32x32x16_bf16 v[72:87], v[160:163], v[48:51], v[72:87]
  v_exp_f32 v27, v27
  v_cvt_pk_bf16_f32 v52, v24, v25
  v_cvt_pk_bf16_f32 v53, v26, v27
  v_exp_f32 v28, v28
  v_exp_f32 v29, v29
  v_exp_f32 v30, v30
  v_exp_f32 v31, v31
  v_cvt_pk_bf16_f32 v54, v28, v29
  v_cvt_pk_bf16_f32 v55, v30, v31
  v_mfma_f32_32x32x16_bf16 v[16:31], a[232:235], v[92:95], 0
  v_exp_f32 v32, v32
  v_exp_f32 v33, v33
  v_exp_f32 v34, v34
  v_exp_f32 v35, v35
  v_cvt_pk_bf16_f32 v48, v32, v33
  v_cvt_pk_bf16_f32 v49, v34, v35
  v_exp_f32 v36, v36
  v_mfma_f32_32x32x16_bf16 v[72:87], v[164:167], v[52:55], v[72:87]
  buffer_load_dwordx4 a[64:67], v2, s[4:7], s67 offen offset:0 sc1
  buffer_load_dwordx4 a[72:75], v2, s[4:7], s67 offen offset:1024 sc1
  buffer_load_dwordx4 a[80:83], v2, s[4:7], s67 offen offset:2048 sc1
  v_exp_f32 v37, v37
  v_exp_f32 v38, v38
  v_exp_f32 v39, v39
  v_cvt_pk_bf16_f32 v50, v36, v37
  v_cvt_pk_bf16_f32 v51, v38, v39
  v_exp_f32 v40, v40
  v_exp_f32 v41, v41
  v_exp_f32 v42, v42
  v_mfma_f32_32x32x16_bf16 v[72:87], v[168:171], v[48:51], v[72:87]
  v_exp_f32 v43, v43
  v_cvt_pk_bf16_f32 v52, v40, v41
  v_cvt_pk_bf16_f32 v53, v42, v43
  v_exp_f32 v44, v44
  v_exp_f32 v45, v45
  v_exp_f32 v46, v46
  v_exp_f32 v47, v47
  v_cvt_pk_bf16_f32 v54, v44, v45
  v_cvt_pk_bf16_f32 v55, v46, v47
  v_mfma_f32_32x32x16_bf16 v[32:47], a[236:239], v[92:95], 0
  v_exp_f32 v16, v16
  v_exp_f32 v17, v17
  v_exp_f32 v18, v18
  v_exp_f32 v19, v19
  v_cvt_pk_bf16_f32 v48, v16, v17
  v_cvt_pk_bf16_f32 v49, v18, v19
  v_exp_f32 v20, v20
  v_mfma_f32_32x32x16_bf16 v[72:87], v[172:175], v[52:55], v[72:87]
  buffer_load_dwordx4 a[88:91], v2, s[4:7], s67 offen offset:3072 sc1
  s_add_u32 s67, s67, 4096
  v_exp_f32 v21, v21
  v_exp_f32 v22, v22
  v_exp_f32 v23, v23
  v_cvt_pk_bf16_f32 v50, v20, v21
  v_cvt_pk_bf16_f32 v51, v22, v23
  v_exp_f32 v24, v24
  v_exp_f32 v25, v25
  v_exp_f32 v26, v26
  v_mfma_f32_32x32x16_bf16 v[72:87], v[176:179], v[48:51], v[72:87]
  v_exp_f32 v27, v27
  v_cvt_pk_bf16_f32 v52, v24, v25
  v_cvt_pk_bf16_f32 v53, v26, v27
  v_exp_f32 v28, v28
  v_exp_f32 v29, v29
  v_exp_f32 v30, v30
  v_exp_f32 v31, v31
  v_cvt_pk_bf16_f32 v54, v28, v29
  v_cvt_pk_bf16_f32 v55, v30, v31
  v_mfma_f32_32x32x16_bf16 v[16:31], a[240:243], v[92:95], 0
  v_exp_f32 v32, v32
  v_exp_f32 v33, v33
  v_exp_f32 v34, v34
  v_exp_f32 v35, v35
  v_cvt_pk_bf16_f32 v48, v32, v33
  v_cvt_pk_bf16_f32 v49, v34, v35
  v_exp_f32 v36, v36
  v_mfma_f32_32x32x16_bf16 v[72:87], v[180:183], v[52:55], v[72:87]
  buffer_load_dwordx4 a[68:71], v2, s[4:7], s68 offen offset:0 sc1
  buffer_load_dwordx4 a[76:79], v2, s[4:7], s68 offen offset:1024 sc1
  buffer_load_dwordx4 a[84:87], v2, s[4:7], s68 offen offset:2048 sc1
  v_exp_f32 v37, v37
  v_exp_f32 v38, v38
  v_exp_f32 v39, v39
  v_cvt_pk_bf16_f32 v50, v36, v37
  v_cvt_pk_bf16_f32 v51, v38, v39
  v_exp_f32 v40, v40
  v_exp_f32 v41, v41
  v_exp_f32 v42, v42
  v_mfma_f32_32x32x16_bf16 v[72:87], v[184:187], v[48:51], v[72:87]
  v_exp_f32 v43, v43
  v_cvt_pk_bf16_f32 v52, v40, v41
  v_cvt_pk_bf16_f32 v53, v42, v43
  v_exp_f32 v44, v44
  v_exp_f32 v45, v45
  v_exp_f32 v46, v46
  v_exp_f32 v47, v47
  v_cvt_pk_bf16_f32 v54, v44, v45
  v_cvt_pk_bf16_f32 v55, v46, v47
  v_mfma_f32_32x32x16_bf16 v[32:47], a[244:247], v[92:95], 0
  v_exp_f32 v16, v16
  v_exp_f32 v17, v17
  v_exp_f32 v18, v18
  v_exp_f32 v19, v19
  v_cvt_pk_bf16_f32 v48, v16, v17
  v_cvt_pk_bf16_f32 v49, v18, v19
  v_exp_f32 v20, v20
  v_mfma_f32_32x32x16_bf16 v[72:87], v[188:191], v[52:55], v[72:87]
  v_exp_f32 v21, v21
  v_exp_f32 v22, v22
  v_exp_f32 v23, v23
  v_cvt_pk_bf16_f32 v50, v20, v21
  v_cvt_pk_bf16_f32 v51, v22, v23
  v_exp_f32 v24, v24
  v_exp_f32 v25, v25
  v_exp_f32 v26, v26
  v_mfma_f32_32x32x16_bf16 v[72:87], v[192:195], v[48:51], v[72:87]
  v_exp_f32 v27, v27
  v_cvt_pk_bf16_f32 v52, v24, v25
  v_cvt_pk_bf16_f32 v53, v26, v27
  v_exp_f32 v28, v28
  v_exp_f32 v29, v29
  v_exp_f32 v30, v30
  v_exp_f32 v31, v31
  v_cvt_pk_bf16_f32 v54, v28, v29
  v_cvt_pk_bf16_f32 v55, v30, v31
  v_mfma_f32_32x32x16_bf16 v[16:31], a[248:251], v[92:95], 0
  v_exp_f32 v32, v32
  v_exp_f32 v33, v33
  v_exp_f32 v34, v34
  v_exp_f32 v35, v35
  v_cvt_pk_bf16_f32 v48, v32, v33
  v_cvt_pk_bf16_f32 v49, v34, v35
  v_exp_f32 v36, v36
  v_mfma_f32_32x32x16_bf16 v[72:87], v[196:199], v[52:55], v[72:87]
  v_exp_f32 v37, v37
  v_exp_f32 v38, v38
  v_exp_f32 v39, v39
  v_cvt_pk_bf16_f32 v50, v36, v37
  v_cvt_pk_bf16_f32 v51, v38, v39
  v_exp_f32 v40, v40
  v_exp_f32 v41, v41
  v_exp_f32 v42, v42
  v_mfma_f32_32x32x16_bf16 v[72:87], v[200:203], v[48:51], v[72:87]
  v_exp_f32 v43, v43
  v_cvt_pk_bf16_f32 v52, v40, v41
  v_cvt_pk_bf16_f32 v53, v42, v43
  v_exp_f32 v44, v44
  v_exp_f32 v45, v45
  v_exp_f32 v46, v46
  v_exp_f32 v47, v47
  v_cvt_pk_bf16_f32 v54, v44, v45
  v_cvt_pk_bf16_f32 v55, v46, v47
  v_mfma_f32_32x32x16_bf16 v[32:47], a[252:255], v[92:95], 0
  s_add_u32 s53, s12, 6
  v_exp_f32 v16, v16
  v_exp_f32 v17, v17
  v_exp_f32 v18, v18
  v_exp_f32 v19, v19
  v_cvt_pk_bf16_f32 v48, v16, v17
  v_cvt_pk_bf16_f32 v49, v18, v19
  v_exp_f32 v20, v20
  v_mfma_f32_32x32x16_bf16 v[72:87], v[204:207], v[52:55], v[72:87]
  s_and_b32 s53, s53, 3
  v_exp_f32 v21, v21
  v_exp_f32 v22, v22
  v_exp_f32 v23, v23
  v_cvt_pk_bf16_f32 v50, v20, v21
  v_cvt_pk_bf16_f32 v51, v22, v23
  v_exp_f32 v24, v24
  v_exp_f32 v25, v25
  v_exp_f32 v26, v26
  v_mfma_f32_32x32x16_bf16 v[72:87], v[208:211], v[48:51], v[72:87]
  s_lshl_b32 s53, s53, 11
  v_exp_f32 v27, v27
  v_cvt_pk_bf16_f32 v52, v24, v25
  v_cvt_pk_bf16_f32 v53, v26, v27
  v_exp_f32 v28, v28
  v_exp_f32 v29, v29
  v_exp_f32 v30, v30
  v_exp_f32 v31, v31
  v_cvt_pk_bf16_f32 v54, v28, v29
  v_cvt_pk_bf16_f32 v55, v30, v31
  s_waitcnt vmcnt(19)
  v_mfma_f32_32x32x16_bf16 v[16:31], v[224:227], v[88:91], 0
  s_add_u32 s53, s53, s49
  v_exp_f32 v32, v32
  v_exp_f32 v33, v33
  v_exp_f32 v34, v34
  v_exp_f32 v35, v35
  v_cvt_pk_bf16_f32 v48, v32, v33
  v_cvt_pk_bf16_f32 v49, v34, v35
  v_exp_f32 v36, v36
  v_mfma_f32_32x32x16_bf16 v[72:87], v[212:215], v[52:55], v[72:87]
  v_exp_f32 v37, v37
  v_exp_f32 v38, v38
  v_exp_f32 v39, v39
  v_cvt_pk_bf16_f32 v50, v36, v37
  v_cvt_pk_bf16_f32 v51, v38, v39
  v_exp_f32 v40, v40
  v_exp_f32 v41, v41
  v_exp_f32 v42, v42
  v_mfma_f32_32x32x16_bf16 v[72:87], v[216:219], v[48:51], v[72:87]
  v_exp_f32 v43, v43
  v_cvt_pk_bf16_f32 v52, v40, v41
  v_cvt_pk_bf16_f32 v53, v42, v43
  v_exp_f32 v44, v44
  v_exp_f32 v45, v45
  v_exp_f32 v46, v46
  v_exp_f32 v47, v47
  v_cvt_pk_bf16_f32 v54, v44, v45
  v_cvt_pk_bf16_f32 v55, v46, v47
  v_mfma_f32_32x32x16_bf16 v[32:47], v[228:231], v[88:91], 0
  buffer_load_dwordx4 v[92:95], v2, s[4:7], s53 offen sc1
  v_exp_f32 v16, v16
  v_exp_f32 v17, v17
  v_exp_f32 v18, v18
  v_exp_f32 v19, v19
  v_cvt_pk_bf16_f32 v48, v16, v17
  v_cvt_pk_bf16_f32 v49, v18, v19
  v_exp_f32 v20, v20
  v_mfma_f32_32x32x16_bf16 v[72:87], v[220:223], v[52:55], v[72:87]
  v_exp_f32 v21, v21
  v_exp_f32 v22, v22
  v_exp_f32 v23, v23
  v_cvt_pk_bf16_f32 v50, v20, v21
  v_cvt_pk_bf16_f32 v51, v22, v23
  v_exp_f32 v24, v24
  v_exp_f32 v25, v25
  v_exp_f32 v26, v26
  v_mfma_f32_32x32x16_bf16 v[56:71], v[96:99], v[48:51], 0
  v_exp_f32 v27, v27
  v_cvt_pk_bf16_f32 v52, v24, v25
  v_cvt_pk_bf16_f32 v53, v26, v27
  v_exp_f32 v28, v28
  v_exp_f32 v29, v29
  v_exp_f32 v30, v30
  v_exp_f32 v31, v31
  v_cvt_pk_bf16_f32 v54, v28, v29
  v_cvt_pk_bf16_f32 v55, v30, v31
  v_mfma_f32_32x32x16_bf16 v[16:31], v[232:235], v[88:91], 0
  v_exp_f32 v32, v32
  v_exp_f32 v33, v33
  v_exp_f32 v34, v34
  v_exp_f32 v35, v35
  v_cvt_pk_bf16_f32 v48, v32, v33
  v_cvt_pk_bf16_f32 v49, v34, v35
  v_exp_f32 v36, v36
  v_mfma_f32_32x32x16_bf16 v[56:71], v[100:103], v[52:55], v[56:71]
  v_exp_f32 v37, v37
  v_exp_f32 v38, v38
  v_exp_f32 v39, v39
  v_cvt_pk_bf16_f32 v50, v36, v37
  v_cvt_pk_bf16_f32 v51, v38, v39
  v_exp_f32 v40, v40
  v_exp_f32 v41, v41
  v_exp_f32 v42, v42
  v_mfma_f32_32x32x16_bf16 v[56:71], v[104:107], v[48:51], v[56:71]
  v_exp_f32 v43, v43
  v_cvt_pk_bf16_f32 v52, v40, v41
  v_cvt_pk_bf16_f32 v53, v42, v43
  v_exp_f32 v44, v44
  v_exp_f32 v45, v45
  v_exp_f32 v46, v46
  v_exp_f32 v47, v47
  v_cvt_pk_bf16_f32 v54, v44, v45
  v_cvt_pk_bf16_f32 v55, v46, v47
  v_mfma_f32_32x32x16_bf16 v[32:47], v[236:239], v[88:91], 0
  v_exp_f32 v16, v16
  v_exp_f32 v17, v17
  v_exp_f32 v18, v18
  v_exp_f32 v19, v19
  v_cvt_pk_bf16_f32 v48, v16, v17
  v_cvt_pk_bf16_f32 v49, v18, v19
  v_exp_f32 v20, v20
  v_mfma_f32_32x32x16_bf16 v[56:71], v[108:111], v[52:55], v[56:71]
  v_exp_f32 v21, v21
  v_exp_f32 v22, v22
  v_exp_f32 v23, v23
  v_cvt_pk_bf16_f32 v50, v20, v21
  v_cvt_pk_bf16_f32 v51, v22, v23
  v_exp_f32 v24, v24
  v_exp_f32 v25, v25
  v_exp_f32 v26, v26
  v_mfma_f32_32x32x16_bf16 v[56:71], v[112:115], v[48:51], v[56:71]
  v_exp_f32 v27, v27
  v_cvt_pk_bf16_f32 v52, v24, v25
  v_cvt_pk_bf16_f32 v53, v26, v27
  v_exp_f32 v28, v28
  v_exp_f32 v29, v29
  v_mov_b32 v240, 157696
  v_mov_b32 v242, 0
  v_mov_b32 v243, 0
  ds_write_b64 v240, v[242:243]
  ds_write_b32 v240, v242 offset:8
  s_waitcnt lgkmcnt(0)
  s_barrier
  s_mul_i32 s53, s12, 13824
  s_add_u32 s53, s53, 101376
  v_add_u32 v7, s53, v2
  v_add_u32 v252, s53, v3
  ds_read_b128 v[240:243], v7 offset:0
  ds_read_b128 v[244:247], v7 offset:1024
  ds_read_b32 v248, v252 offset:2048
  v_exp_f32 v30, v30
  v_exp_f32 v31, v31
  v_cvt_pk_bf16_f32 v54, v28, v29
  v_cvt_pk_bf16_f32 v55, v30, v31
  v_mfma_f32_32x32x16_bf16 v[16:31], a[208:211], v[88:91], 0
  v_exp_f32 v32, v32
  v_exp_f32 v33, v33
  v_exp_f32 v34, v34
  v_exp_f32 v35, v35
  v_cvt_pk_bf16_f32 v48, v32, v33
  v_cvt_pk_bf16_f32 v49, v34, v35
  v_exp_f32 v36, v36
  v_mfma_f32_32x32x16_bf16 v[56:71], v[116:119], v[52:55], v[56:71]
  v_exp_f32 v37, v37
  v_exp_f32 v38, v38
  v_exp_f32 v39, v39
  v_cvt_pk_bf16_f32 v50, v36, v37
  v_cvt_pk_bf16_f32 v51, v38, v39
  v_exp_f32 v40, v40
  v_exp_f32 v41, v41
  v_exp_f32 v42, v42
  v_mfma_f32_32x32x16_bf16 v[56:71], v[120:123], v[48:51], v[56:71]
  v_exp_f32 v43, v43
  v_cvt_pk_bf16_f32 v52, v40, v41
  v_cvt_pk_bf16_f32 v53, v42, v43
  v_exp_f32 v44, v44
  v_exp_f32 v45, v45
  s_waitcnt lgkmcnt(0)
  v_add_f32 v72, v72, v240
  v_add_f32 v73, v73, v241
  v_add_f32 v74, v74, v242
  v_add_f32 v75, v75, v243
  v_add_f32 v76, v76, v244
  v_add_f32 v77, v77, v245
  v_add_f32 v78, v78, v246
  v_add_f32 v79, v79, v247
  v_add_f32 v80, v80, v248
  ds_read_b128 v[240:243], v7 offset:2304
  ds_read_b128 v[244:247], v7 offset:3328
  ds_read_b32 v248, v252 offset:4352
  v_exp_f32 v46, v46
  v_exp_f32 v47, v47
  v_cvt_pk_bf16_f32 v54, v44, v45
  v_cvt_pk_bf16_f32 v55, v46, v47
  v_mfma_f32_32x32x16_bf16 v[32:47], a[212:215], v[88:91], 0
  v_exp_f32 v16, v16
  v_exp_f32 v17, v17
  v_exp_f32 v18, v18
  v_exp_f32 v19, v19
  v_cvt_pk_bf16_f32 v48, v16, v17
  v_cvt_pk_bf16_f32 v49, v18, v19
  v_exp_f32 v20, v20
  v_mfma_f32_32x32x16_bf16 v[56:71], v[124:127], v[52:55], v[56:71]
  v_exp_f32 v21, v21
  v_exp_f32 v22, v22
  v_exp_f32 v23, v23
  v_cvt_pk_bf16_f32 v50, v20, v21
  v_cvt_pk_bf16_f32 v51, v22, v23
  v_exp_f32 v24, v24
  v_exp_f32 v25, v25
  v_exp_f32 v26, v26
  v_mfma_f32_32x32x16_bf16 v[56:71], v[128:131], v[48:51], v[56:71]
  v_exp_f32 v27, v27
  v_cvt_pk_bf16_f32 v52, v24, v25
  v_cvt_pk_bf16_f32 v53, v26, v27
  v_exp_f32 v28, v28
  v_exp_f32 v29, v29
  s_waitcnt lgkmcnt(0)
  v_add_f32 v72, v72, v240
  v_add_f32 v73, v73, v241
  v_add_f32 v74, v74, v242
  v_add_f32 v75, v75, v243
  v_add_f32 v76, v76, v244
  v_add_f32 v77, v77, v245
  v_add_f32 v78, v78, v246
  v_add_f32 v79, v79, v247
  v_add_f32 v80, v80, v248
  ds_read_b128 v[240:243], v7 offset:4608
  ds_read_b128 v[244:247], v7 offset:5632
  ds_read_b32 v248, v252 offset:6656
  v_exp_f32 v30, v30
  v_exp_f32 v31, v31
  v_cvt_pk_bf16_f32 v54, v28, v29
  v_cvt_pk_bf16_f32 v55, v30, v31
  v_mfma_f32_32x32x16_bf16 v[16:31], a[216:219], v[88:91], 0
  v_exp_f32 v32, v32
  v_exp_f32 v33, v33
  v_exp_f32 v34, v34
  v_exp_f32 v35, v35
  v_cvt_pk_bf16_f32 v48, v32, v33
  v_cvt_pk_bf16_f32 v49, v34, v35
  v_exp_f32 v36, v36
  v_mfma_f32_32x32x16_bf16 v[56:71], v[132:135], v[52:55], v[56:71]
  v_exp_f32 v37, v37
  v_exp_f32 v38, v38
  v_exp_f32 v39, v39
  v_cvt_pk_bf16_f32 v50, v36, v37
  v_cvt_pk_bf16_f32 v51, v38, v39
  v_exp_f32 v40, v40
  v_exp_f32 v41, v41
  v_exp_f32 v42, v42
  v_mfma_f32_32x32x16_bf16 v[56:71], v[136:139], v[48:51], v[56:71]
  v_exp_f32 v43, v43
  v_cvt_pk_bf16_f32 v52, v40, v41
  v_cvt_pk_bf16_f32 v53, v42, v43
  v_exp_f32 v44, v44
  v_exp_f32 v45, v45
  s_waitcnt lgkmcnt(0)
  v_add_f32 v72, v72, v240
  v_add_f32 v73, v73, v241
  v_add_f32 v74, v74, v242
  v_add_f32 v75, v75, v243
  v_add_f32 v76, v76, v244
  v_add_f32 v77, v77, v245
  v_add_f32 v78, v78, v246
  v_add_f32 v79, v79, v247
  v_add_f32 v80, v80, v248
  v_add_f32 v240, abs(v72), abs(v73)
  v_add_f32 v241, abs(v74), abs(v75)
  v_add_f32 v242, abs(v76), abs(v77)
  v_add_f32 v243, abs(v78), abs(v79)
  v_add_f32 v240, v240, v241
  v_add_f32 v242, v242, v243
  v_add_f32 v240, v240, v242
  v_cmp_gt_f32 s[70:71], s57, v240
  v_cmp_gt_f32 s[72:73], s57, v80
  v_cmp_lt_f32 s[74:75], s56, v80
  s_and_b64 s[70:71], s[70:71], s[72:73]
  s_and_b64 s[70:71], s[70:71], s[74:75]
  s_cmp_eq_u64 s[70:71], -1
  s_cbranch_scc0 a_later_20
  v_rcp_f32 v240, v80
  s_nop 0
  v_mul_f32 v72, v240, v72
  v_mul_f32 v73, v240, v73
  v_mul_f32 v74, v240, v74
  v_mul_f32 v75, v240, v75
  v_mul_f32 v76, v240, v76
  v_mul_f32 v77, v240, v77
  v_mul_f32 v78, v240, v78
  v_mul_f32 v79, v240, v79
  v_cvt_pk_bf16_f32 v244, v72, v73
  v_cvt_pk_bf16_f32 v245, v74, v75
  v_cvt_pk_bf16_f32 v246, v76, v77
  v_cvt_pk_bf16_f32 v247, v78, v79
  buffer_store_dwordx4 v[244:247], v2, s[4:7], s39 offen sc1
  s_mov_b32 s40, 1
  s_mov_b32 s41, 1
a_later_20:
  v_exp_f32 v46, v46
  v_exp_f32 v47, v47
  v_cvt_pk_bf16_f32 v54, v44, v45
  v_cvt_pk_bf16_f32 v55, v46, v47
  v_mfma_f32_32x32x16_bf16 v[32:47], a[220:223], v[88:91], 0
  s_lshl_b32 s42, s37, 8
  v_exp_f32 v16, v16
  v_exp_f32 v17, v17
  v_exp_f32 v18, v18
  v_exp_f32 v19, v19
  v_cvt_pk_bf16_f32 v48, v16, v17
  v_cvt_pk_bf16_f32 v49, v18, v19
  v_exp_f32 v20, v20
  v_mfma_f32_32x32x16_bf16 v[56:71], v[140:143], v[52:55], v[56:71]
  s_add_u32 s42, s42, s28
  v_exp_f32 v21, v21
  v_exp_f32 v22, v22
  v_exp_f32 v23, v23
  v_cvt_pk_bf16_f32 v50, v20, v21
  v_cvt_pk_bf16_f32 v51, v22, v23
  v_exp_f32 v24, v24
  v_exp_f32 v25, v25
  v_exp_f32 v26, v26
  v_mfma_f32_32x32x16_bf16 v[56:71], v[144:147], v[48:51], v[56:71]
  s_add_u32 s42, s42, 262144
  v_exp_f32 v27, v27
  v_cvt_pk_bf16_f32 v52, v24, v25
  v_cvt_pk_bf16_f32 v53, v26, v27
  v_exp_f32 v28, v28
  v_exp_f32 v29, v29
  v_exp_f32 v30, v30
  v_exp_f32 v31, v31
  v_cvt_pk_bf16_f32 v54, v28, v29
  v_cvt_pk_bf16_f32 v55, v30, v31
  v_mfma_f32_32x32x16_bf16 v[16:31], a[224:227], v[88:91], 0
  s_mov_b32 s69, -1
  v_exp_f32 v32, v32
  v_exp_f32 v33, v33
  v_exp_f32 v34, v34
  v_exp_f32 v35, v35
  v_cvt_pk_bf16_f32 v48, v32, v33
  v_cvt_pk_bf16_f32 v49, v34, v35
  v_exp_f32 v36, v36
  v_mfma_f32_32x32x16_bf16 v[56:71], v[148:151], v[52:55], v[56:71]
  s_mov_b32 s97, 0
  v_exp_f32 v37, v37
  v_exp_f32 v38, v38
  v_exp_f32 v39, v39
  v_cvt_pk_bf16_f32 v50, v36, v37
  v_cvt_pk_bf16_f32 v51, v38, v39
  v_exp_f32 v40, v40
  v_exp_f32 v41, v41
  v_exp_f32 v42, v42
  v_mfma_f32_32x32x16_bf16 v[56:71], v[152:155], v[48:51], v[56:71]
  v_exp_f32 v43, v43
  v_cvt_pk_bf16_f32 v52, v40, v41
  v_cvt_pk_bf16_f32 v53, v42, v43
  v_exp_f32 v44, v44
  v_exp_f32 v45, v45
  v_exp_f32 v46, v46
  v_exp_f32 v47, v47
  v_cvt_pk_bf16_f32 v54, v44, v45
  v_cvt_pk_bf16_f32 v55, v46, v47
  v_mfma_f32_32x32x16_bf16 v[32:47], a[228:231], v[88:91], 0
  v_exp_f32 v16, v16
  v_exp_f32 v17, v17
  v_exp_f32 v18, v18
  v_exp_f32 v19, v19
  v_cvt_pk_bf16_f32 v48, v16, v17
  v_cvt_pk_bf16_f32 v49, v18, v19
  v_exp_f32 v20, v20
  v_mfma_f32_32x32x16_bf16 v[56:71], v[156:159], v[52:55], v[56:71]
  v_exp_f32 v21, v21
  v_exp_f32 v22, v22
  v_exp_f32 v23, v23
  v_cvt_pk_bf16_f32 v50, v20, v21
  v_cvt_pk_bf16_f32 v51, v22, v23
  v_exp_f32 v24, v24
  v_exp_f32 v25, v25
  v_exp_f32 v26, v26
  v_mfma_f32_32x32x16_bf16 v[56:71], v[160:163], v[48:51], v[56:71]
  v_exp_f32 v27, v27
  v_cvt_pk_bf16_f32 v52, v24, v25
  v_cvt_pk_bf16_f32 v53, v26, v27
  v_exp_f32 v28, v28
  v_exp_f32 v29, v29
  v_exp_f32 v30, v30
  v_exp_f32 v31, v31
  v_cvt_pk_bf16_f32 v54, v28, v29
  v_cvt_pk_bf16_f32 v55, v30, v31
  v_mfma_f32_32x32x16_bf16 v[16:31], a[232:235], v[88:91], 0
  v_exp_f32 v32, v32
  v_exp_f32 v33, v33
  v_exp_f32 v34, v34
  v_exp_f32 v35, v35
  v_cvt_pk_bf16_f32 v48, v32, v33
  v_cvt_pk_bf16_f32 v49, v34, v35
  v_exp_f32 v36, v36
  v_mfma_f32_32x32x16_bf16 v[56:71], v[164:167], v[52:55], v[56:71]
  v_exp_f32 v37, v37
  v_exp_f32 v38, v38
  v_exp_f32 v39, v39
  v_cvt_pk_bf16_f32 v50, v36, v37
  v_cvt_pk_bf16_f32 v51, v38, v39
  v_exp_f32 v40, v40
  v_exp_f32 v41, v41
  v_exp_f32 v42, v42
  v_mfma_f32_32x32x16_bf16 v[56:71], v[168:171], v[48:51], v[56:71]
  v_exp_f32 v43, v43
  v_cvt_pk_bf16_f32 v52, v40, v41
  v_cvt_pk_bf16_f32 v53, v42, v43
  v_exp_f32 v44, v44
  v_exp_f32 v45, v45
  s_waitcnt vmcnt(0)
  s_cmp_lg_u32 s41, 2
  s_cbranch_scc1 sge_21
  v_readfirstlane_b32 s52, v0
  s_cmp_lg_u32 s52, s69
  s_cbranch_scc1 notlast_22
  s_mov_b64 exec, 1
  v_mov_b32 v0, 1
  buffer_store_dword v0, v3, s[4:7], s42 offen offset:256 sc1
  s_mov_b64 exec, -1
notlast_22:
  s_mov_b32 s41, 0
sge_21:
  s_cmp_lg_u32 s41, 1
  s_cbranch_scc1 sge_23
  s_mov_b64 exec, 1
  v_mov_b32 v0, 1
  s_cmp_eq_u32 s69, -1
  s_cbranch_scc0 sa_24
  s_mov_b64 exec, s[94:95]
  v_mov_b32 v0, 1
  buffer_store_dword v0, v3, s[4:7], s42 offen sc1
  s_branch sb_25
sa_24:
  buffer_atomic_add v0, v3, s[4:7], s42 offen sc0 sc1
sb_25:
  s_mov_b64 exec, -1
  s_mov_b32 s41, s97
sge_23:
  v_exp_f32 v46, v46
  v_exp_f32 v47, v47
  v_cvt_pk_bf16_f32 v54, v44, v45
  v_cvt_pk_bf16_f32 v55, v46, v47
  v_mfma_f32_32x32x16_bf16 v[32:47], a[236:239], v[88:91], 0
  v_exp_f32 v16, v16
  v_exp_f32 v17, v17
  v_exp_f32 v18, v18
  v_exp_f32 v19, v19
  v_cvt_pk_bf16_f32 v48, v16, v17
  v_cvt_pk_bf16_f32 v49, v18, v19
  v_exp_f32 v20, v20
  v_mfma_f32_32x32x16_bf16 v[56:71], v[172:175], v[52:55], v[56:71]
  buffer_load_dwordx4 a[92:95], v2, s[4:7], s68 offen offset:3072 sc1
  s_add_u32 s68, s68, 4096
  v_exp_f32 v21, v21
  v_exp_f32 v22, v22
  v_exp_f32 v23, v23
  v_cvt_pk_bf16_f32 v50, v20, v21
  v_cvt_pk_bf16_f32 v51, v22, v23
  v_exp_f32 v24, v24
  v_exp_f32 v25, v25
  v_exp_f32 v26, v26
  v_mfma_f32_32x32x16_bf16 v[56:71], v[176:179], v[48:51], v[56:71]
  v_exp_f32 v27, v27
  v_cvt_pk_bf16_f32 v52, v24, v25
  v_cvt_pk_bf16_f32 v53, v26, v27
  v_exp_f32 v28, v28
  v_exp_f32 v29, v29
  v_exp_f32 v30, v30
  v_exp_f32 v31, v31
  v_cvt_pk_bf16_f32 v54, v28, v29
  v_cvt_pk_bf16_f32 v55, v30, v31
  v_mfma_f32_32x32x16_bf16 v[16:31], a[240:243], v[88:91], 0
  v_exp_f32 v32, v32
  v_exp_f32 v33, v33
  v_exp_f32 v34, v34
  v_exp_f32 v35, v35
  v_cvt_pk_bf16_f32 v48, v32, v33
  v_cvt_pk_bf16_f32 v49, v34, v35
  v_exp_f32 v36, v36
  v_mfma_f32_32x32x16_bf16 v[56:71], v[180:183], v[52:55], v[56:71]
  buffer_load_dwordx4 a[96:99], v2, s[4:7], s67 offen offset:0 sc1
  buffer_load_dwordx4 a[104:107], v2, s[4:7], s67 offen offset:1024 sc1
  buffer_load_dwordx4 a[112:115], v2, s[4:7], s67 offen offset:2048 sc1
  v_exp_f32 v37, v37
  v_exp_f32 v38, v38
  v_exp_f32 v39, v39
  v_cvt_pk_bf16_f32 v50, v36, v37
  v_cvt_pk_bf16_f32 v51, v38, v39
  v_exp_f32 v40, v40
  v_exp_f32 v41, v41
  v_exp_f32 v42, v42
  v_mfma_f32_32x32x16_bf16 v[56:71], v[184:187], v[48:51], v[56:71]
  v_exp_f32 v43, v43
  v_cvt_pk_bf16_f32 v52, v40, v41
  v_cvt_pk_bf16_f32 v53, v42, v43
  v_exp_f32 v44, v44
  v_exp_f32 v45, v45
  v_exp_f32 v46, v46
  v_exp_f32 v47, v47
  v_cvt_pk_bf16_f32 v54, v44, v45
  v_cvt_pk_bf16_f32 v55, v46, v47
  v_mfma_f32_32x32x16_bf16 v[32:47], a[244:247], v[88:91], 0
  v_exp_f32 v16, v16
  v_exp_f32 v17, v17
  v_exp_f32 v18, v18
  v_exp_f32 v19, v19
  v_cvt_pk_bf16_f32 v48, v16, v17
  v_cvt_pk_bf16_f32 v49, v18, v19
  v_exp_f32 v20, v20
  v_mfma_f32_32x32x16_bf16 v[56:71], v[188:191], v[52:55], v[56:71]
  buffer_load_dwordx4 a[120:123], v2, s[4:7], s67 offen offset:3072 sc1
  s_add_u32 s67, s67, 4096
  v_exp_f32 v21, v21
  v_exp_f32 v22, v22
  v_exp_f32 v23, v23
  v_cvt_pk_bf16_f32 v50, v20, v21
  v_cvt_pk_bf16_f32 v51, v22, v23
  v_exp_f32 v24, v24
  v_exp_f32 v25, v25
  v_exp_f32 v26, v26
  v_mfma_f32_32x32x16_bf16 v[56:71], v[192:195], v[48:51], v[56:71]
  v_exp_f32 v27, v27
  v_cvt_pk_bf16_f32 v52, v24, v25
  v_cvt_pk_bf16_f32 v53, v26, v27
  v_exp_f32 v28, v28
  v_exp_f32 v29, v29
  v_exp_f32 v30, v30
  v_exp_f32 v31, v31
  v_cvt_pk_bf16_f32 v54, v28, v29
  v_cvt_pk_bf16_f32 v55, v30, v31
  v_mfma_f32_32x32x16_bf16 v[16:31], a[248:251], v[88:91], 0
  v_exp_f32 v32, v32
  v_exp_f32 v33, v33
  v_exp_f32 v34, v34
  v_exp_f32 v35, v35
  v_cvt_pk_bf16_f32 v48, v32, v33
  v_cvt_pk_bf16_f32 v49, v34, v35
  v_exp_f32 v36, v36
  v_mfma_f32_32x32x16_bf16 v[56:71], v[196:199], v[52:55], v[56:71]
  buffer_load_dwordx4 a[100:103], v2, s[4:7], s68 offen offset:0 sc1
  buffer_load_dwordx4 a[108:111], v2, s[4:7], s68 offen offset:1024 sc1
  buffer_load_dwordx4 a[116:119], v2, s[4:7], s68 offen offset:2048 sc1
  v_exp_f32 v37, v37
  v_exp_f32 v38, v38
  v_exp_f32 v39, v39
  v_cvt_pk_bf16_f32 v50, v36, v37
  v_cvt_pk_bf16_f32 v51, v38, v39
  v_exp_f32 v40, v40
  v_exp_f32 v41, v41
  v_exp_f32 v42, v42
  v_mfma_f32_32x32x16_bf16 v[56:71], v[200:203], v[48:51], v[56:71]
  v_exp_f32 v43, v43
  v_cvt_pk_bf16_f32 v52, v40, v41
  v_cvt_pk_bf16_f32 v53, v42, v43
  v_exp_f32 v44, v44
  v_exp_f32 v45, v45
  v_exp_f32 v46, v46
  v_exp_f32 v47, v47
  v_cvt_pk_bf16_f32 v54, v44, v45
  v_cvt_pk_bf16_f32 v55, v46, v47
  v_mfma_f32_32x32x16_bf16 v[32:47], a[252:255], v[88:91], 0
  s_add_u32 s53, s12, 7
  v_exp_f32 v16, v16
  v_exp_f32 v17, v17
  v_exp_f32 v18, v18
  v_exp_f32 v19, v19
  v_cvt_pk_bf16_f32 v48, v16, v17
  v_cvt_pk_bf16_f32 v49, v18, v19
  v_exp_f32 v20, v20
  v_mfma_f32_32x32x16_bf16 v[56:71], v[204:207], v[52:55], v[56:71]
  s_and_b32 s53, s53, 3
  buffer_load_dwordx4 a[124:127], v2, s[4:7], s68 offen offset:3072 sc1
  s_add_u32 s68, s68, 4096
  v_exp_f32 v21, v21
  v_exp_f32 v22, v22
  v_exp_f32 v23, v23
  v_cvt_pk_bf16_f32 v50, v20, v21
  v_cvt_pk_bf16_f32 v51, v22, v23
  v_exp_f32 v24, v24
  v_exp_f32 v25, v25
  v_exp_f32 v26, v26
  v_mfma_f32_32x32x16_bf16 v[56:71], v[208:211], v[48:51], v[56:71]
  s_lshl_b32 s53, s53, 11
  v_exp_f32 v27, v27
  v_cvt_pk_bf16_f32 v52, v24, v25
  v_cvt_pk_bf16_f32 v53, v26, v27
  v_exp_f32 v28, v28
  v_exp_f32 v29, v29
  v_exp_f32 v30, v30
  v_exp_f32 v31, v31
  v_cvt_pk_bf16_f32 v54, v28, v29
  v_cvt_pk_bf16_f32 v55, v30, v31
  v_mfma_f32_32x32x16_bf16 v[16:31], v[224:227], v[92:95], 0
  s_add_u32 s53, s53, s49
  v_exp_f32 v32, v32
  v_exp_f32 v33, v33
  v_exp_f32 v34, v34
  v_exp_f32 v35, v35
  v_cvt_pk_bf16_f32 v48, v32, v33
  v_cvt_pk_bf16_f32 v49, v34, v35
  v_exp_f32 v36, v36
  v_mfma_f32_32x32x16_bf16 v[56:71], v[212:215], v[52:55], v[56:71]
  buffer_load_dwordx4 a[128:131], v2, s[4:7], s67 offen offset:0 sc1
  buffer_load_dwordx4 a[136:139], v2, s[4:7], s67 offen offset:1024 sc1
  buffer_load_dwordx4 a[144:147], v2, s[4:7], s67 offen offset:2048 sc1
  v_exp_f32 v37, v37
  v_exp_f32 v38, v38
  v_exp_f32 v39, v39
  v_cvt_pk_bf16_f32 v50, v36, v37
  v_cvt_pk_bf16_f32 v51, v38, v39
  v_exp_f32 v40, v40
  v_exp_f32 v41, v41
  v_exp_f32 v42, v42
  v_mfma_f32_32x32x16_bf16 v[56:71], v[216:219], v[48:51], v[56:71]
  v_exp_f32 v43, v43
  v_cvt_pk_bf16_f32 v52, v40, v41
  v_cvt_pk_bf16_f32 v53, v42, v43
  v_exp_f32 v44, v44
  v_exp_f32 v45, v45
  v_exp_f32 v46, v46
  v_exp_f32 v47, v47
  v_cvt_pk_bf16_f32 v54, v44, v45
  v_cvt_pk_bf16_f32 v55, v46, v47
  v_mfma_f32_32x32x16_bf16 v[32:47], v[228:231], v[92:95], 0
  buffer_load_dwordx4 v[88:91], v2, s[4:7], s53 offen sc1
  v_exp_f32 v16, v16
  v_exp_f32 v17, v17
  v_exp_f32 v18, v18
  v_exp_f32 v19, v19
  v_cvt_pk_bf16_f32 v48, v16, v17
  v_cvt_pk_bf16_f32 v49, v18, v19
  v_exp_f32 v20, v20
  v_mfma_f32_32x32x16_bf16 v[56:71], v[220:223], v[52:55], v[56:71]
  v_exp_f32 v21, v21
  v_exp_f32 v22, v22
  v_exp_f32 v23, v23
  v_cvt_pk_bf16_f32 v50, v20, v21
  v_cvt_pk_bf16_f32 v51, v22, v23
  v_exp_f32 v24, v24
  v_exp_f32 v25, v25
  v_exp_f32 v26, v26
  v_mfma_f32_32x32x16_bf16 v[72:87], v[96:99], v[48:51], 0
  v_exp_f32 v27, v27
  v_cvt_pk_bf16_f32 v52, v24, v25
  v_cvt_pk_bf16_f32 v53, v26, v27
  v_exp_f32 v28, v28
  v_exp_f32 v29, v29
  v_exp_f32 v30, v30
  v_exp_f32 v31, v31
  v_cvt_pk_bf16_f32 v54, v28, v29
  v_cvt_pk_bf16_f32 v55, v30, v31
  v_mfma_f32_32x32x16_bf16 v[16:31], v[232:235], v[92:95], 0
  s_add_u32 s53, s12, 5
  v_exp_f32 v32, v32
  v_exp_f32 v33, v33
  v_exp_f32 v34, v34
  v_exp_f32 v35, v35
  v_cvt_pk_bf16_f32 v48, v32, v33
  v_cvt_pk_bf16_f32 v49, v34, v35
  v_exp_f32 v36, v36
  v_mfma_f32_32x32x16_bf16 v[72:87], v[100:103], v[52:55], v[72:87]
  s_and_b32 s53, s53, 3
  buffer_load_dwordx4 a[152:155], v2, s[4:7], s67 offen offset:3072 sc1
  s_add_u32 s67, s67, 4096
  v_exp_f32 v37, v37
  v_exp_f32 v38, v38
  v_exp_f32 v39, v39
  v_cvt_pk_bf16_f32 v50, v36, v37
  v_cvt_pk_bf16_f32 v51, v38, v39
  v_exp_f32 v40, v40
  v_exp_f32 v41, v41
  v_exp_f32 v42, v42
  v_mfma_f32_32x32x16_bf16 v[72:87], v[104:107], v[48:51], v[72:87]
  s_mul_i32 s53, s53, 13824
  v_exp_f32 v43, v43
  v_cvt_pk_bf16_f32 v52, v40, v41
  v_cvt_pk_bf16_f32 v53, v42, v43
  v_exp_f32 v44, v44
  v_exp_f32 v45, v45
  v_exp_f32 v46, v46
  v_exp_f32 v47, v47
  v_cvt_pk_bf16_f32 v54, v44, v45
  v_cvt_pk_bf16_f32 v55, v46, v47
  v_mfma_f32_32x32x16_bf16 v[32:47], v[236:239], v[92:95], 0
  s_add_u32 s53, s53, 112896
  v_exp_f32 v16, v16
  v_exp_f32 v17, v17
  v_exp_f32 v18, v18
  v_exp_f32 v19, v19
  v_cvt_pk_bf16_f32 v48, v16, v17
  v_cvt_pk_bf16_f32 v49, v18, v19
  v_exp_f32 v20, v20
  v_mfma_f32_32x32x16_bf16 v[72:87], v[108:111], v[52:55], v[72:87]
  buffer_load_dwordx4 a[132:135], v2, s[4:7], s68 offen offset:0 sc1
  buffer_load_dwordx4 a[140:143], v2, s[4:7], s68 offen offset:1024 sc1
  buffer_load_dwordx4 a[148:151], v2, s[4:7], s68 offen offset:2048 sc1
  v_exp_f32 v21, v21
  v_exp_f32 v22, v22
  v_exp_f32 v23, v23
  v_cvt_pk_bf16_f32 v50, v20, v21
  v_cvt_pk_bf16_f32 v51, v22, v23
  v_exp_f32 v24, v24
  v_exp_f32 v25, v25
  v_exp_f32 v26, v26
  v_mfma_f32_32x32x16_bf16 v[72:87], v[112:115], v[48:51], v[72:87]
  v_exp_f32 v27, v27
  v_cvt_pk_bf16_f32 v52, v24, v25
  v_cvt_pk_bf16_f32 v53, v26, v27
  v_exp_f32 v28, v28
  v_exp_f32 v29, v29
  v_exp_f32 v30, v30
  v_exp_f32 v31, v31
  v_cvt_pk_bf16_f32 v54, v28, v29
  v_cvt_pk_bf16_f32 v55, v30, v31
  v_mfma_f32_32x32x16_bf16 v[16:31], a[208:211], v[92:95], 0
  v_exp_f32 v32, v32
  v_exp_f32 v33, v33
  v_exp_f32 v34, v34
  v_exp_f32 v35, v35
  v_cvt_pk_bf16_f32 v48, v32, v33
  v_cvt_pk_bf16_f32 v49, v34, v35
  v_exp_f32 v36, v36
  v_mfma_f32_32x32x16_bf16 v[72:87], v[116:119], v[52:55], v[72:87]
  v_exp_f32 v37, v37
  v_exp_f32 v38, v38
  v_exp_f32 v39, v39
  v_cvt_pk_bf16_f32 v50, v36, v37
  v_cvt_pk_bf16_f32 v51, v38, v39
  v_exp_f32 v40, v40
  v_exp_f32 v41, v41
  v_exp_f32 v42, v42
  v_mfma_f32_32x32x16_bf16 v[72:87], v[120:123], v[48:51], v[72:87]
  v_exp_f32 v43, v43
  v_cvt_pk_bf16_f32 v52, v40, v41
  v_cvt_pk_bf16_f32 v53, v42, v43
  v_exp_f32 v44, v44
  v_exp_f32 v45, v45
  v_add_u32 v7, s53, v2
  v_add_u32 v252, s53, v3
  ds_write_b128 v7, v[56:59]
  ds_write_b128 v7, v[60:63] offset:1024
  ds_write_b32 v252, v64 offset:2048
  v_exp_f32 v46, v46
  v_exp_f32 v47, v47
  v_cvt_pk_bf16_f32 v54, v44, v45
  v_cvt_pk_bf16_f32 v55, v46, v47
  v_mfma_f32_32x32x16_bf16 v[32:47], a[212:215], v[92:95], 0
  v_exp_f32 v16, v16
  v_exp_f32 v17, v17
  v_exp_f32 v18, v18
  v_exp_f32 v19, v19
  v_cvt_pk_bf16_f32 v48, v16, v17
  v_cvt_pk_bf16_f32 v49, v18, v19
  v_exp_f32 v20, v20
  v_mfma_f32_32x32x16_bf16 v[72:87], v[124:127], v[52:55], v[72:87]
  buffer_load_dwordx4 a[156:159], v2, s[4:7], s68 offen offset:3072 sc1
  s_add_u32 s68, s68, 4096
  v_exp_f32 v21, v21
  v_exp_f32 v22, v22
  v_exp_f32 v23, v23
  v_cvt_pk_bf16_f32 v50, v20, v21
  v_cvt_pk_bf16_f32 v51, v22, v23
  v_exp_f32 v24, v24
  v_exp_f32 v25, v25
  v_exp_f32 v26, v26
  v_mfma_f32_32x32x16_bf16 v[72:87], v[128:131], v[48:51], v[72:87]
  v_exp_f32 v27, v27
  v_cvt_pk_bf16_f32 v52, v24, v25
  v_cvt_pk_bf16_f32 v53, v26, v27
  v_exp_f32 v28, v28
  v_exp_f32 v29, v29
  v_exp_f32 v30, v30
  v_exp_f32 v31, v31
  v_cvt_pk_bf16_f32 v54, v28, v29
  v_cvt_pk_bf16_f32 v55, v30, v31
  v_mfma_f32_32x32x16_bf16 v[16:31], a[216:219], v[92:95], 0
  v_exp_f32 v32, v32
  v_exp_f32 v33, v33
  v_exp_f32 v34, v34
  v_exp_f32 v35, v35
  v_cvt_pk_bf16_f32 v48, v32, v33
  v_cvt_pk_bf16_f32 v49, v34, v35
  v_exp_f32 v36, v36
  v_mfma_f32_32x32x16_bf16 v[72:87], v[132:135], v[52:55], v[72:87]
  buffer_load_dwordx4 a[160:163], v2, s[4:7], s67 offen offset:0 sc1
  buffer_load_dwordx4 a[168:171], v2, s[4:7], s67 offen offset:1024 sc1
  buffer_load_dwordx4 a[176:179], v2, s[4:7], s67 offen offset:2048 sc1
  v_exp_f32 v37, v37
  v_exp_f32 v38, v38
  v_exp_f32 v39, v39
  v_cvt_pk_bf16_f32 v50, v36, v37
  v_cvt_pk_bf16_f32 v51, v38, v39
  v_exp_f32 v40, v40
  v_exp_f32 v41, v41
  v_exp_f32 v42, v42
  v_mfma_f32_32x32x16_bf16 v[72:87], v[136:139], v[48:51], v[72:87]
  v_exp_f32 v43, v43
  v_cvt_pk_bf16_f32 v52, v40, v41
  v_cvt_pk_bf16_f32 v53, v42, v43
  v_exp_f32 v44, v44
  v_exp_f32 v45, v45
  v_exp_f32 v46, v46
  v_exp_f32 v47, v47
  v_cvt_pk_bf16_f32 v54, v44, v45
  v_cvt_pk_bf16_f32 v55, v46, v47
  v_mfma_f32_32x32x16_bf16 v[32:47], a[220:223], v[92:95], 0
  v_exp_f32 v16, v16
  v_exp_f32 v17, v17
  v_exp_f32 v18, v18
  v_exp_f32 v19, v19
  v_cvt_pk_bf16_f32 v48, v16, v17
  v_cvt_pk_bf16_f32 v49, v18, v19
  v_exp_f32 v20, v20
  v_mfma_f32_32x32x16_bf16 v[72:87], v[140:143], v[52:55], v[72:87]
  buffer_load_dwordx4 a[184:187], v2, s[4:7], s67 offen offset:3072 sc1
  s_add_u32 s67, s67, 4096
  v_exp_f32 v21, v21
  v_exp_f32 v22, v22
  v_exp_f32 v23, v23
  v_cvt_pk_bf16_f32 v50, v20, v21
  v_cvt_pk_bf16_f32 v51, v22, v23
  v_exp_f32 v24, v24
  v_exp_f32 v25, v25
  v_exp_f32 v26, v26
  v_mfma_f32_32x32x16_bf16 v[72:87], v[144:147], v[48:51], v[72:87]
  v_exp_f32 v27, v27
  v_cvt_pk_bf16_f32 v52, v24, v25
  v_cvt_pk_bf16_f32 v53, v26, v27
  v_exp_f32 v28, v28
  v_exp_f32 v29, v29
  v_exp_f32 v30, v30
  v_exp_f32 v31, v31
  v_cvt_pk_bf16_f32 v54, v28, v29
  v_cvt_pk_bf16_f32 v55, v30, v31
  v_mfma_f32_32x32x16_bf16 v[16:31], a[224:227], v[92:95], 0
  v_exp_f32 v32, v32
  v_exp_f32 v33, v33
  v_exp_f32 v34, v34
  v_exp_f32 v35, v35
  v_cvt_pk_bf16_f32 v48, v32, v33
  v_cvt_pk_bf16_f32 v49, v34, v35
  v_exp_f32 v36, v36
  v_mfma_f32_32x32x16_bf16 v[72:87], v[148:151], v[52:55], v[72:87]
  buffer_load_dwordx4 a[164:167], v2, s[4:7], s68 offen offset:0 sc1
  buffer_load_dwordx4 a[172:175], v2, s[4:7], s68 offen offset:1024 sc1
  buffer_load_dwordx4 a[180:183], v2, s[4:7], s68 offen offset:2048 sc1
  v_exp_f32 v37, v37
  v_exp_f32 v38, v38
  v_exp_f32 v39, v39
  v_cvt_pk_bf16_f32 v50, v36, v37
  v_cvt_pk_bf16_f32 v51, v38, v39
  v_exp_f32 v40, v40
  v_exp_f32 v41, v41
  v_exp_f32 v42, v42
  v_mfma_f32_32x32x16_bf16 v[72:87], v[152:155], v[48:51], v[72:87]
  v_exp_f32 v43, v43
  v_cvt_pk_bf16_f32 v52, v40, v41
  v_cvt_pk_bf16_f32 v53, v42, v43
  v_exp_f32 v44, v44
  v_exp_f32 v45, v45
  v_exp_f32 v46, v46
  v_exp_f32 v47, v47
  v_cvt_pk_bf16_f32 v54, v44, v45
  v_cvt_pk_bf16_f32 v55, v46, v47
  v_mfma_f32_32x32x16_bf16 v[32:47], a[228:231], v[92:95], 0
  v_exp_f32 v16, v16
  v_exp_f32 v17, v17
  v_exp_f32 v18, v18
  v_exp_f32 v19, v19
  v_cvt_pk_bf16_f32 v48, v16, v17
  v_cvt_pk_bf16_f32 v49, v18, v19
  v_exp_f32 v20, v20
  v_mfma_f32_32x32x16_bf16 v[72:87], v[156:159], v[52:55], v[72:87]
  buffer_load_dwordx4 a[188:191], v2, s[4:7], s68 offen offset:3072 sc1
  s_add_u32 s68, s68, 4096
  v_exp_f32 v21, v21
  v_exp_f32 v22, v22
  v_exp_f32 v23, v23
  v_cvt_pk_bf16_f32 v50, v20, v21
  v_cvt_pk_bf16_f32 v51, v22, v23
  v_exp_f32 v24, v24
  v_exp_f32 v25, v25
  v_exp_f32 v26, v26
  v_mfma_f32_32x32x16_bf16 v[72:87], v[160:163], v[48:51], v[72:87]
  v_exp_f32 v27, v27
  v_cvt_pk_bf16_f32 v52, v24, v25
  v_cvt_pk_bf16_f32 v53, v26, v27
  v_exp_f32 v28, v28
  v_exp_f32 v29, v29
  v_exp_f32 v30, v30
  v_exp_f32 v31, v31
  v_cvt_pk_bf16_f32 v54, v28, v29
  v_cvt_pk_bf16_f32 v55, v30, v31
  v_mfma_f32_32x32x16_bf16 v[16:31], a[232:235], v[92:95], 0
  v_exp_f32 v32, v32
  v_exp_f32 v33, v33
  v_exp_f32 v34, v34
  v_exp_f32 v35, v35
  v_cvt_pk_bf16_f32 v48, v32, v33
  v_cvt_pk_bf16_f32 v49, v34, v35
  v_exp_f32 v36, v36
  v_mfma_f32_32x32x16_bf16 v[72:87], v[164:167], v[52:55], v[72:87]
  buffer_load_dwordx4 a[192:195], v2, s[4:7], s67 offen offset:0 sc1
  buffer_load_dwordx4 a[200:203], v2, s[4:7], s67 offen offset:1024 sc1
  s_add_u32 s67, s67, 4096
  v_exp_f32 v37, v37
  v_exp_f32 v38, v38
  v_exp_f32 v39, v39
  v_cvt_pk_bf16_f32 v50, v36, v37
  v_cvt_pk_bf16_f32 v51, v38, v39
  v_exp_f32 v40, v40
  v_exp_f32 v41, v41
  v_exp_f32 v42, v42
  v_mfma_f32_32x32x16_bf16 v[72:87], v[168:171], v[48:51], v[72:87]
  v_exp_f32 v43, v43
  v_cvt_pk_bf16_f32 v52, v40, v41
  v_cvt_pk_bf16_f32 v53, v42, v43
  v_exp_f32 v44, v44
  v_exp_f32 v45, v45
  v_exp_f32 v46, v46
  v_exp_f32 v47, v47
  v_cvt_pk_bf16_f32 v54, v44, v45
  v_cvt_pk_bf16_f32 v55, v46, v47
  v_mfma_f32_32x32x16_bf16 v[32:47], a[236:239], v[92:95], 0
  v_exp_f32 v16, v16
  v_exp_f32 v17, v17
  v_exp_f32 v18, v18
  v_exp_f32 v19, v19
  v_cvt_pk_bf16_f32 v48, v16, v17
  v_cvt_pk_bf16_f32 v49, v18, v19
  v_exp_f32 v20, v20
  v_mfma_f32_32x32x16_bf16 v[72:87], v[172:175], v[52:55], v[72:87]
  buffer_load_dwordx4 a[196:199], v2, s[4:7], s68 offen offset:0 sc1
  buffer_load_dwordx4 a[204:207], v2, s[4:7], s68 offen offset:1024 sc1
  s_add_u32 s68, s68, 4096
  v_exp_f32 v21, v21
  v_exp_f32 v22, v22
  v_exp_f32 v23, v23
  v_cvt_pk_bf16_f32 v50, v20, v21
  v_cvt_pk_bf16_f32 v51, v22, v23
  v_exp_f32 v24, v24
  v_exp_f32 v25, v25
  v_exp_f32 v26, v26
  v_mfma_f32_32x32x16_bf16 v[72:87], v[176:179], v[48:51], v[72:87]
  v_exp_f32 v27, v27
  v_cvt_pk_bf16_f32 v52, v24, v25
  v_cvt_pk_bf16_f32 v53, v26, v27
  v_exp_f32 v28, v28
  v_exp_f32 v29, v29
  v_exp_f32 v30, v30
  v_exp_f32 v31, v31
  v_cvt_pk_bf16_f32 v54, v28, v29
  v_cvt_pk_bf16_f32 v55, v30, v31
  v_mfma_f32_32x32x16_bf16 v[16:31], a[240:243], v[92:95], 0
  v_exp_f32 v32, v32
  v_exp_f32 v33, v33
  v_exp_f32 v34, v34
  v_exp_f32 v35, v35
  v_cvt_pk_bf16_f32 v48, v32, v33
  v_cvt_pk_bf16_f32 v49, v34, v35
  v_exp_f32 v36, v36
  v_mfma_f32_32x32x16_bf16 v[72:87], v[180:183], v[52:55], v[72:87]
  s_mul_i32 s60, s14, 50688
  s_mul_i32 s61, s12, 12672
  s_add_u32 s60, s60, s61
  s_add_u32 s60, s60, 37748736
  v_lshlrev_b32 v4, 7, v1
  s_add_u32 s61, s60, 4480
  buffer_load_dword v5, v4, s[4:7], s60 offen sc1
  buffer_load_dword v5, v4, s[4:7], s61 offen sc1
  v_exp_f32 v37, v37
  v_exp_f32 v38, v38
  v_exp_f32 v39, v39
  v_cvt_pk_bf16_f32 v50, v36, v37
  v_cvt_pk_bf16_f32 v51, v38, v39
  v_exp_f32 v40, v40
  v_exp_f32 v41, v41
  v_exp_f32 v42, v42
  v_mfma_f32_32x32x16_bf16 v[72:87], v[184:187], v[48:51], v[72:87]
  v_exp_f32 v43, v43
  v_cvt_pk_bf16_f32 v52, v40, v41
  v_cvt_pk_bf16_f32 v53, v42, v43
  v_exp_f32 v44, v44
  v_exp_f32 v45, v45
  v_exp_f32 v46, v46
  v_exp_f32 v47, v47
  v_cvt_pk_bf16_f32 v54, v44, v45
  v_cvt_pk_bf16_f32 v55, v46, v47
  v_mfma_f32_32x32x16_bf16 v[32:47], a[244:247], v[92:95], 0
  v_exp_f32 v16, v16
  v_exp_f32 v17, v17
  v_exp_f32 v18, v18
  v_exp_f32 v19, v19
  v_cvt_pk_bf16_f32 v48, v16, v17
  v_cvt_pk_bf16_f32 v49, v18, v19
  v_exp_f32 v20, v20
  v_mfma_f32_32x32x16_bf16 v[72:87], v[188:191], v[52:55], v[72:87]
  v_exp_f32 v21, v21
  v_exp_f32 v22, v22
  v_exp_f32 v23, v23
  v_cvt_pk_bf16_f32 v50, v20, v21
  v_cvt_pk_bf16_f32 v51, v22, v23
  v_exp_f32 v24, v24
  v_exp_f32 v25, v25
  v_exp_f32 v26, v26
  v_mfma_f32_32x32x16_bf16 v[72:87], v[192:195], v[48:51], v[72:87]
  v_exp_f32 v27, v27
  v_cvt_pk_bf16_f32 v52, v24, v25
  v_cvt_pk_bf16_f32 v53, v26, v27
  v_exp_f32 v28, v28
  v_exp_f32 v29, v29
  v_exp_f32 v30, v30
  v_exp_f32 v31, v31
  v_cvt_pk_bf16_f32 v54, v28, v29
  v_cvt_pk_bf16_f32 v55, v30, v31
  v_mfma_f32_32x32x16_bf16 v[16:31], a[248:251], v[92:95], 0
  v_exp_f32 v32, v32
  v_exp_f32 v33, v33
  v_exp_f32 v34, v34
  v_exp_f32 v35, v35
  v_cvt_pk_bf16_f32 v48, v32, v33
  v_cvt_pk_bf16_f32 v49, v34, v35
  v_exp_f32 v36, v36
  v_mfma_f32_32x32x16_bf16 v[72:87], v[196:199], v[52:55], v[72:87]
  v_exp_f32 v37, v37
  v_exp_f32 v38, v38
  v_exp_f32 v39, v39
  v_cvt_pk_bf16_f32 v50, v36, v37
  v_cvt_pk_bf16_f32 v51, v38, v39
  v_exp_f32 v40, v40
  v_exp_f32 v41, v41
  v_exp_f32 v42, v42
  v_mfma_f32_32x32x16_bf16 v[72:87], v[200:203], v[48:51], v[72:87]
  v_exp_f32 v43, v43
  v_cvt_pk_bf16_f32 v52, v40, v41
  v_cvt_pk_bf16_f32 v53, v42, v43
  v_exp_f32 v44, v44
  v_exp_f32 v45, v45
  v_exp_f32 v46, v46
  v_exp_f32 v47, v47
  v_cvt_pk_bf16_f32 v54, v44, v45
  v_cvt_pk_bf16_f32 v55, v46, v47
  v_mfma_f32_32x32x16_bf16 v[32:47], a[252:255], v[92:95], 0
  s_add_u32 s53, s12, 8
  v_exp_f32 v16, v16
  v_exp_f32 v17, v17
  v_exp_f32 v18, v18
  v_exp_f32 v19, v19
  v_cvt_pk_bf16_f32 v48, v16, v17
  v_cvt_pk_bf16_f32 v49, v18, v19
  v_exp_f32 v20, v20
  v_mfma_f32_32x32x16_bf16 v[72:87], v[204:207], v[52:55], v[72:87]
  s_and_b32 s53, s53, 3
  v_exp_f32 v21, v21
  v_exp_f32 v22, v22
  v_exp_f32 v23, v23
  v_cvt_pk_bf16_f32 v50, v20, v21
  v_cvt_pk_bf16_f32 v51, v22, v23
  v_exp_f32 v24, v24
  v_exp_f32 v25, v25
  v_exp_f32 v26, v26
  v_mfma_f32_32x32x16_bf16 v[72:87], v[208:211], v[48:51], v[72:87]
  s_lshl_b32 s53, s53, 11
  v_exp_f32 v27, v27
  v_cvt_pk_bf16_f32 v52, v24, v25
  v_cvt_pk_bf16_f32 v53, v26, v27
  v_exp_f32 v28, v28
  v_exp_f32 v29, v29
  v_exp_f32 v30, v30
  v_exp_f32 v31, v31
  v_cvt_pk_bf16_f32 v54, v28, v29
  v_cvt_pk_bf16_f32 v55, v30, v31
  s_waitcnt vmcnt(19)
  v_mfma_f32_32x32x16_bf16 v[16:31], v[224:227], v[88:91], 0
  s_add_u32 s53, s53, s49
  v_exp_f32 v32, v32
  v_exp_f32 v33, v33
  v_exp_f32 v34, v34
  v_exp_f32 v35, v35
  v_cvt_pk_bf16_f32 v48, v32, v33
  v_cvt_pk_bf16_f32 v49, v34, v35
  v_exp_f32 v36, v36
  v_mfma_f32_32x32x16_bf16 v[72:87], v[212:215], v[52:55], v[72:87]
  v_exp_f32 v37, v37
  v_exp_f32 v38, v38
  v_exp_f32 v39, v39
  v_cvt_pk_bf16_f32 v50, v36, v37
  v_cvt_pk_bf16_f32 v51, v38, v39
  v_exp_f32 v40, v40
  v_exp_f32 v41, v41
  v_exp_f32 v42, v42
  v_mfma_f32_32x32x16_bf16 v[72:87], v[216:219], v[48:51], v[72:87]
  v_exp_f32 v43, v43
  v_cvt_pk_bf16_f32 v52, v40, v41
  v_cvt_pk_bf16_f32 v53, v42, v43
  v_exp_f32 v44, v44
  v_exp_f32 v45, v45
  v_exp_f32 v46, v46
  v_exp_f32 v47, v47
  v_cvt_pk_bf16_f32 v54, v44, v45
  v_cvt_pk_bf16_f32 v55, v46, v47
  v_mfma_f32_32x32x16_bf16 v[32:47], v[228:231], v[88:91], 0
  buffer_load_dwordx4 v[92:95], v2, s[4:7], s53 offen sc1
  v_exp_f32 v16, v16
  v_exp_f32 v17, v17
  v_exp_f32 v18, v18
  v_exp_f32 v19, v19
  v_cvt_pk_bf16_f32 v48, v16, v17
  v_cvt_pk_bf16_f32 v49, v18, v19
  v_exp_f32 v20, v20
  v_mfma_f32_32x32x16_bf16 v[72:87], v[220:223], v[52:55], v[72:87]
  v_exp_f32 v21, v21
  v_exp_f32 v22, v22
  v_exp_f32 v23, v23
  v_cvt_pk_bf16_f32 v50, v20, v21
  v_cvt_pk_bf16_f32 v51, v22, v23
  v_exp_f32 v24, v24
  v_exp_f32 v25, v25
  v_exp_f32 v26, v26
  v_mfma_f32_32x32x16_bf16 v[56:71], v[96:99], v[48:51], 0
  v_exp_f32 v27, v27
  v_cvt_pk_bf16_f32 v52, v24, v25
  v_cvt_pk_bf16_f32 v53, v26, v27
  v_exp_f32 v28, v28
  v_exp_f32 v29, v29
  v_exp_f32 v30, v30
  v_exp_f32 v31, v31
  v_cvt_pk_bf16_f32 v54, v28, v29
  v_cvt_pk_bf16_f32 v55, v30, v31
  v_mfma_f32_32x32x16_bf16 v[16:31], v[232:235], v[88:91], 0
  s_add_u32 s53, s12, 6
  v_exp_f32 v32, v32
  v_exp_f32 v33, v33
  v_exp_f32 v34, v34
  v_exp_f32 v35, v35
  v_cvt_pk_bf16_f32 v48, v32, v33
  v_cvt_pk_bf16_f32 v49, v34, v35
  v_exp_f32 v36, v36
  v_mfma_f32_32x32x16_bf16 v[56:71], v[100:103], v[52:55], v[56:71]
  s_and_b32 s53, s53, 3
  v_exp_f32 v37, v37
  v_exp_f32 v38, v38
  v_exp_f32 v39, v39
  v_cvt_pk_bf16_f32 v50, v36, v37
  v_cvt_pk_bf16_f32 v51, v38, v39
  v_exp_f32 v40, v40
  v_exp_f32 v41, v41
  v_exp_f32 v42, v42
  v_mfma_f32_32x32x16_bf16 v[56:71], v[104:107], v[48:51], v[56:71]
  s_mul_i32 s53, s53, 13824
  v_exp_f32 v43, v43
  v_cvt_pk_bf16_f32 v52, v40, v41
  v_cvt_pk_bf16_f32 v53, v42, v43
  v_exp_f32 v44, v44
  v_exp_f32 v45, v45
  v_exp_f32 v46, v46
  v_exp_f32 v47, v47
  v_cvt_pk_bf16_f32 v54, v44, v45
  v_cvt_pk_bf16_f32 v55, v46, v47
  v_mfma_f32_32x32x16_bf16 v[32:47], v[236:239], v[88:91], 0
  s_add_u32 s53, s53, 110592
  v_exp_f32 v16, v16
  v_exp_f32 v17, v17
  v_exp_f32 v18, v18
  v_exp_f32 v19, v19
  v_cvt_pk_bf16_f32 v48, v16, v17
  v_cvt_pk_bf16_f32 v49, v18, v19
  v_exp_f32 v20, v20
  v_mfma_f32_32x32x16_bf16 v[56:71], v[108:111], v[52:55], v[56:71]
  v_exp_f32 v21, v21
  v_exp_f32 v22, v22
  v_exp_f32 v23, v23
  v_cvt_pk_bf16_f32 v50, v20, v21
  v_cvt_pk_bf16_f32 v51, v22, v23
  v_exp_f32 v24, v24
  v_exp_f32 v25, v25
  v_exp_f32 v26, v26
  v_mfma_f32_32x32x16_bf16 v[56:71], v[112:115], v[48:51], v[56:71]
  v_exp_f32 v27, v27
  v_cvt_pk_bf16_f32 v52, v24, v25
  v_cvt_pk_bf16_f32 v53, v26, v27
  v_exp_f32 v28, v28
  v_exp_f32 v29, v29
  v_exp_f32 v30, v30
  v_exp_f32 v31, v31
  v_cvt_pk_bf16_f32 v54, v28, v29
  v_cvt_pk_bf16_f32 v55, v30, v31
  v_mfma_f32_32x32x16_bf16 v[16:31], a[208:211], v[88:91], 0
  v_exp_f32 v32, v32
  v_exp_f32 v33, v33
  v_exp_f32 v34, v34
  v_exp_f32 v35, v35
  v_cvt_pk_bf16_f32 v48, v32, v33
  v_cvt_pk_bf16_f32 v49, v34, v35
  v_exp_f32 v36, v36
  v_mfma_f32_32x32x16_bf16 v[56:71], v[116:119], v[52:55], v[56:71]
  v_exp_f32 v37, v37
  v_exp_f32 v38, v38
  v_exp_f32 v39, v39
  v_cvt_pk_bf16_f32 v50, v36, v37
  v_cvt_pk_bf16_f32 v51, v38, v39
  v_exp_f32 v40, v40
  v_exp_f32 v41, v41
  v_exp_f32 v42, v42
  v_mfma_f32_32x32x16_bf16 v[56:71], v[120:123], v[48:51], v[56:71]
  v_exp_f32 v43, v43
  v_cvt_pk_bf16_f32 v52, v40, v41
  v_cvt_pk_bf16_f32 v53, v42, v43
  v_exp_f32 v44, v44
  v_exp_f32 v45, v45
  v_add_u32 v7, s53, v2
  v_add_u32 v252, s53, v3
  ds_write_b128 v7, v[72:75]
  ds_write_b128 v7, v[76:79] offset:1024
  ds_write_b32 v252, v80 offset:2048
  v_exp_f32 v46, v46
  v_exp_f32 v47, v47
  v_cvt_pk_bf16_f32 v54, v44, v45
  v_cvt_pk_bf16_f32 v55, v46, v47
  v_mfma_f32_32x32x16_bf16 v[32:47], a[212:215], v[88:91], 0
  v_exp_f32 v16, v16
  v_exp_f32 v17, v17
  v_exp_f32 v18, v18
  v_exp_f32 v19, v19
  v_cvt_pk_bf16_f32 v48, v16, v17
  v_cvt_pk_bf16_f32 v49, v18, v19
  v_exp_f32 v20, v20
  v_mfma_f32_32x32x16_bf16 v[56:71], v[124:127], v[52:55], v[56:71]
  v_exp_f32 v21, v21
  v_exp_f32 v22, v22
  v_exp_f32 v23, v23
  v_cvt_pk_bf16_f32 v50, v20, v21
  v_cvt_pk_bf16_f32 v51, v22, v23
  v_exp_f32 v24, v24
  v_exp_f32 v25, v25
  v_exp_f32 v26, v26
  v_mfma_f32_32x32x16_bf16 v[56:71], v[128:131], v[48:51], v[56:71]
  v_exp_f32 v27, v27
  v_cvt_pk_bf16_f32 v52, v24, v25
  v_cvt_pk_bf16_f32 v53, v26, v27
  v_exp_f32 v28, v28
  v_exp_f32 v29, v29
  v_exp_f32 v30, v30
  v_exp_f32 v31, v31
  v_cvt_pk_bf16_f32 v54, v28, v29
  v_cvt_pk_bf16_f32 v55, v30, v31
  v_mfma_f32_32x32x16_bf16 v[16:31], a[216:219], v[88:91], 0
  v_exp_f32 v32, v32
  v_exp_f32 v33, v33
  v_exp_f32 v34, v34
  v_exp_f32 v35, v35
  v_cvt_pk_bf16_f32 v48, v32, v33
  v_cvt_pk_bf16_f32 v49, v34, v35
  v_exp_f32 v36, v36
  v_mfma_f32_32x32x16_bf16 v[56:71], v[132:135], v[52:55], v[56:71]
  v_exp_f32 v37, v37
  v_exp_f32 v38, v38
  v_exp_f32 v39, v39
  v_cvt_pk_bf16_f32 v50, v36, v37
  v_cvt_pk_bf16_f32 v51, v38, v39
  v_exp_f32 v40, v40
  v_exp_f32 v41, v41
  v_exp_f32 v42, v42
  v_mfma_f32_32x32x16_bf16 v[56:71], v[136:139], v[48:51], v[56:71]
  v_exp_f32 v43, v43
  v_cvt_pk_bf16_f32 v52, v40, v41
  v_cvt_pk_bf16_f32 v53, v42, v43
  v_exp_f32 v44, v44
  v_exp_f32 v45, v45
  v_exp_f32 v46, v46
  v_exp_f32 v47, v47
  v_cvt_pk_bf16_f32 v54, v44, v45
  v_cvt_pk_bf16_f32 v55, v46, v47
  v_mfma_f32_32x32x16_bf16 v[32:47], a[220:223], v[88:91], 0
  v_exp_f32 v16, v16
  v_exp_f32 v17, v17
  v_exp_f32 v18, v18
  v_exp_f32 v19, v19
  v_cvt_pk_bf16_f32 v48, v16, v17
  v_cvt_pk_bf16_f32 v49, v18, v19
  v_exp_f32 v20, v20
  v_mfma_f32_32x32x16_bf16 v[56:71], v[140:143], v[52:55], v[56:71]
  v_exp_f32 v21, v21
  v_exp_f32 v22, v22
  v_exp_f32 v23, v23
  v_cvt_pk_bf16_f32 v50, v20, v21
  v_cvt_pk_bf16_f32 v51, v22, v23
  v_exp_f32 v24, v24
  v_exp_f32 v25, v25
  v_exp_f32 v26, v26
  v_mfma_f32_32x32x16_bf16 v[56:71], v[144:147], v[48:51], v[56:71]
  v_exp_f32 v27, v27
  v_cvt_pk_bf16_f32 v52, v24, v25
  v_cvt_pk_bf16_f32 v53, v26, v27
  v_exp_f32 v28, v28
  v_exp_f32 v29, v29
  v_exp_f32 v30, v30
  v_exp_f32 v31, v31
  v_cvt_pk_bf16_f32 v54, v28, v29
  v_cvt_pk_bf16_f32 v55, v30, v31
  v_mfma_f32_32x32x16_bf16 v[16:31], a[224:227], v[88:91], 0
  v_exp_f32 v32, v32
  v_exp_f32 v33, v33
  v_exp_f32 v34, v34
  v_exp_f32 v35, v35
  v_cvt_pk_bf16_f32 v48, v32, v33
  v_cvt_pk_bf16_f32 v49, v34, v35
  v_exp_f32 v36, v36
  v_mfma_f32_32x32x16_bf16 v[56:71], v[148:151], v[52:55], v[56:71]
  v_exp_f32 v37, v37
  v_exp_f32 v38, v38
  v_exp_f32 v39, v39
  v_cvt_pk_bf16_f32 v50, v36, v37
  v_cvt_pk_bf16_f32 v51, v38, v39
  v_exp_f32 v40, v40
  v_exp_f32 v41, v41
  v_exp_f32 v42, v42
  v_mfma_f32_32x32x16_bf16 v[56:71], v[152:155], v[48:51], v[56:71]
  v_exp_f32 v43, v43
  v_cvt_pk_bf16_f32 v52, v40, v41
  v_cvt_pk_bf16_f32 v53, v42, v43
  v_exp_f32 v44, v44
  v_exp_f32 v45, v45
  v_exp_f32 v46, v46
  v_exp_f32 v47, v47
  v_cvt_pk_bf16_f32 v54, v44, v45
  v_cvt_pk_bf16_f32 v55, v46, v47
  v_mfma_f32_32x32x16_bf16 v[32:47], a[228:231], v[88:91], 0
  v_exp_f32 v16, v16
  v_exp_f32 v17, v17
  v_exp_f32 v18, v18
  v_exp_f32 v19, v19
  v_cvt_pk_bf16_f32 v48, v16, v17
  v_cvt_pk_bf16_f32 v49, v18, v19
  v_exp_f32 v20, v20
  v_mfma_f32_32x32x16_bf16 v[56:71], v[156:159], v[52:55], v[56:71]
  v_exp_f32 v21, v21
  v_exp_f32 v22, v22
  v_exp_f32 v23, v23
  v_cvt_pk_bf16_f32 v50, v20, v21
  v_cvt_pk_bf16_f32 v51, v22, v23
  v_exp_f32 v24, v24
  v_exp_f32 v25, v25
  v_exp_f32 v26, v26
  v_mfma_f32_32x32x16_bf16 v[56:71], v[160:163], v[48:51], v[56:71]
  v_exp_f32 v27, v27
  v_cvt_pk_bf16_f32 v52, v24, v25
  v_cvt_pk_bf16_f32 v53, v26, v27
  v_exp_f32 v28, v28
  v_exp_f32 v29, v29
  v_exp_f32 v30, v30
  v_exp_f32 v31, v31
  v_cvt_pk_bf16_f32 v54, v28, v29
  v_cvt_pk_bf16_f32 v55, v30, v31
  v_mfma_f32_32x32x16_bf16 v[16:31], a[232:235], v[88:91], 0
  v_exp_f32 v32, v32
  v_exp_f32 v33, v33
  v_exp_f32 v34, v34
  v_exp_f32 v35, v35
  v_cvt_pk_bf16_f32 v48, v32, v33
  v_cvt_pk_bf16_f32 v49, v34, v35
  v_exp_f32 v36, v36
  v_mfma_f32_32x32x16_bf16 v[56:71], v[164:167], v[52:55], v[56:71]
  v_exp_f32 v37, v37
  v_exp_f32 v38, v38
  v_exp_f32 v39, v39
  v_cvt_pk_bf16_f32 v50, v36, v37
  v_cvt_pk_bf16_f32 v51, v38, v39
  v_exp_f32 v40, v40
  v_exp_f32 v41, v41
  v_exp_f32 v42, v42
  v_mfma_f32_32x32x16_bf16 v[56:71], v[168:171], v[48:51], v[56:71]
  v_exp_f32 v43, v43
  v_cvt_pk_bf16_f32 v52, v40, v41
  v_cvt_pk_bf16_f32 v53, v42, v43
  v_exp_f32 v44, v44
  v_exp_f32 v45, v45
  v_exp_f32 v46, v46
  v_exp_f32 v47, v47
  v_cvt_pk_bf16_f32 v54, v44, v45
  v_cvt_pk_bf16_f32 v55, v46, v47
  v_mfma_f32_32x32x16_bf16 v[32:47], a[236:239], v[88:91], 0
  v_exp_f32 v16, v16
  v_exp_f32 v17, v17
  v_exp_f32 v18, v18
  v_exp_f32 v19, v19
  v_cvt_pk_bf16_f32 v48, v16, v17
  v_cvt_pk_bf16_f32 v49, v18, v19
  v_exp_f32 v20, v20
  v_mfma_f32_32x32x16_bf16 v[56:71], v[172:175], v[52:55], v[56:71]
  v_exp_f32 v21, v21
  v_exp_f32 v22, v22
  v_exp_f32 v23, v23
  v_cvt_pk_bf16_f32 v50, v20, v21
  v_cvt_pk_bf16_f32 v51, v22, v23
  v_exp_f32 v24, v24
  v_exp_f32 v25, v25
  v_exp_f32 v26, v26
  v_mfma_f32_32x32x16_bf16 v[56:71], v[176:179], v[48:51], v[56:71]
  v_exp_f32 v27, v27
  v_cvt_pk_bf16_f32 v52, v24, v25
  v_cvt_pk_bf16_f32 v53, v26, v27
  v_exp_f32 v28, v28
  v_exp_f32 v29, v29
  v_exp_f32 v30, v30
  v_exp_f32 v31, v31
  v_cvt_pk_bf16_f32 v54, v28, v29
  v_cvt_pk_bf16_f32 v55, v30, v31
  v_mfma_f32_32x32x16_bf16 v[16:31], a[240:243], v[88:91], 0
  v_exp_f32 v32, v32
  v_exp_f32 v33, v33
  v_exp_f32 v34, v34
  v_exp_f32 v35, v35
  v_cvt_pk_bf16_f32 v48, v32, v33
  v_cvt_pk_bf16_f32 v49, v34, v35
  v_exp_f32 v36, v36
  v_mfma_f32_32x32x16_bf16 v[56:71], v[180:183], v[52:55], v[56:71]
  v_exp_f32 v37, v37
  v_exp_f32 v38, v38
  v_exp_f32 v39, v39
  v_cvt_pk_bf16_f32 v50, v36, v37
  v_cvt_pk_bf16_f32 v51, v38, v39
  v_exp_f32 v40, v40
  v_exp_f32 v41, v41
  v_exp_f32 v42, v42
  v_mfma_f32_32x32x16_bf16 v[56:71], v[184:187], v[48:51], v[56:71]
  v_exp_f32 v43, v43
  v_cvt_pk_bf16_f32 v52, v40, v41
  v_cvt_pk_bf16_f32 v53, v42, v43
  v_exp_f32 v44, v44
  v_exp_f32 v45, v45
  v_exp_f32 v46, v46
  v_exp_f32 v47, v47
  v_cvt_pk_bf16_f32 v54, v44, v45
  v_cvt_pk_bf16_f32 v55, v46, v47
  v_mfma_f32_32x32x16_bf16 v[32:47], a[244:247], v[88:91], 0
  v_exp_f32 v16, v16
  v_exp_f32 v17, v17
  v_exp_f32 v18, v18
  v_exp_f32 v19, v19
  v_cvt_pk_bf16_f32 v48, v16, v17
  v_cvt_pk_bf16_f32 v49, v18, v19
  v_exp_f32 v20, v20
  v_mfma_f32_32x32x16_bf16 v[56:71], v[188:191], v[52:55], v[56:71]
  v_exp_f32 v21, v21
  v_exp_f32 v22, v22
  v_exp_f32 v23, v23
  v_cvt_pk_bf16_f32 v50, v20, v21
  v_cvt_pk_bf16_f32 v51, v22, v23
  v_exp_f32 v24, v24
  v_exp_f32 v25, v25
  v_exp_f32 v26, v26
  v_mfma_f32_32x32x16_bf16 v[56:71], v[192:195], v[48:51], v[56:71]
  v_exp_f32 v27, v27
  v_cvt_pk_bf16_f32 v52, v24, v25
  v_cvt_pk_bf16_f32 v53, v26, v27
  v_exp_f32 v28, v28
  v_exp_f32 v29, v29
  v_exp_f32 v30, v30
  v_exp_f32 v31, v31
  v_cvt_pk_bf16_f32 v54, v28, v29
  v_cvt_pk_bf16_f32 v55, v30, v31
  v_mfma_f32_32x32x16_bf16 v[16:31], a[248:251], v[88:91], 0
  v_exp_f32 v32, v32
  v_exp_f32 v33, v33
  v_exp_f32 v34, v34
  v_exp_f32 v35, v35
  v_cvt_pk_bf16_f32 v48, v32, v33
  v_cvt_pk_bf16_f32 v49, v34, v35
  v_exp_f32 v36, v36
  v_mfma_f32_32x32x16_bf16 v[56:71], v[196:199], v[52:55], v[56:71]
  v_exp_f32 v37, v37
  v_exp_f32 v38, v38
  v_exp_f32 v39, v39
  v_cvt_pk_bf16_f32 v50, v36, v37
  v_cvt_pk_bf16_f32 v51, v38, v39
  v_exp_f32 v40, v40
  v_exp_f32 v41, v41
  v_exp_f32 v42, v42
  v_mfma_f32_32x32x16_bf16 v[56:71], v[200:203], v[48:51], v[56:71]
  v_exp_f32 v43, v43
  v_cvt_pk_bf16_f32 v52, v40, v41
  v_cvt_pk_bf16_f32 v53, v42, v43
  v_exp_f32 v44, v44
  v_exp_f32 v45, v45
  v_exp_f32 v46, v46
  v_exp_f32 v47, v47
  v_cvt_pk_bf16_f32 v54, v44, v45
  v_cvt_pk_bf16_f32 v55, v46, v47
  v_mfma_f32_32x32x16_bf16 v[32:47], a[252:255], v[88:91], 0
  v_exp_f32 v16, v16
  v_exp_f32 v17, v17
  v_exp_f32 v18, v18
  v_exp_f32 v19, v19
  v_cvt_pk_bf16_f32 v48, v16, v17
  v_cvt_pk_bf16_f32 v49, v18, v19
  v_exp_f32 v20, v20
  v_mfma_f32_32x32x16_bf16 v[56:71], v[204:207], v[52:55], v[56:71]
  v_exp_f32 v21, v21
  v_exp_f32 v22, v22
  v_exp_f32 v23, v23
  v_cvt_pk_bf16_f32 v50, v20, v21
  v_cvt_pk_bf16_f32 v51, v22, v23
  v_exp_f32 v24, v24
  v_exp_f32 v25, v25
  v_exp_f32 v26, v26
  v_mfma_f32_32x32x16_bf16 v[56:71], v[208:211], v[48:51], v[56:71]
  v_exp_f32 v27, v27
  v_cvt_pk_bf16_f32 v52, v24, v25
  v_cvt_pk_bf16_f32 v53, v26, v27
  v_exp_f32 v28, v28
  v_exp_f32 v29, v29
  v_exp_f32 v30, v30
  v_exp_f32 v31, v31
  v_cvt_pk_bf16_f32 v54, v28, v29
  v_cvt_pk_bf16_f32 v55, v30, v31
  s_waitcnt vmcnt(0)
  v_mfma_f32_32x32x16_bf16 v[16:31], v[224:227], v[92:95], 0
  v_exp_f32 v32, v32
  v_exp_f32 v33, v33
  v_exp_f32 v34, v34
  v_exp_f32 v35, v35
  v_cvt_pk_bf16_f32 v48, v32, v33
  v_cvt_pk_bf16_f32 v49, v34, v35
  v_exp_f32 v36, v36
  v_mfma_f32_32x32x16_bf16 v[56:71], v[212:215], v[52:55], v[56:71]
  v_exp_f32 v37, v37
  v_exp_f32 v38, v38
  v_exp_f32 v39, v39
  v_cvt_pk_bf16_f32 v50, v36, v37
  v_cvt_pk_bf16_f32 v51, v38, v39
  v_exp_f32 v40, v40
  v_exp_f32 v41, v41
  v_exp_f32 v42, v42
  v_mfma_f32_32x32x16_bf16 v[56:71], v[216:219], v[48:51], v[56:71]
  v_exp_f32 v43, v43
  v_cvt_pk_bf16_f32 v52, v40, v41
  v_cvt_pk_bf16_f32 v53, v42, v43
  v_exp_f32 v44, v44
  v_exp_f32 v45, v45
  v_exp_f32 v46, v46
  v_exp_f32 v47, v47
  v_cvt_pk_bf16_f32 v54, v44, v45
  v_cvt_pk_bf16_f32 v55, v46, v47
  v_mfma_f32_32x32x16_bf16 v[32:47], v[228:231], v[92:95], 0
  v_exp_f32 v16, v16
  v_exp_f32 v17, v17
  v_exp_f32 v18, v18
  v_exp_f32 v19, v19
  v_cvt_pk_bf16_f32 v48, v16, v17
  v_cvt_pk_bf16_f32 v49, v18, v19
  v_exp_f32 v20, v20
  v_mfma_f32_32x32x16_bf16 v[56:71], v[220:223], v[52:55], v[56:71]
  v_exp_f32 v21, v21
  v_exp_f32 v22, v22
  v_exp_f32 v23, v23
  v_cvt_pk_bf16_f32 v50, v20, v21
  v_cvt_pk_bf16_f32 v51, v22, v23
  v_exp_f32 v24, v24
  v_exp_f32 v25, v25
  v_exp_f32 v26, v26
  v_mfma_f32_32x32x16_bf16 v[72:87], v[96:99], v[48:51], 0
  v_exp_f32 v27, v27
  v_cvt_pk_bf16_f32 v52, v24, v25
  v_cvt_pk_bf16_f32 v53, v26, v27
  v_exp_f32 v28, v28
  v_exp_f32 v29, v29
  v_exp_f32 v30, v30
  v_exp_f32 v31, v31
  v_cvt_pk_bf16_f32 v54, v28, v29
  v_cvt_pk_bf16_f32 v55, v30, v31
  v_mfma_f32_32x32x16_bf16 v[16:31], v[232:235], v[92:95], 0
  s_add_u32 s53, s12, 7
  v_exp_f32 v32, v32
  v_exp_f32 v33, v33
  v_exp_f32 v34, v34
  v_exp_f32 v35, v35
  v_cvt_pk_bf16_f32 v48, v32, v33
  v_cvt_pk_bf16_f32 v49, v34, v35
  v_exp_f32 v36, v36
  v_mfma_f32_32x32x16_bf16 v[72:87], v[100:103], v[52:55], v[72:87]
  s_and_b32 s53, s53, 3
  v_exp_f32 v37, v37
  v_exp_f32 v38, v38
  v_exp_f32 v39, v39
  v_cvt_pk_bf16_f32 v50, v36, v37
  v_cvt_pk_bf16_f32 v51, v38, v39
  v_exp_f32 v40, v40
  v_exp_f32 v41, v41
  v_exp_f32 v42, v42
  v_mfma_f32_32x32x16_bf16 v[72:87], v[104:107], v[48:51], v[72:87]
  s_mul_i32 s53, s53, 13824
  v_exp_f32 v43, v43
  v_cvt_pk_bf16_f32 v52, v40, v41
  v_cvt_pk_bf16_f32 v53, v42, v43
  v_exp_f32 v44, v44
  v_exp_f32 v45, v45
  v_exp_f32 v46, v46
  v_exp_f32 v47, v47
  v_cvt_pk_bf16_f32 v54, v44, v45
  v_cvt_pk_bf16_f32 v55, v46, v47
  v_mfma_f32_32x32x16_bf16 v[32:47], v[236:239], v[92:95], 0
  s_add_u32 s53, s53, 108288
  v_exp_f32 v16, v16
  v_exp_f32 v17, v17
  v_exp_f32 v18, v18
  v_exp_f32 v19, v19
  v_cvt_pk_bf16_f32 v48, v16, v17
  v_cvt_pk_bf16_f32 v49, v18, v19
  v_exp_f32 v20, v20
  v_mfma_f32_32x32x16_bf16 v[72:87], v[108:111], v[52:55], v[72:87]
  v_exp_f32 v21, v21
  v_exp_f32 v22, v22
  v_exp_f32 v23, v23
  v_cvt_pk_bf16_f32 v50, v20, v21
  v_cvt_pk_bf16_f32 v51, v22, v23
  v_exp_f32 v24, v24
  v_exp_f32 v25, v25
  v_exp_f32 v26, v26
  v_mfma_f32_32x32x16_bf16 v[72:87], v[112:115], v[48:51], v[72:87]
  v_exp_f32 v27, v27
  v_cvt_pk_bf16_f32 v52, v24, v25
  v_cvt_pk_bf16_f32 v53, v26, v27
  v_exp_f32 v28, v28
  v_exp_f32 v29, v29
  v_exp_f32 v30, v30
  v_exp_f32 v31, v31
  v_cvt_pk_bf16_f32 v54, v28, v29
  v_cvt_pk_bf16_f32 v55, v30, v31
  v_mfma_f32_32x32x16_bf16 v[16:31], a[208:211], v[92:95], 0
  v_exp_f32 v32, v32
  v_exp_f32 v33, v33
  v_exp_f32 v34, v34
  v_exp_f32 v35, v35
  v_cvt_pk_bf16_f32 v48, v32, v33
  v_cvt_pk_bf16_f32 v49, v34, v35
  v_exp_f32 v36, v36
  v_mfma_f32_32x32x16_bf16 v[72:87], v[116:119], v[52:55], v[72:87]
  v_exp_f32 v37, v37
  v_exp_f32 v38, v38
  v_exp_f32 v39, v39
  v_cvt_pk_bf16_f32 v50, v36, v37
  v_cvt_pk_bf16_f32 v51, v38, v39
  v_exp_f32 v40, v40
  v_exp_f32 v41, v41
  v_exp_f32 v42, v42
  v_mfma_f32_32x32x16_bf16 v[72:87], v[120:123], v[48:51], v[72:87]
  v_exp_f32 v43, v43
  v_cvt_pk_bf16_f32 v52, v40, v41
  v_cvt_pk_bf16_f32 v53, v42, v43
  v_exp_f32 v44, v44
  v_exp_f32 v45, v45
  v_add_u32 v7, s53, v2
  v_add_u32 v252, s53, v3
  ds_write_b128 v7, v[56:59]
  ds_write_b128 v7, v[60:63] offset:1024
  ds_write_b32 v252, v64 offset:2048
  v_exp_f32 v46, v46
  v_exp_f32 v47, v47
  v_cvt_pk_bf16_f32 v54, v44, v45
  v_cvt_pk_bf16_f32 v55, v46, v47
  v_mfma_f32_32x32x16_bf16 v[32:47], a[212:215], v[92:95], 0
  v_exp_f32 v16, v16
  v_exp_f32 v17, v17
  v_exp_f32 v18, v18
  v_exp_f32 v19, v19
  v_cvt_pk_bf16_f32 v48, v16, v17
  v_cvt_pk_bf16_f32 v49, v18, v19
  v_exp_f32 v20, v20
  v_mfma_f32_32x32x16_bf16 v[72:87], v[124:127], v[52:55], v[72:87]
  v_exp_f32 v21, v21
  v_exp_f32 v22, v22
  v_exp_f32 v23, v23
  v_cvt_pk_bf16_f32 v50, v20, v21
  v_cvt_pk_bf16_f32 v51, v22, v23
  v_exp_f32 v24, v24
  v_exp_f32 v25, v25
  v_exp_f32 v26, v26
  v_mfma_f32_32x32x16_bf16 v[72:87], v[128:131], v[48:51], v[72:87]
  v_exp_f32 v27, v27
  v_cvt_pk_bf16_f32 v52, v24, v25
  v_cvt_pk_bf16_f32 v53, v26, v27
  v_exp_f32 v28, v28
  v_exp_f32 v29, v29
  v_exp_f32 v30, v30
  v_exp_f32 v31, v31
  v_cvt_pk_bf16_f32 v54, v28, v29
  v_cvt_pk_bf16_f32 v55, v30, v31
  v_mfma_f32_32x32x16_bf16 v[16:31], a[216:219], v[92:95], 0
  v_exp_f32 v32, v32
  v_exp_f32 v33, v33
  v_exp_f32 v34, v34
  v_exp_f32 v35, v35
  v_cvt_pk_bf16_f32 v48, v32, v33
  v_cvt_pk_bf16_f32 v49, v34, v35
  v_exp_f32 v36, v36
  v_mfma_f32_32x32x16_bf16 v[72:87], v[132:135], v[52:55], v[72:87]
  v_exp_f32 v37, v37
  v_exp_f32 v38, v38
  v_exp_f32 v39, v39
  v_cvt_pk_bf16_f32 v50, v36, v37
  v_cvt_pk_bf16_f32 v51, v38, v39
  v_exp_f32 v40, v40
  v_exp_f32 v41, v41
  v_exp_f32 v42, v42
  v_mfma_f32_32x32x16_bf16 v[72:87], v[136:139], v[48:51], v[72:87]
  v_exp_f32 v43, v43
  v_cvt_pk_bf16_f32 v52, v40, v41
  v_cvt_pk_bf16_f32 v53, v42, v43
  v_exp_f32 v44, v44
  v_exp_f32 v45, v45
  v_exp_f32 v46, v46
  v_exp_f32 v47, v47
  v_cvt_pk_bf16_f32 v54, v44, v45
  v_cvt_pk_bf16_f32 v55, v46, v47
  v_mfma_f32_32x32x16_bf16 v[32:47], a[220:223], v[92:95], 0
  v_exp_f32 v16, v16
  v_exp_f32 v17, v17
  v_exp_f32 v18, v18
  v_exp_f32 v19, v19
  v_cvt_pk_bf16_f32 v48, v16, v17
  v_cvt_pk_bf16_f32 v49, v18, v19
  v_exp_f32 v20, v20
  v_mfma_f32_32x32x16_bf16 v[72:87], v[140:143], v[52:55], v[72:87]
  v_exp_f32 v21, v21
  v_exp_f32 v22, v22
  v_exp_f32 v23, v23
  v_cvt_pk_bf16_f32 v50, v20, v21
  v_cvt_pk_bf16_f32 v51, v22, v23
  v_exp_f32 v24, v24
  v_exp_f32 v25, v25
  v_exp_f32 v26, v26
  v_mfma_f32_32x32x16_bf16 v[72:87], v[144:147], v[48:51], v[72:87]
  v_exp_f32 v27, v27
  v_cvt_pk_bf16_f32 v52, v24, v25
  v_cvt_pk_bf16_f32 v53, v26, v27
  v_exp_f32 v28, v28
  v_exp_f32 v29, v29
  v_exp_f32 v30, v30
  v_exp_f32 v31, v31
  v_cvt_pk_bf16_f32 v54, v28, v29
  v_cvt_pk_bf16_f32 v55, v30, v31
  v_mfma_f32_32x32x16_bf16 v[16:31], a[224:227], v[92:95], 0
  v_exp_f32 v32, v32
  v_exp_f32 v33, v33
  v_exp_f32 v34, v34
  v_exp_f32 v35, v35
  v_cvt_pk_bf16_f32 v48, v32, v33
  v_cvt_pk_bf16_f32 v49, v34, v35
  v_exp_f32 v36, v36
  v_mfma_f32_32x32x16_bf16 v[72:87], v[148:151], v[52:55], v[72:87]
  v_exp_f32 v37, v37
  v_exp_f32 v38, v38
  v_exp_f32 v39, v39
  v_cvt_pk_bf16_f32 v50, v36, v37
  v_cvt_pk_bf16_f32 v51, v38, v39
  v_exp_f32 v40, v40
  v_exp_f32 v41, v41
  v_exp_f32 v42, v42
  v_mfma_f32_32x32x16_bf16 v[72:87], v[152:155], v[48:51], v[72:87]
  v_exp_f32 v43, v43
  v_cvt_pk_bf16_f32 v52, v40, v41
  v_cvt_pk_bf16_f32 v53, v42, v43
  v_exp_f32 v44, v44
  v_exp_f32 v45, v45
  v_exp_f32 v46, v46
  v_exp_f32 v47, v47
  v_cvt_pk_bf16_f32 v54, v44, v45
  v_cvt_pk_bf16_f32 v55, v46, v47
  v_mfma_f32_32x32x16_bf16 v[32:47], a[228:231], v[92:95], 0
  v_exp_f32 v16, v16
  v_exp_f32 v17, v17
  v_exp_f32 v18, v18
  v_exp_f32 v19, v19
  v_cvt_pk_bf16_f32 v48, v16, v17
  v_cvt_pk_bf16_f32 v49, v18, v19
  v_exp_f32 v20, v20
  v_mfma_f32_32x32x16_bf16 v[72:87], v[156:159], v[52:55], v[72:87]
  v_exp_f32 v21, v21
  v_exp_f32 v22, v22
  v_exp_f32 v23, v23
  v_cvt_pk_bf16_f32 v50, v20, v21
  v_cvt_pk_bf16_f32 v51, v22, v23
  v_exp_f32 v24, v24
  v_exp_f32 v25, v25
  v_exp_f32 v26, v26
  v_mfma_f32_32x32x16_bf16 v[72:87], v[160:163], v[48:51], v[72:87]
  v_exp_f32 v27, v27
  v_cvt_pk_bf16_f32 v52, v24, v25
  v_cvt_pk_bf16_f32 v53, v26, v27
  v_exp_f32 v28, v28
  v_exp_f32 v29, v29
  s_waitcnt vmcnt(0) lgkmcnt(0)
  s_barrier
  s_mul_i32 s53, s12, 13824
  s_add_u32 s53, s53, 108288
  v_add_u32 v7, s53, v2
  v_add_u32 v252, s53, v3
  v_exp_f32 v30, v30
  v_exp_f32 v31, v31
  v_cvt_pk_bf16_f32 v54, v28, v29
  v_cvt_pk_bf16_f32 v55, v30, v31
  v_mfma_f32_32x32x16_bf16 v[16:31], a[232:235], v[92:95], 0
  v_exp_f32 v32, v32
  v_exp_f32 v33, v33
  v_exp_f32 v34, v34
  v_exp_f32 v35, v35
  v_cvt_pk_bf16_f32 v48, v32, v33
  v_cvt_pk_bf16_f32 v49, v34, v35
  v_exp_f32 v36, v36
  v_mfma_f32_32x32x16_bf16 v[72:87], v[164:167], v[52:55], v[72:87]
  v_exp_f32 v37, v37
  v_exp_f32 v38, v38
  v_exp_f32 v39, v39
  v_cvt_pk_bf16_f32 v50, v36, v37
  v_cvt_pk_bf16_f32 v51, v38, v39
  v_exp_f32 v40, v40
  v_exp_f32 v41, v41
  v_exp_f32 v42, v42
  v_mfma_f32_32x32x16_bf16 v[72:87], v[168:171], v[48:51], v[72:87]
  v_exp_f32 v43, v43
  v_cvt_pk_bf16_f32 v52, v40, v41
  v_cvt_pk_bf16_f32 v53, v42, v43
  v_exp_f32 v44, v44
  v_exp_f32 v45, v45
  ds_read_b128 v[96:99], v7 offset:0
  ds_read_b128 v[100:103], v7 offset:1024
  ds_read_b32 v104, v252 offset:2048
  v_exp_f32 v46, v46
  v_exp_f32 v47, v47
  v_cvt_pk_bf16_f32 v54, v44, v45
  v_cvt_pk_bf16_f32 v55, v46, v47
  v_mfma_f32_32x32x16_bf16 v[32:47], a[236:239], v[92:95], 0
  s_lshl_b32 s50, s38, 8
  s_add_u32 s50, s50, s28
  s_add_u32 s50, s50, 262144
  v_lshlrev_b32 v4, 8, v1
  s_mov_b64 exec, 255
  buffer_load_dword v5, v4, s[4:7], s50 offen offset:0 sc1
  s_mov_b64 exec, -1
  v_exp_f32 v16, v16
  v_exp_f32 v17, v17
  v_exp_f32 v18, v18
  v_exp_f32 v19, v19
  v_cvt_pk_bf16_f32 v48, v16, v17
  v_cvt_pk_bf16_f32 v49, v18, v19
  v_exp_f32 v20, v20
  v_mfma_f32_32x32x16_bf16 v[72:87], v[172:175], v[52:55], v[72:87]
  v_exp_f32 v21, v21
  v_exp_f32 v22, v22
  v_exp_f32 v23, v23
  v_cvt_pk_bf16_f32 v50, v20, v21
  v_cvt_pk_bf16_f32 v51, v22, v23
  v_exp_f32 v24, v24
  v_exp_f32 v25, v25
  v_exp_f32 v26, v26
  v_mfma_f32_32x32x16_bf16 v[72:87], v[176:179], v[48:51], v[72:87]
  v_exp_f32 v27, v27
  v_cvt_pk_bf16_f32 v52, v24, v25
  v_cvt_pk_bf16_f32 v53, v26, v27
  v_exp_f32 v28, v28
  v_exp_f32 v29, v29
  ds_read_b128 v[108:111], v7 offset:2304
  ds_read_b128 v[112:115], v7 offset:3328
  ds_read_b32 v116, v252 offset:4352
  v_exp_f32 v30, v30
  v_exp_f32 v31, v31
  v_cvt_pk_bf16_f32 v54, v28, v29
  v_cvt_pk_bf16_f32 v55, v30, v31
  v_mfma_f32_32x32x16_bf16 v[16:31], a[240:243], v[92:95], 0
  v_exp_f32 v32, v32
  v_exp_f32 v33, v33
  v_exp_f32 v34, v34
  v_exp_f32 v35, v35
  v_cvt_pk_bf16_f32 v48, v32, v33
  v_cvt_pk_bf16_f32 v49, v34, v35
  v_exp_f32 v36, v36
  v_mfma_f32_32x32x16_bf16 v[72:87], v[180:183], v[52:55], v[72:87]
  v_exp_f32 v37, v37
  v_exp_f32 v38, v38
  v_exp_f32 v39, v39
  v_cvt_pk_bf16_f32 v50, v36, v37
  v_cvt_pk_bf16_f32 v51, v38, v39
  v_exp_f32 v40, v40
  v_exp_f32 v41, v41
  v_exp_f32 v42, v42
  v_mfma_f32_32x32x16_bf16 v[72:87], v[184:187], v[48:51], v[72:87]
  v_exp_f32 v43, v43
  v_cvt_pk_bf16_f32 v52, v40, v41
  v_cvt_pk_bf16_f32 v53, v42, v43
  v_exp_f32 v44, v44
  v_exp_f32 v45, v45
  ds_read_b128 v[120:123], v7 offset:4608
  ds_read_b128 v[124:127], v7 offset:5632
  ds_read_b32 v128, v252 offset:6656
  v_exp_f32 v46, v46
  v_exp_f32 v47, v47
  v_cvt_pk_bf16_f32 v54, v44, v45
  v_cvt_pk_bf16_f32 v55, v46, v47
  v_mfma_f32_32x32x16_bf16 v[32:47], a[244:247], v[92:95], 0
  v_exp_f32 v16, v16
  v_exp_f32 v17, v17
  v_exp_f32 v18, v18
  v_exp_f32 v19, v19
  v_cvt_pk_bf16_f32 v48, v16, v17
  v_cvt_pk_bf16_f32 v49, v18, v19
  v_exp_f32 v20, v20
  v_mfma_f32_32x32x16_bf16 v[72:87], v[188:191], v[52:55], v[72:87]
  v_exp_f32 v21, v21
  v_exp_f32 v22, v22
  v_exp_f32 v23, v23
  v_cvt_pk_bf16_f32 v50, v20, v21
  v_cvt_pk_bf16_f32 v51, v22, v23
  v_exp_f32 v24, v24
  v_exp_f32 v25, v25
  v_exp_f32 v26, v26
  v_mfma_f32_32x32x16_bf16 v[72:87], v[192:195], v[48:51], v[72:87]
  v_exp_f32 v27, v27
  v_cvt_pk_bf16_f32 v52, v24, v25
  v_cvt_pk_bf16_f32 v53, v26, v27
  v_exp_f32 v28, v28
  v_exp_f32 v29, v29
  v_exp_f32 v30, v30
  v_exp_f32 v31, v31
  v_cvt_pk_bf16_f32 v54, v28, v29
  v_cvt_pk_bf16_f32 v55, v30, v31
  v_mfma_f32_32x32x16_bf16 v[16:31], a[248:251], v[92:95], 0
  v_exp_f32 v32, v32
  v_exp_f32 v33, v33
  v_exp_f32 v34, v34
  v_exp_f32 v35, v35
  v_cvt_pk_bf16_f32 v48, v32, v33
  v_cvt_pk_bf16_f32 v49, v34, v35
  v_exp_f32 v36, v36
  v_mfma_f32_32x32x16_bf16 v[72:87], v[196:199], v[52:55], v[72:87]
  v_exp_f32 v37, v37
  v_exp_f32 v38, v38
  v_exp_f32 v39, v39
  v_cvt_pk_bf16_f32 v50, v36, v37
  v_cvt_pk_bf16_f32 v51, v38, v39
  v_exp_f32 v40, v40
  v_exp_f32 v41, v41
  v_exp_f32 v42, v42
  v_mfma_f32_32x32x16_bf16 v[72:87], v[200:203], v[48:51], v[72:87]
  v_exp_f32 v43, v43
  v_cvt_pk_bf16_f32 v52, v40, v41
  v_cvt_pk_bf16_f32 v53, v42, v43
  v_exp_f32 v44, v44
  v_exp_f32 v45, v45
  v_exp_f32 v46, v46
  v_exp_f32 v47, v47
  v_cvt_pk_bf16_f32 v54, v44, v45
  v_cvt_pk_bf16_f32 v55, v46, v47
  v_mfma_f32_32x32x16_bf16 v[32:47], a[252:255], v[92:95], 0
  v_exp_f32 v16, v16
  v_exp_f32 v17, v17
  v_exp_f32 v18, v18
  v_exp_f32 v19, v19
  v_cvt_pk_bf16_f32 v48, v16, v17
  v_cvt_pk_bf16_f32 v49, v18, v19
  v_exp_f32 v20, v20
  v_mfma_f32_32x32x16_bf16 v[72:87], v[204:207], v[52:55], v[72:87]
  v_exp_f32 v21, v21
  v_exp_f32 v22, v22
  v_exp_f32 v23, v23
  v_cvt_pk_bf16_f32 v50, v20, v21
  v_cvt_pk_bf16_f32 v51, v22, v23
  v_exp_f32 v24, v24
  v_exp_f32 v25, v25
  v_exp_f32 v26, v26
  v_mfma_f32_32x32x16_bf16 v[72:87], v[208:211], v[48:51], v[72:87]
  v_exp_f32 v27, v27
  v_cvt_pk_bf16_f32 v52, v24, v25
  v_cvt_pk_bf16_f32 v53, v26, v27
  v_exp_f32 v28, v28
  v_exp_f32 v29, v29
  v_exp_f32 v30, v30
  v_exp_f32 v31, v31
  v_cvt_pk_bf16_f32 v54, v28, v29
  v_cvt_pk_bf16_f32 v55, v30, v31
  v_exp_f32 v32, v32
  v_exp_f32 v33, v33
  v_exp_f32 v34, v34
  v_exp_f32 v35, v35
  v_cvt_pk_bf16_f32 v48, v32, v33
  v_cvt_pk_bf16_f32 v49, v34, v35
  v_exp_f32 v36, v36
  v_mfma_f32_32x32x16_bf16 v[72:87], v[212:215], v[52:55], v[72:87]
  v_exp_f32 v37, v37
  v_exp_f32 v38, v38
  v_exp_f32 v39, v39
  v_cvt_pk_bf16_f32 v50, v36, v37
  v_cvt_pk_bf16_f32 v51, v38, v39
  v_exp_f32 v40, v40
  v_exp_f32 v41, v41
  v_exp_f32 v42, v42
  v_mfma_f32_32x32x16_bf16 v[72:87], v[216:219], v[48:51], v[72:87]
  v_exp_f32 v43, v43
  v_cvt_pk_bf16_f32 v52, v40, v41
  v_cvt_pk_bf16_f32 v53, v42, v43
  v_exp_f32 v44, v44
  v_exp_f32 v45, v45
  v_exp_f32 v46, v46
  v_exp_f32 v47, v47
  v_cvt_pk_bf16_f32 v54, v44, v45
  v_cvt_pk_bf16_f32 v55, v46, v47
  s_nop 1
  v_mfma_f32_32x32x16_bf16 v[72:87], v[220:223], v[52:55], v[72:87]
  s_waitcnt lgkmcnt(0)
  s_add_u32 s55, s39, 32768
  s_mov_b32 s43, 1
  s_lshl_b32 s42, s37, 8
  s_add_u32 s42, s42, s28
  s_add_u32 s42, s42, 270336
  s_mov_b32 s69, -1
  s_mov_b32 s97, 0
  s_nop 3
  v_pk_add_f32 v[72:73], v[72:73], v[96:97]
  v_pk_add_f32 v[74:75], v[74:75], v[98:99]
  v_pk_add_f32 v[76:77], v[76:77], v[100:101]
  v_pk_add_f32 v[78:79], v[78:79], v[102:103]
  v_add_f32 v80, v80, v104
  v_pk_add_f32 v[72:73], v[72:73], v[108:109]
  v_pk_add_f32 v[74:75], v[74:75], v[110:111]
  v_pk_add_f32 v[76:77], v[76:77], v[112:113]
  v_pk_add_f32 v[78:79], v[78:79], v[114:115]
  v_add_f32 v80, v80, v116
  v_pk_add_f32 v[72:73], v[72:73], v[120:121]
  v_pk_add_f32 v[74:75], v[74:75], v[122:123]
  v_pk_add_f32 v[76:77], v[76:77], v[124:125]
  v_pk_add_f32 v[78:79], v[78:79], v[126:127]
  v_add_f32 v80, v80, v128
  v_add_f32 v16, abs(v72), abs(v73)
  v_add_f32 v17, abs(v74), abs(v75)
  v_add_f32 v18, abs(v76), abs(v77)
  v_add_f32 v19, abs(v78), abs(v79)
  v_add_f32 v16, v16, v17
  v_add_f32 v18, v18, v19
  v_add_f32 v16, v16, v18
  v_cmp_gt_f32 s[70:71], s57, v16
  v_cmp_gt_f32 s[72:73], s57, v80
  v_cmp_lt_f32 s[74:75], s56, v80
  s_and_b64 s[70:71], s[70:71], s[72:73]
  s_and_b64 s[70:71], s[70:71], s[74:75]
  s_cmp_eq_u64 s[70:71], -1
  s_cbranch_scc1 attn_fin
attn_slow:
  s_lshl_b32 s53, s12, 11
  s_lshl_b32 s54, s43, 10
  s_add_u32 s53, s53, s54
  s_add_u32 s53, s53, s48
  buffer_load_dwordx4 v[88:91], v2, s[4:7], s53 offen sc1
  v_and_b32 v34, 27, v1
  v_cmp_eq_u32 vcc, 16, v34
  v_mov_b32 v35, 0x3f803f80
  s_nop 0
  v_cndmask_b32 v34, 0, v35, vcc
  v_mov_b32 v228, v34
  v_mov_b32 v229, v34
  v_mov_b32 v230, v34
  v_mov_b32 v231, v34
  v_mov_b32 v232, v34
  v_mov_b32 v233, v34
  v_mov_b32 v234, v34
  v_mov_b32 v235, v34
  v_mov_b32 v32, 0xff61b1e6
  v_mov_b32 v72, 0
  v_mov_b32 v73, 0
  v_mov_b32 v74, 0
  v_mov_b32 v75, 0
  v_mov_b32 v76, 0
  v_mov_b32 v77, 0
  v_mov_b32 v78, 0
  v_mov_b32 v79, 0
  v_mov_b32 v80, 0
  v_mov_b32 v81, 0
  v_mov_b32 v82, 0
  v_mov_b32 v83, 0
  v_mov_b32 v84, 0
  v_mov_b32 v85, 0
  v_mov_b32 v86, 0
  v_mov_b32 v87, 0
  s_add_u32 s46, s44, 4194304
  s_add_u32 s47, s44, 8388608
  s_mov_b32 s54, 64
attn_slow_loop:
  buffer_load_dwordx4 v[224:227], v2, s[4:7], s46 offen sc1
  s_mov_b64 exec, s[30:31]
  buffer_load_dwordx4 v[228:231], v6, s[4:7], s47 offen sc1
  buffer_load_dwordx4 v[232:235], v6, s[4:7], s47 offen offset:512 sc1
  s_mov_b64 exec, -1
  s_add_u32 s46, s46, 1024
  s_add_u32 s47, s47, 1024
  s_waitcnt vmcnt(0)
  v_mfma_f32_32x32x16_bf16 v[16:31], v[224:227], v[88:91], 0
  s_nop 11
  v_max3_f32 v34, v16, v17, v32
  v_max3_f32 v34, v18, v19, v34
  v_max3_f32 v34, v20, v21, v34
  v_max3_f32 v34, v22, v23, v34
  v_max3_f32 v34, v24, v25, v34
  v_max3_f32 v34, v26, v27, v34
  v_max3_f32 v34, v28, v29, v34
  v_max3_f32 v34, v30, v31, v34
  v_mov_b32 v35, v34
  s_nop 1
  v_permlane32_swap_b32 v34, v35
  v_max_f32 v34, v34, v35
  v_sub_f32 v33, v32, v34
  v_exp_f32 v33, v33
  v_mov_b32 v32, v34
  v_sub_f32 v16, v16, v32
  v_exp_f32 v16, v16
  v_sub_f32 v17, v17, v32
  v_exp_f32 v17, v17
  v_sub_f32 v18, v18, v32
  v_exp_f32 v18, v18
  v_sub_f32 v19, v19, v32
  v_exp_f32 v19, v19
  v_sub_f32 v20, v20, v32
  v_exp_f32 v20, v20
  v_sub_f32 v21, v21, v32
  v_exp_f32 v21, v21
  v_sub_f32 v22, v22, v32
  v_exp_f32 v22, v22
  v_sub_f32 v23, v23, v32
  v_exp_f32 v23, v23
  v_sub_f32 v24, v24, v32
  v_exp_f32 v24, v24
  v_sub_f32 v25, v25, v32
  v_exp_f32 v25, v25
  v_sub_f32 v26, v26, v32
  v_exp_f32 v26, v26
  v_sub_f32 v27, v27, v32
  v_exp_f32 v27, v27
  v_sub_f32 v28, v28, v32
  v_exp_f32 v28, v28
  v_sub_f32 v29, v29, v32
  v_exp_f32 v29, v29
  v_sub_f32 v30, v30, v32
  v_exp_f32 v30, v30
  v_sub_f32 v31, v31, v32
  v_exp_f32 v31, v31
  v_mul_f32 v72, v33, v72
  v_mul_f32 v73, v33, v73
  v_mul_f32 v74, v33, v74
  v_mul_f32 v75, v33, v75
  v_mul_f32 v76, v33, v76
  v_mul_f32 v77, v33, v77
  v_mul_f32 v78, v33, v78
  v_mul_f32 v79, v33, v79
  v_mul_f32 v80, v33, v80
  v_mul_f32 v81, v33, v81
  v_mul_f32 v82, v33, v82
  v_mul_f32 v83, v33, v83
  v_mul_f32 v84, v33, v84
  v_mul_f32 v85, v33, v85
  v_mul_f32 v86, v33, v86
  v_mul_f32 v87, v33, v87
  v_cvt_pk_bf16_f32 v48, v16, v17
  v_cvt_pk_bf16_f32 v49, v18, v19
  v_cvt_pk_bf16_f32 v50, v20, v21
  v_cvt_pk_bf16_f32 v51, v22, v23
  v_cvt_pk_bf16_f32 v52, v24, v25
  v_cvt_pk_bf16_f32 v53, v26, v27
  v_cvt_pk_bf16_f32 v54, v28, v29
  v_cvt_pk_bf16_f32 v55, v30, v31
  v_mfma_f32_32x32x16_bf16 v[72:87], v[228:231], v[48:51], v[72:87]
  s_nop 0
  v_mfma_f32_32x32x16_bf16 v[72:87], v[232:235], v[52:55], v[72:87]
  s_sub_u32 s54, s54, 1
  s_cmp_lg_u32 s54, 0
  s_nop 7
  s_cbranch_scc1 attn_slow_loop
  s_nop 7
attn_fin:
  v_rcp_f32 v16, v80
  s_nop 0
  v_pk_mul_f32 v[72:73], v[72:73], v[16:17] op_sel:[0,0] op_sel_hi:[1,0]
  v_pk_mul_f32 v[74:75], v[74:75], v[16:17] op_sel:[0,0] op_sel_hi:[1,0]
  v_pk_mul_f32 v[76:77], v[76:77], v[16:17] op_sel:[0,0] op_sel_hi:[1,0]
  v_pk_mul_f32 v[78:79], v[78:79], v[16:17] op_sel:[0,0] op_sel_hi:[1,0]
  v_cvt_pk_bf16_f32 v248, v72, v73
  v_cvt_pk_bf16_f32 v249, v74, v75
  v_cvt_pk_bf16_f32 v250, v76, v77
  v_cvt_pk_bf16_f32 v251, v78, v79
  buffer_store_dwordx4 v[248:251], v2, s[4:7], s55 offen sc1
  s_mov_b32 s41, 1
  s_cmp_eq_u32 s40, 1
  s_cbranch_scc1 attn_done
  s_cmp_lg_u32 s41, 1
  s_cbranch_scc1 sge_26
  s_waitcnt vmcnt(0)
  s_mov_b64 exec, 1
  v_mov_b32 v0, 1
  s_cmp_eq_u32 s69, -1
  s_cbranch_scc0 sa_27
  s_mov_b64 exec, s[94:95]
  v_mov_b32 v0, 1
  buffer_store_dword v0, v3, s[4:7], s42 offen sc1
  s_branch sb_28
sa_27:
  buffer_atomic_add v0, v3, s[4:7], s42 offen sc0 sc1
sb_28:
  s_mov_b64 exec, -1
  s_mov_b32 s41, s97
sge_26:
  s_cmp_lg_u32 s41, 2
  s_cbranch_scc1 sge_29
  s_waitcnt vmcnt(0)
  v_readfirstlane_b32 s52, v0
  s_cmp_lg_u32 s52, s69
  s_cbranch_scc1 notlast_30
  s_mov_b64 exec, 1
  v_mov_b32 v0, 1
  buffer_store_dword v0, v3, s[4:7], s42 offen offset:256 sc1
  s_mov_b64 exec, -1
notlast_30:
  s_mov_b32 s41, 0
sge_29:
  s_cmp_eq_u32 s43, 0
  s_cbranch_scc1 attn_done
  s_mov_b32 s43, 0
  s_mov_b32 s55, s39
  s_lshl_b32 s42, s37, 8
  s_add_u32 s42, s42, s28
  s_add_u32 s42, s42, 262144
  s_mov_b32 s69, -1
  s_mov_b32 s97, 0
  s_branch attn_slow
attn_done:
  s_mul_i32 s56, s21, 32
  s_lshl_b32 s29, s12, 3
  s_add_u32 s56, s56, s29
  s_lshl_b32 s56, s56, 10
  s_add_u32 s56, s56, s27
  s_add_u32 s56, s56, 12582912
  s_add_u32 s57, s56, 32768
  s_lshl_b32 s58, s27, 1
  s_add_u32 s58, s58, s32
  s_add_u32 s58, s58, 30146560
  s_lshl_b32 s59, s20, 12
  s_lshl_b32 s54, s22, 8
  s_add_u32 s59, s59, s54
  s_mul_i32 s54, s26, 524288
  s_add_u32 s59, s59, s54
  s_add_u32 s59, s59, 36700160
  s_and_b32 s54, s12, 1
  s_add_u32 s54, s54, 0
  s_xor_b32 s55, s54, s12
  s_mul_i32 s54, s54, 3
  s_add_u32 s54, s54, s55
  s_lshl_b32 s54, s54, 12
  s_add_u32 s54, s54, 97280
  v_add_u32 v240, s54, v2
  s_and_b32 s54, s12, 1
  s_xor_b32 s54, s54, 1
  s_add_u32 s54, s54, 0
  s_xor_b32 s55, s54, s12
  s_mul_i32 s54, s54, 3
  s_add_u32 s54, s54, s55
  s_lshl_b32 s54, s54, 12
  s_add_u32 s54, s54, 97280
  v_add_u32 v241, s54, v2
  s_and_b32 s54, s12, 1
  s_add_u32 s54, s54, 2
  s_xor_b32 s55, s54, s12
  s_mul_i32 s54, s54, 3
  s_add_u32 s54, s54, s55
  s_lshl_b32 s54, s54, 12
  s_add_u32 s54, s54, 97280
  v_add_u32 v242, s54, v2
  s_and_b32 s54, s12, 1
  s_xor_b32 s54, s54, 1
  s_add_u32 s54, s54, 2
  s_xor_b32 s55, s54, s12
  s_mul_i32 s54, s54, 3
  s_add_u32 s54, s54, s55
  s_lshl_b32 s54, s54, 12
  s_add_u32 s54, s54, 97280
  v_add_u32 v243, s54, v2
  s_mul_i32 s55, s12, 12288
  s_add_u32 s55, s55, 101376
  v_add_u32 v244, s55, v2
  s_waitcnt vmcnt(1)
  s_mov_b64 exec, 255
  v_cmp_ne_u32 vcc, 1, v5
  s_mov_b64 exec, -1
  s_cmp_eq_u64 vcc, 0
  s_cbranch_scc1 main_wo_go
  s_mov_b32 s51, 0
poll_31:
  s_mov_b64 exec, 255
  buffer_load_dword v5, v4, s[4:7], s50 offen offset:0 sc1
  s_mov_b64 exec, -1
  s_add_u32 s51, s51, 1
  s_waitcnt vmcnt(0)
  s_cmp_lg_u32 s41, 2
  s_cbranch_scc1 sge_32
  v_readfirstlane_b32 s52, v0
  s_cmp_lg_u32 s52, s69
  s_cbranch_scc1 notlast_33
  s_mov_b64 exec, 1
  v_mov_b32 v0, 1
  buffer_store_dword v0, v3, s[4:7], s42 offen offset:256 sc1
  s_mov_b64 exec, -1
notlast_33:
  s_mov_b32 s41, 0
sge_32:
  s_cmp_lg_u32 s41, 1
  s_cbranch_scc1 sge_34
  s_mov_b64 exec, 1
  v_mov_b32 v0, 1
  s_cmp_eq_u32 s69, -1
  s_cbranch_scc0 sa_35
  s_mov_b64 exec, s[94:95]
  v_mov_b32 v0, 1
  buffer_store_dword v0, v3, s[4:7], s42 offen sc1
  s_branch sb_36
sa_35:
  buffer_atomic_add v0, v3, s[4:7], s42 offen sc0 sc1
sb_36:
  s_mov_b64 exec, -1
  s_mov_b32 s41, s97
sge_34:
  s_mov_b64 exec, 255
  v_cmp_ne_u32 vcc, 1, v5
  s_mov_b64 exec, -1
  s_cmp_eq_u64 vcc, 0
  s_cbranch_scc1 main_wo_go
  s_cmp_lt_u32 s51, 2097152
  s_cbranch_scc1 poll_31
main_wo_go:
  s_barrier
  buffer_load_dwordx4 v[80:83], v2, s[4:7], s56 offen offset:0 sc1
  buffer_load_dwordx4 v[84:87], v2, s[4:7], s56 offen offset:1024 sc1
  buffer_load_dwordx4 v[88:91], v2, s[4:7], s56 offen offset:2048 sc1
  buffer_load_dwordx4 v[92:95], v2, s[4:7], s56 offen offset:3072 sc1
  s_add_u32 s56, s56, 4096
  buffer_load_dwordx4 v[96:99], v2, s[4:7], s56 offen offset:0 sc1
  buffer_load_dwordx4 v[100:103], v2, s[4:7], s56 offen offset:1024 sc1
  buffer_load_dwordx4 v[104:107], v2, s[4:7], s56 offen offset:2048 sc1
  buffer_load_dwordx4 v[108:111], v2, s[4:7], s56 offen offset:3072 sc1
  s_add_u32 s56, s56, 4096
  s_cmp_lg_u32 s41, 1
  s_cbranch_scc1 sgd_37
  s_waitcnt vmcnt(8)
  s_mov_b64 exec, 1
  v_mov_b32 v0, 1
  s_cmp_eq_u32 s69, -1
  s_cbranch_scc0 sa_39
  s_mov_b64 exec, s[94:95]
  v_mov_b32 v0, 1
  buffer_store_dword v0, v3, s[4:7], s42 offen sc1
  s_branch sb_40
sa_39:
  buffer_atomic_add v0, v3, s[4:7], s42 offen sc0 sc1
sb_40:
  s_mov_b64 exec, -1
  s_mov_b32 s41, s97
  s_branch sge_38
sgd_37:
  s_mov_b64 exec, 2
  buffer_load_dword v0, v3, s[4:7], 0 offen
  s_mov_b64 exec, -1
sge_38:
  s_waitcnt vmcnt(8)
  v_mfma_f32_32x32x16_bf16 v[32:47], a[4:7], v[80:83], 0
  s_mul_i32 s67, s22, 96
  s_add_u32 s67, s67, s33
  s_lshl_b32 s67, s67, 10
  s_add_u32 s67, s67, 41437184
  s_mul_i32 s68, s23, 96
  s_add_u32 s68, s68, s33
  s_lshl_b32 s68, s68, 10
  s_add_u32 s68, s68, 41437184
  v_mfma_f32_32x32x16_bf16 v[16:31], a[0:3], v[80:83], 0
  s_waitcnt vmcnt(7)
  v_mfma_f32_32x32x16_bf16 v[32:47], a[12:15], v[84:87], v[32:47]
  buffer_load_dwordx4 a[208:211], v2, s[4:7], s67 offen offset:0 sc1
  buffer_load_dwordx4 a[216:219], v2, s[4:7], s67 offen offset:1024 sc1
  buffer_load_dwordx4 a[224:227], v2, s[4:7], s67 offen offset:2048 sc1
  buffer_load_dwordx4 a[232:235], v2, s[4:7], s67 offen offset:3072 sc1
  s_add_u32 s67, s67, 4096
  v_mfma_f32_32x32x16_bf16 v[16:31], a[8:11], v[84:87], v[16:31]
  s_waitcnt vmcnt(10)
  v_mfma_f32_32x32x16_bf16 v[32:47], a[20:23], v[88:91], v[32:47]
  buffer_load_dwordx4 a[212:215], v2, s[4:7], s68 offen offset:0 sc1
  buffer_load_dwordx4 a[220:223], v2, s[4:7], s68 offen offset:1024 sc1
  buffer_load_dwordx4 a[228:231], v2, s[4:7], s68 offen offset:2048 sc1
  buffer_load_dwordx4 a[236:239], v2, s[4:7], s68 offen offset:3072 sc1
  s_add_u32 s68, s68, 4096
  v_mfma_f32_32x32x16_bf16 v[16:31], a[16:19], v[88:91], v[16:31]
  s_waitcnt vmcnt(13)
  v_mfma_f32_32x32x16_bf16 v[32:47], a[28:31], v[92:95], v[32:47]
  v_mfma_f32_32x32x16_bf16 v[16:31], a[24:27], v[92:95], v[16:31]
  s_waitcnt vmcnt(12)
  v_mfma_f32_32x32x16_bf16 v[32:47], a[36:39], v[96:99], v[32:47]
  v_mfma_f32_32x32x16_bf16 v[16:31], a[32:35], v[96:99], v[16:31]
  s_waitcnt vmcnt(11)
  v_mfma_f32_32x32x16_bf16 v[32:47], a[44:47], v[100:103], v[32:47]
  s_waitcnt vmcnt(10)
  v_mfma_f32_32x32x16_bf16 v[32:47], a[52:55], v[104:107], v[32:47]
  s_waitcnt vmcnt(9)
  v_mfma_f32_32x32x16_bf16 v[32:47], a[60:63], v[108:111], v[32:47]
  s_cmp_lg_u32 s41, 2
  s_cbranch_scc1 sge_41
  s_waitcnt vmcnt(8)
  v_readfirstlane_b32 s52, v0
  s_cmp_lg_u32 s52, s69
  s_cbranch_scc1 notlast_42
  s_mov_b64 exec, 1
  v_mov_b32 v0, 1
  buffer_store_dword v0, v3, s[4:7], s42 offen offset:256 sc1
  s_mov_b64 exec, -1
notlast_42:
  s_mov_b32 s41, 0
sge_41:
  v_mfma_f32_32x32x16_bf16 v[16:31], a[40:43], v[100:103], v[16:31]
  v_mfma_f32_32x32x16_bf16 v[16:31], a[48:51], v[104:107], v[16:31]
  v_mfma_f32_32x32x16_bf16 v[16:31], a[56:59], v[108:111], v[16:31]
  s_lshl_b32 s50, s38, 8
  s_add_u32 s50, s50, s28
  s_add_u32 s50, s50, 270336
  v_lshlrev_b32 v4, 8, v1
  s_nop 2
  ds_write_b128 v241, v[32:35] offset:0
  ds_write_b128 v241, v[36:39] offset:1024
  ds_write_b128 v241, v[40:43] offset:2048
  ds_write_b128 v241, v[44:47] offset:3072
  s_lshr_b32 s54, s12, 1
  s_cmp_eq_u32 s54, 0
  s_cbranch_scc1 b_self_43
  ds_write_b128 v240, v[16:19] offset:0
  ds_write_b128 v240, v[20:23] offset:1024
  ds_write_b128 v240, v[24:27] offset:2048
  ds_write_b128 v240, v[28:31] offset:3072
b_self_43:
  s_waitcnt lgkmcnt(0)
  s_barrier
  s_lshr_b32 s54, s12, 1
  s_cmp_lg_u32 s54, 0
  s_cbranch_scc1 b_notown_44
  ds_read_b128 v[176:179], v244 offset:0
  ds_read_b128 v[180:183], v244 offset:1024
  ds_read_b128 v[184:187], v244 offset:2048
  ds_read_b128 v[188:191], v244 offset:3072
  ds_read_b128 v[192:195], v244 offset:4096
  ds_read_b128 v[196:199], v244 offset:5120
  ds_read_b128 v[200:203], v244 offset:6144
  ds_read_b128 v[204:207], v244 offset:7168
  ds_read_b128 v[208:211], v244 offset:8192
  ds_read_b128 v[212:215], v244 offset:9216
  ds_read_b128 v[216:219], v244 offset:10240
  ds_read_b128 v[220:223], v244 offset:11264
  v_lshlrev_b32 v224, 16, v8
  v_and_b32 v225, 0xffff0000, v8
  v_lshlrev_b32 v226, 16, v9
  v_and_b32 v227, 0xffff0000, v9
  v_lshlrev_b32 v228, 16, v10
  v_and_b32 v229, 0xffff0000, v10
  v_lshlrev_b32 v230, 16, v11
  v_and_b32 v231, 0xffff0000, v11
  v_lshlrev_b32 v232, 16, v12
  v_and_b32 v233, 0xffff0000, v12
  v_lshlrev_b32 v234, 16, v13
  v_and_b32 v235, 0xffff0000, v13
  v_lshlrev_b32 v236, 16, v14
  v_and_b32 v237, 0xffff0000, v14
  v_lshlrev_b32 v238, 16, v15
  v_and_b32 v239, 0xffff0000, v15
  v_pk_add_f32 v[16:17], v[16:17], v[224:225]
  v_pk_add_f32 v[18:19], v[18:19], v[226:227]
  v_pk_add_f32 v[20:21], v[20:21], v[228:229]
  v_pk_add_f32 v[22:23], v[22:23], v[230:231]
  v_pk_add_f32 v[24:25], v[24:25], v[232:233]
  v_pk_add_f32 v[26:27], v[26:27], v[234:235]
  v_pk_add_f32 v[28:29], v[28:29], v[236:237]
  v_pk_add_f32 v[30:31], v[30:31], v[238:239]
  s_waitcnt lgkmcnt(8)
  v_pk_add_f32 v[16:17], v[16:17], v[176:177]
  v_pk_add_f32 v[18:19], v[18:19], v[178:179]
  v_pk_add_f32 v[20:21], v[20:21], v[180:181]
  v_pk_add_f32 v[22:23], v[22:23], v[182:183]
  v_pk_add_f32 v[24:25], v[24:25], v[184:185]
  v_pk_add_f32 v[26:27], v[26:27], v[186:187]
  v_pk_add_f32 v[28:29], v[28:29], v[188:189]
  v_pk_add_f32 v[30:31], v[30:31], v[190:191]
  s_waitcnt lgkmcnt(4)
  v_pk_add_f32 v[16:17], v[16:17], v[192:193]
  v_pk_add_f32 v[18:19], v[18:19], v[194:195]
  v_pk_add_f32 v[20:21], v[20:21], v[196:197]
  v_pk_add_f32 v[22:23], v[22:23], v[198:199]
  v_pk_add_f32 v[24:25], v[24:25], v[200:201]
  v_pk_add_f32 v[26:27], v[26:27], v[202:203]
  v_pk_add_f32 v[28:29], v[28:29], v[204:205]
  v_pk_add_f32 v[30:31], v[30:31], v[206:207]
  s_waitcnt lgkmcnt(0)
  v_pk_add_f32 v[16:17], v[16:17], v[208:209]
  v_pk_add_f32 v[18:19], v[18:19], v[210:211]
  v_pk_add_f32 v[20:21], v[20:21], v[212:213]
  v_pk_add_f32 v[22:23], v[22:23], v[214:215]
  v_pk_add_f32 v[24:25], v[24:25], v[216:217]
  v_pk_add_f32 v[26:27], v[26:27], v[218:219]
  v_pk_add_f32 v[28:29], v[28:29], v[220:221]
  v_pk_add_f32 v[30:31], v[30:31], v[222:223]
  v_cvt_pk_bf16_f32 v8, v16, v17
  v_cvt_pk_bf16_f32 v9, v18, v19
  v_cvt_pk_bf16_f32 v10, v20, v21
  v_cvt_pk_bf16_f32 v11, v22, v23
  v_cvt_pk_bf16_f32 v12, v24, v25
  v_cvt_pk_bf16_f32 v13, v26, v27
  v_cvt_pk_bf16_f32 v14, v28, v29
  v_cvt_pk_bf16_f32 v15, v30, v31
  buffer_store_dwordx4 v[8:11], v2, s[4:7], s58 offen sc1
  buffer_store_dwordx4 v[12:15], v2, s[4:7], s58 offen offset:1024 sc1
  v_pk_add_f32 v[176:177], v[16:17], v[18:19]
  v_pk_mul_f32 v[178:179], v[16:17], v[16:17]
  v_pk_fma_f32 v[178:179], v[18:19], v[18:19], v[178:179]
  v_pk_add_f32 v[176:177], v[176:177], v[20:21]
  v_pk_fma_f32 v[178:179], v[20:21], v[20:21], v[178:179]
  v_pk_add_f32 v[176:177], v[176:177], v[22:23]
  v_pk_fma_f32 v[178:179], v[22:23], v[22:23], v[178:179]
  v_pk_add_f32 v[176:177], v[176:177], v[24:25]
  v_pk_fma_f32 v[178:179], v[24:25], v[24:25], v[178:179]
  v_pk_add_f32 v[176:177], v[176:177], v[26:27]
  v_pk_fma_f32 v[178:179], v[26:27], v[26:27], v[178:179]
  v_pk_add_f32 v[176:177], v[176:177], v[28:29]
  v_pk_fma_f32 v[178:179], v[28:29], v[28:29], v[178:179]
  v_pk_add_f32 v[176:177], v[176:177], v[30:31]
  v_pk_fma_f32 v[178:179], v[30:31], v[30:31], v[178:179]
  v_add_f32 v6, v176, v177
  v_add_f32 v7, v178, v179
  s_nop 1
  v_permlane32_swap_b32 v6, v7
  v_add_f32 v6, v6, v7
  buffer_store_dword v6, v3, s[4:7], s59 offen sc1
  s_lshl_b32 s42, s84, 8
  s_add_u32 s42, s42, s28
  s_add_u32 s42, s42, 786432
  s_mov_b32 s69, -1
  s_mov_b32 s97, 0
  s_mov_b32 s41, 1
b_notown_44:
  s_mov_b32 s51, 0
poll_46:
  s_mov_b64 exec, 255
  buffer_load_dword v5, v4, s[4:7], s50 offen offset:0 sc1
  s_mov_b64 exec, -1
  s_add_u32 s51, s51, 1
  s_waitcnt vmcnt(0)
  s_cmp_lg_u32 s41, 2
  s_cbranch_scc1 sge_47
  v_readfirstlane_b32 s52, v0
  s_cmp_lg_u32 s52, s69
  s_cbranch_scc1 notlast_48
  s_mov_b64 exec, 1
  v_mov_b32 v0, 1
  buffer_store_dword v0, v3, s[4:7], s42 offen offset:256 sc1
  s_mov_b64 exec, -1
notlast_48:
  s_mov_b32 s41, 0
sge_47:
  s_cmp_lg_u32 s41, 1
  s_cbranch_scc1 sge_49
  s_mov_b64 exec, 1
  v_mov_b32 v0, 1
  s_cmp_eq_u32 s69, -1
  s_cbranch_scc0 sa_50
  s_mov_b64 exec, s[94:95]
  v_mov_b32 v0, 1
  buffer_store_dword v0, v3, s[4:7], s42 offen sc1
  s_branch sb_51
sa_50:
  buffer_atomic_add v0, v3, s[4:7], s42 offen sc0 sc1
sb_51:
  s_mov_b64 exec, -1
  s_mov_b32 s41, s97
sge_49:
  s_mov_b64 exec, 255
  v_cmp_ne_u32 vcc, 1, v5
  s_mov_b64 exec, -1
  s_cmp_eq_u64 vcc, 0
  s_cbranch_scc1 go_45
  s_cmp_lt_u32 s51, 2097152
  s_cbranch_scc1 poll_46
go_45:
  buffer_load_dwordx4 v[112:115], v2, s[4:7], s57 offen offset:0 sc1
  buffer_load_dwordx4 v[116:119], v2, s[4:7], s57 offen offset:1024 sc1
  buffer_load_dwordx4 v[120:123], v2, s[4:7], s57 offen offset:2048 sc1
  buffer_load_dwordx4 v[124:127], v2, s[4:7], s57 offen offset:3072 sc1
  s_add_u32 s57, s57, 4096
  buffer_load_dwordx4 v[128:131], v2, s[4:7], s57 offen offset:0 sc1
  buffer_load_dwordx4 v[132:135], v2, s[4:7], s57 offen offset:1024 sc1
  buffer_load_dwordx4 v[136:139], v2, s[4:7], s57 offen offset:2048 sc1
  buffer_load_dwordx4 v[140:143], v2, s[4:7], s57 offen offset:3072 sc1
  s_add_u32 s57, s57, 4096
  s_waitcnt vmcnt(7)
  s_cmp_lg_u32 s41, 2
  s_cbranch_scc1 sge_52
  v_readfirstlane_b32 s52, v0
  s_cmp_lg_u32 s52, s69
  s_cbranch_scc1 notlast_53
  s_mov_b64 exec, 1
  v_mov_b32 v0, 1
  buffer_store_dword v0, v3, s[4:7], s42 offen offset:256 sc1
  s_mov_b64 exec, -1
notlast_53:
  s_mov_b32 s41, 0
sge_52:
  s_cmp_lg_u32 s41, 1
  s_cbranch_scc1 sge_54
  s_mov_b64 exec, 1
  v_mov_b32 v0, 1
  s_cmp_eq_u32 s69, -1
  s_cbranch_scc0 sa_55
  s_mov_b64 exec, s[94:95]
  v_mov_b32 v0, 1
  buffer_store_dword v0, v3, s[4:7], s42 offen sc1
  s_branch sb_56
sa_55:
  buffer_atomic_add v0, v3, s[4:7], s42 offen sc0 sc1
sb_56:
  s_mov_b64 exec, -1
  s_mov_b32 s41, s97
sge_54:
  v_mfma_f32_32x32x16_bf16 v[64:79], a[4:7], v[112:115], 0
  v_mfma_f32_32x32x16_bf16 v[48:63], a[0:3], v[112:115], 0
  s_waitcnt vmcnt(6)
  v_mfma_f32_32x32x16_bf16 v[64:79], a[12:15], v[116:119], v[64:79]
  v_mfma_f32_32x32x16_bf16 v[48:63], a[8:11], v[116:119], v[48:63]
  s_waitcnt vmcnt(5)
  v_mfma_f32_32x32x16_bf16 v[64:79], a[20:23], v[120:123], v[64:79]
  v_mfma_f32_32x32x16_bf16 v[48:63], a[16:19], v[120:123], v[48:63]
  s_waitcnt vmcnt(4)
  v_mfma_f32_32x32x16_bf16 v[64:79], a[28:31], v[124:127], v[64:79]
  v_mfma_f32_32x32x16_bf16 v[48:63], a[24:27], v[124:127], v[48:63]
  s_waitcnt vmcnt(3)
  v_mfma_f32_32x32x16_bf16 v[64:79], a[36:39], v[128:131], v[64:79]
  v_mfma_f32_32x32x16_bf16 v[48:63], a[32:35], v[128:131], v[48:63]
  s_waitcnt vmcnt(2)
  v_mfma_f32_32x32x16_bf16 v[64:79], a[44:47], v[132:135], v[64:79]
  s_waitcnt vmcnt(1)
  v_mfma_f32_32x32x16_bf16 v[64:79], a[52:55], v[136:139], v[64:79]
  s_waitcnt vmcnt(0)
  v_mfma_f32_32x32x16_bf16 v[64:79], a[60:63], v[140:143], v[64:79]
  v_mfma_f32_32x32x16_bf16 v[48:63], a[40:43], v[132:135], v[48:63]
  v_mfma_f32_32x32x16_bf16 v[48:63], a[48:51], v[136:139], v[48:63]
  v_mfma_f32_32x32x16_bf16 v[48:63], a[56:59], v[140:143], v[48:63]
  s_cmp_lg_u32 s41, 2
  s_cbranch_scc1 sge_57
  s_waitcnt vmcnt(0)
  v_readfirstlane_b32 s52, v0
  s_cmp_lg_u32 s52, s69
  s_cbranch_scc1 notlast_58
  s_mov_b64 exec, 1
  v_mov_b32 v0, 1
  buffer_store_dword v0, v3, s[4:7], s42 offen offset:256 sc1
  s_mov_b64 exec, -1
notlast_58:
  s_mov_b32 s41, 0
sge_57:
  s_lshl_b32 s50, s85, 8
  s_add_u32 s50, s50, s28
  s_add_u32 s50, s50, 786432
  v_lshlrev_b32 v4, 8, v1
  s_mov_b64 exec, 65535
  buffer_load_dword v5, v4, s[4:7], s50 offen offset:0 sc1
  s_mov_b64 exec, -1
  ds_write_b128 v243, v[64:67] offset:0
  ds_write_b128 v243, v[68:71] offset:1024
  ds_write_b128 v243, v[72:75] offset:2048
  ds_write_b128 v243, v[76:79] offset:3072
  s_lshr_b32 s54, s12, 1
  s_cmp_eq_u32 s54, 1
  s_cbranch_scc1 b_self_59
  ds_write_b128 v242, v[48:51] offset:0
  ds_write_b128 v242, v[52:55] offset:1024
  ds_write_b128 v242, v[56:59] offset:2048
  ds_write_b128 v242, v[60:63] offset:3072
b_self_59:
  s_waitcnt lgkmcnt(0)
  s_barrier
  s_lshr_b32 s54, s12, 1
  s_cmp_lg_u32 s54, 1
  s_cbranch_scc1 b_notown_60
  ds_read_b128 v[176:179], v244 offset:0
  ds_read_b128 v[180:183], v244 offset:1024
  ds_read_b128 v[184:187], v244 offset:2048
  ds_read_b128 v[188:191], v244 offset:3072
  ds_read_b128 v[192:195], v244 offset:4096
  ds_read_b128 v[196:199], v244 offset:5120
  ds_read_b128 v[200:203], v244 offset:6144
  ds_read_b128 v[204:207], v244 offset:7168
  ds_read_b128 v[208:211], v244 offset:8192
  ds_read_b128 v[212:215], v244 offset:9216
  ds_read_b128 v[216:219], v244 offset:10240
  ds_read_b128 v[220:223], v244 offset:11264
  v_lshlrev_b32 v224, 16, v8
  v_and_b32 v225, 0xffff0000, v8
  v_lshlrev_b32 v226, 16, v9
  v_and_b32 v227, 0xffff0000, v9
  v_lshlrev_b32 v228, 16, v10
  v_and_b32 v229, 0xffff0000, v10
  v_lshlrev_b32 v230, 16, v11
  v_and_b32 v231, 0xffff0000, v11
  v_lshlrev_b32 v232, 16, v12
  v_and_b32 v233, 0xffff0000, v12
  v_lshlrev_b32 v234, 16, v13
  v_and_b32 v235, 0xffff0000, v13
  v_lshlrev_b32 v236, 16, v14
  v_and_b32 v237, 0xffff0000, v14
  v_lshlrev_b32 v238, 16, v15
  v_and_b32 v239, 0xffff0000, v15
  v_pk_add_f32 v[48:49], v[48:49], v[224:225]
  v_pk_add_f32 v[50:51], v[50:51], v[226:227]
  v_pk_add_f32 v[52:53], v[52:53], v[228:229]
  v_pk_add_f32 v[54:55], v[54:55], v[230:231]
  v_pk_add_f32 v[56:57], v[56:57], v[232:233]
  v_pk_add_f32 v[58:59], v[58:59], v[234:235]
  v_pk_add_f32 v[60:61], v[60:61], v[236:237]
  v_pk_add_f32 v[62:63], v[62:63], v[238:239]
  s_waitcnt lgkmcnt(8)
  v_pk_add_f32 v[48:49], v[48:49], v[176:177]
  v_pk_add_f32 v[50:51], v[50:51], v[178:179]
  v_pk_add_f32 v[52:53], v[52:53], v[180:181]
  v_pk_add_f32 v[54:55], v[54:55], v[182:183]
  v_pk_add_f32 v[56:57], v[56:57], v[184:185]
  v_pk_add_f32 v[58:59], v[58:59], v[186:187]
  v_pk_add_f32 v[60:61], v[60:61], v[188:189]
  v_pk_add_f32 v[62:63], v[62:63], v[190:191]
  s_waitcnt lgkmcnt(4)
  v_pk_add_f32 v[48:49], v[48:49], v[192:193]
  v_pk_add_f32 v[50:51], v[50:51], v[194:195]
  v_pk_add_f32 v[52:53], v[52:53], v[196:197]
  v_pk_add_f32 v[54:55], v[54:55], v[198:199]
  v_pk_add_f32 v[56:57], v[56:57], v[200:201]
  v_pk_add_f32 v[58:59], v[58:59], v[202:203]
  v_pk_add_f32 v[60:61], v[60:61], v[204:205]
  v_pk_add_f32 v[62:63], v[62:63], v[206:207]
  s_waitcnt lgkmcnt(0)
  v_pk_add_f32 v[48:49], v[48:49], v[208:209]
  v_pk_add_f32 v[50:51], v[50:51], v[210:211]
  v_pk_add_f32 v[52:53], v[52:53], v[212:213]
  v_pk_add_f32 v[54:55], v[54:55], v[214:215]
  v_pk_add_f32 v[56:57], v[56:57], v[216:217]
  v_pk_add_f32 v[58:59], v[58:59], v[218:219]
  v_pk_add_f32 v[60:61], v[60:61], v[220:221]
  v_pk_add_f32 v[62:63], v[62:63], v[222:223]
  v_cvt_pk_bf16_f32 v8, v48, v49
  v_cvt_pk_bf16_f32 v9, v50, v51
  v_cvt_pk_bf16_f32 v10, v52, v53
  v_cvt_pk_bf16_f32 v11, v54, v55
  v_cvt_pk_bf16_f32 v12, v56, v57
  v_cvt_pk_bf16_f32 v13, v58, v59
  v_cvt_pk_bf16_f32 v14, v60, v61
  v_cvt_pk_bf16_f32 v15, v62, v63
  buffer_store_dwordx4 v[8:11], v2, s[4:7], s58 offen sc1
  buffer_store_dwordx4 v[12:15], v2, s[4:7], s58 offen offset:1024 sc1
  v_pk_add_f32 v[176:177], v[48:49], v[50:51]
  v_pk_mul_f32 v[178:179], v[48:49], v[48:49]
  v_pk_fma_f32 v[178:179], v[50:51], v[50:51], v[178:179]
  v_pk_add_f32 v[176:177], v[176:177], v[52:53]
  v_pk_fma_f32 v[178:179], v[52:53], v[52:53], v[178:179]
  v_pk_add_f32 v[176:177], v[176:177], v[54:55]
  v_pk_fma_f32 v[178:179], v[54:55], v[54:55], v[178:179]
  v_pk_add_f32 v[176:177], v[176:177], v[56:57]
  v_pk_fma_f32 v[178:179], v[56:57], v[56:57], v[178:179]
  v_pk_add_f32 v[176:177], v[176:177], v[58:59]
  v_pk_fma_f32 v[178:179], v[58:59], v[58:59], v[178:179]
  v_pk_add_f32 v[176:177], v[176:177], v[60:61]
  v_pk_fma_f32 v[178:179], v[60:61], v[60:61], v[178:179]
  v_pk_add_f32 v[176:177], v[176:177], v[62:63]
  v_pk_fma_f32 v[178:179], v[62:63], v[62:63], v[178:179]
  v_add_f32 v6, v176, v177
  v_add_f32 v7, v178, v179
  s_nop 1
  v_permlane32_swap_b32 v6, v7
  v_add_f32 v6, v6, v7
  buffer_store_dword v6, v3, s[4:7], s59 offen sc1
  s_lshl_b32 s42, s84, 8
  s_add_u32 s42, s42, s28
  s_add_u32 s42, s42, 786432
  s_mov_b32 s69, -1
  s_mov_b32 s97, 0
  s_mov_b32 s41, 1
b_notown_60:
  s_cmp_lg_u32 s41, 1
  s_cbranch_scc1 sge_61
  s_waitcnt vmcnt(0)
  s_mov_b64 exec, 1
  v_mov_b32 v0, 1
  s_cmp_eq_u32 s69, -1
  s_cbranch_scc0 sa_62
  s_mov_b64 exec, s[94:95]
  v_mov_b32 v0, 1
  buffer_store_dword v0, v3, s[4:7], s42 offen sc1
  s_branch sb_63
sa_62:
  buffer_atomic_add v0, v3, s[4:7], s42 offen sc0 sc1
sb_63:
  s_mov_b64 exec, -1
  s_mov_b32 s41, s97
sge_61:
  s_cmp_lg_u32 s41, 2
  s_cbranch_scc1 sge_64
  s_waitcnt vmcnt(0)
  v_readfirstlane_b32 s52, v0
  s_cmp_lg_u32 s52, s69
  s_cbranch_scc1 notlast_65
  s_mov_b64 exec, 1
  v_mov_b32 v0, 1
  buffer_store_dword v0, v3, s[4:7], s42 offen offset:256 sc1
  s_mov_b64 exec, -1
notlast_65:
  s_mov_b32 s41, 0
sge_64:
  s_cmp_eq_u32 s16, 15
  s_cbranch_scc1 main_skip_ffn1
  s_lshl_b32 s47, s17, 15
  s_lshl_b32 s29, s27, 1
  s_add_u32 s47, s47, s29
  s_add_u32 s47, s47, 30146560
  s_lshl_b32 s48, s17, 12
  s_mul_i32 s29, s26, 524288
  s_add_u32 s48, s48, s29
  s_add_u32 s48, s48, 36700160
  s_lshl_b32 s55, s12, 10
  s_add_u32 s55, s55, 159744
  v_add_u32 v64, s55, v2
  v_add_u32 v65, s55, v3
  v_add_u32 v70, 33792, v2
  v_add_u32 v71, 67584, v2
  s_mul_i32 s56, s17, 86
  s_mul_i32 s57, s16, 6
  s_add_u32 s56, s56, s57
  s_lshl_b32 s56, s56, 10
  s_mul_i32 s57, s26, 5636096
  s_add_u32 s56, s56, s57
  s_add_u32 s56, s56, 16777216
  s_add_u32 s57, s56, 4096
  s_cmp_eq_u32 s16, 14
  s_cselect_b32 s29, 67108864, 0
  s_add_u32 s58, s56, s29
  s_add_u32 s57, s57, s29
  v_mov_b32 v67, 157696
  v_mov_b32 v79, 1
  s_waitcnt vmcnt(0)
  s_mov_b64 exec, 65535
  v_cmp_ne_u32 vcc, 1, v5
  s_mov_b64 exec, -1
  s_cmp_eq_u64 vcc, 0
  s_cbranch_scc1 main_f1_go
  s_mov_b32 s51, 0
poll_66:
  s_mov_b64 exec, 65535
  buffer_load_dword v5, v4, s[4:7], s50 offen offset:0 sc1
  s_mov_b64 exec, -1
  s_add_u32 s51, s51, 1
  s_waitcnt vmcnt(0)
  s_mov_b64 exec, 65535
  v_cmp_ne_u32 vcc, 1, v5
  s_mov_b64 exec, -1
  s_cmp_eq_u64 vcc, 0
  s_cbranch_scc1 main_f1_go
  s_cmp_lt_u32 s51, 2097152
  s_cbranch_scc1 poll_66
main_f1_go:
  buffer_load_dwordx4 v[128:131], v2, s[4:7], s47 offen offset:0 sc1
  buffer_load_dwordx4 v[132:135], v2, s[4:7], s47 offen offset:1024 sc1
  buffer_load_dwordx4 v[136:139], v2, s[4:7], s47 offen offset:2048 sc1
  buffer_load_dwordx4 v[140:143], v2, s[4:7], s47 offen offset:3072 sc1
  s_add_u32 s47, s47, 4096
  buffer_load_dwordx4 v[144:147], v2, s[4:7], s47 offen offset:0 sc1
  buffer_load_dwordx4 v[148:151], v2, s[4:7], s47 offen offset:1024 sc1
  buffer_load_dwordx4 v[16:19], v2, s[4:7], s48 offen offset:0 sc1
  buffer_load_dwordx4 v[20:23], v2, s[4:7], s48 offen offset:1024 sc1
  buffer_load_dwordx4 v[24:27], v2, s[4:7], s48 offen offset:2048 sc1
  buffer_load_dwordx4 v[28:31], v2, s[4:7], s48 offen offset:3072 sc1
  buffer_load_dwordx4 v[152:155], v2, s[4:7], s47 offen offset:2048 sc1
  buffer_load_dwordx4 v[156:159], v2, s[4:7], s47 offen offset:3072 sc1
  s_add_u32 s47, s47, 4096
  buffer_load_dwordx4 v[160:163], v2, s[4:7], s47 offen offset:0 sc1
  buffer_load_dwordx4 v[164:167], v2, s[4:7], s47 offen offset:1024 sc1
  buffer_load_dwordx4 v[168:171], v2, s[4:7], s47 offen offset:2048 sc1
  buffer_load_dwordx4 v[172:175], v2, s[4:7], s47 offen offset:3072 sc1
  s_add_u32 s47, s47, 4096
  buffer_load_dwordx4 v[176:179], v2, s[4:7], s47 offen offset:0 sc1
  buffer_load_dwordx4 v[180:183], v2, s[4:7], s47 offen offset:1024 sc1
  buffer_load_dwordx4 v[184:187], v2, s[4:7], s47 offen offset:2048 sc1
  buffer_load_dwordx4 v[188:191], v2, s[4:7], s47 offen offset:3072 sc1
  s_add_u32 s47, s47, 4096
  ds_read_b128 v[32:35], v2 offset:0
  ds_read_b128 v[36:39], v2 offset:1024
  ds_read_b128 v[40:43], v2 offset:2048
  ds_read_b128 v[44:47], v70 offset:0
  ds_read_b128 v[48:51], v2 offset:3072
  ds_read_b128 v[52:55], v2 offset:4096
  s_waitcnt vmcnt(19) lgkmcnt(5)
  v_mfma_f32_32x32x16_bf16 v[80:95], v[32:35], v[128:131], 0
  ds_read_b128 v[56:59], v70 offset:1024
  buffer_load_dwordx4 v[192:195], v2, s[4:7], s47 offen offset:0 sc1
  s_waitcnt vmcnt(19) lgkmcnt(5)
  v_mfma_f32_32x32x16_bf16 v[80:95], v[36:39], v[132:135], v[80:95]
  ds_read_b128 v[60:63], v2 offset:5120
  buffer_load_dwordx4 v[196:199], v2, s[4:7], s47 offen offset:1024 sc1
  s_waitcnt vmcnt(19) lgkmcnt(5)
  v_mfma_f32_32x32x16_bf16 v[80:95], v[40:43], v[136:139], v[80:95]
  ds_read_b128 v[32:35], v2 offset:6144
  buffer_load_dwordx4 v[200:203], v2, s[4:7], s47 offen offset:2048 sc1
  s_waitcnt lgkmcnt(5)
  v_mfma_f32_32x32x16_bf16 v[96:111], v[44:47], v[128:131], 0
  ds_read_b128 v[36:39], v70 offset:2048
  s_waitcnt vmcnt(19) lgkmcnt(5)
  v_mfma_f32_32x32x16_bf16 v[80:95], v[48:51], v[140:143], v[80:95]
  ds_read_b128 v[40:43], v2 offset:7168
  buffer_load_dwordx4 v[204:207], v2, s[4:7], s47 offen offset:3072 sc1
  s_add_u32 s47, s47, 4096
  s_waitcnt vmcnt(19) lgkmcnt(5)
  v_mfma_f32_32x32x16_bf16 v[80:95], v[52:55], v[144:147], v[80:95]
  ds_read_b128 v[44:47], v2 offset:8192
  buffer_load_dwordx4 v[208:211], v2, s[4:7], s47 offen offset:0 sc1
  s_waitcnt lgkmcnt(5)
  v_mfma_f32_32x32x16_bf16 v[96:111], v[56:59], v[132:135], v[96:111]
  ds_read_b128 v[48:51], v70 offset:3072
  s_waitcnt vmcnt(19) lgkmcnt(5)
  v_mfma_f32_32x32x16_bf16 v[80:95], v[60:63], v[148:151], v[80:95]
  ds_read_b128 v[52:55], v2 offset:9216
  buffer_load_dwordx4 v[212:215], v2, s[4:7], s47 offen offset:1024 sc1
  s_waitcnt vmcnt(15) lgkmcnt(5)
  v_mfma_f32_32x32x16_bf16 v[80:95], v[32:35], v[152:155], v[80:95]
  ds_read_b128 v[56:59], v2 offset:10240
  buffer_load_dwordx4 v[216:219], v2, s[4:7], s47 offen offset:2048 sc1
  v_add_f32 v16, v16, v24
  v_add_f32 v17, v17, v25
  s_waitcnt lgkmcnt(5)
  v_mfma_f32_32x32x16_bf16 v[96:111], v[36:39], v[136:139], v[96:111]
  ds_read_b128 v[60:63], v70 offset:4096
  v_add_f32 v18, v18, v26
  v_add_f32 v19, v19, v27
  v_add_f32 v20, v20, v28
  v_add_f32 v21, v21, v29
  s_waitcnt vmcnt(15) lgkmcnt(5)
  v_mfma_f32_32x32x16_bf16 v[80:95], v[40:43], v[156:159], v[80:95]
  ds_read_b128 v[32:35], v2 offset:11264
  buffer_load_dwordx4 v[220:223], v2, s[4:7], s47 offen offset:3072 sc1
  s_add_u32 s47, s47, 4096
  v_add_f32 v22, v22, v30
  v_add_f32 v23, v23, v31
  s_waitcnt vmcnt(15) lgkmcnt(5)
  v_mfma_f32_32x32x16_bf16 v[80:95], v[44:47], v[160:163], v[80:95]
  ds_read_b128 v[36:39], v2 offset:12288
  buffer_load_dwordx4 v[224:227], v2, s[4:7], s47 offen offset:0 sc1
  v_add_f32 v16, v16, v20
  v_add_f32 v17, v17, v21
  s_waitcnt lgkmcnt(5)
  v_mfma_f32_32x32x16_bf16 v[96:111], v[48:51], v[140:143], v[96:111]
  ds_read_b128 v[40:43], v70 offset:5120
  v_add_f32 v18, v18, v22
  v_add_f32 v19, v19, v23
  ds_write_b128 v64, v[16:19]
  ds_read2_b32 v[20:21], v65 offset0:0 offset1:64
  s_waitcnt vmcnt(15) lgkmcnt(7)
  v_mfma_f32_32x32x16_bf16 v[80:95], v[52:55], v[164:167], v[80:95]
  ds_read_b128 v[44:47], v2 offset:13312
  buffer_load_dwordx4 v[228:231], v2, s[4:7], s47 offen offset:1024 sc1
  ds_read2_b32 v[22:23], v65 offset0:128 offset1:192
  s_waitcnt vmcnt(15) lgkmcnt(8)
  v_mfma_f32_32x32x16_bf16 v[80:95], v[56:59], v[168:171], v[80:95]
  ds_read_b128 v[48:51], v2 offset:14336
  buffer_load_dwordx4 v[232:235], v2, s[4:7], s47 offen offset:2048 sc1
  s_waitcnt lgkmcnt(8)
  v_mfma_f32_32x32x16_bf16 v[96:111], v[60:63], v[144:147], v[96:111]
  ds_read_b128 v[52:55], v70 offset:6144
  s_waitcnt vmcnt(15) lgkmcnt(8)
  v_mfma_f32_32x32x16_bf16 v[80:95], v[32:35], v[172:175], v[80:95]
  ds_read_b128 v[56:59], v2 offset:15360
  buffer_load_dwordx4 v[236:239], v2, s[4:7], s47 offen offset:3072 sc1
  s_add_u32 s47, s47, 4096
  s_waitcnt vmcnt(15) lgkmcnt(8)
  v_mfma_f32_32x32x16_bf16 v[80:95], v[36:39], v[176:179], v[80:95]
  ds_read_b128 v[60:63], v2 offset:16384
  buffer_load_dwordx4 v[240:243], v2, s[4:7], s47 offen offset:0 sc1
  s_waitcnt lgkmcnt(8)
  v_mfma_f32_32x32x16_bf16 v[96:111], v[40:43], v[148:151], v[96:111]
  ds_read_b128 v[32:35], v70 offset:7168
  s_waitcnt vmcnt(15) lgkmcnt(6)
  v_mfma_f32_32x32x16_bf16 v[80:95], v[44:47], v[180:183], v[80:95]
  ds_read_b128 v[36:39], v2 offset:17408
  buffer_load_dwordx4 v[244:247], v2, s[4:7], s47 offen offset:1024 sc1
  s_waitcnt vmcnt(15) lgkmcnt(5)
  v_mfma_f32_32x32x16_bf16 v[80:95], v[48:51], v[184:187], v[80:95]
  ds_read_b128 v[40:43], v2 offset:18432
  buffer_load_dwordx4 v[248:251], v2, s[4:7], s47 offen offset:2048 sc1
  v_add_f32 v20, v20, v21
  v_add_f32 v22, v22, v23
  s_waitcnt lgkmcnt(5)
  v_mfma_f32_32x32x16_bf16 v[96:111], v[52:55], v[152:155], v[96:111]
  ds_read_b128 v[44:47], v70 offset:8192
  v_add_f32 v16, v20, v22
  v_mov_b32 v17, v16
  s_nop 1
  v_permlane32_swap_b32 v16, v17
  v_mul_f32 v16, 0xbb000000, v16
  s_waitcnt vmcnt(15) lgkmcnt(5)
  v_mfma_f32_32x32x16_bf16 v[80:95], v[56:59], v[188:191], v[80:95]
  ds_read_b128 v[48:51], v2 offset:19456
  buffer_load_dwordx4 v[252:255], v2, s[4:7], s47 offen offset:3072 sc1
  s_add_u32 s47, s47, 4096
  v_mul_f32 v17, 0x3b000000, v17
  v_fma_f32 v17, -v16, v16, v17
  s_waitcnt vmcnt(15) lgkmcnt(5)
  v_mfma_f32_32x32x16_bf16 v[80:95], v[60:63], v[192:195], v[80:95]
  ds_read_b128 v[52:55], v2 offset:20480
  v_max_f32 v17, 0, v17
  v_add_f32 v17, 0x3727c5ac, v17
  v_rsq_f32 v68, v17
  s_waitcnt lgkmcnt(5)
  v_mfma_f32_32x32x16_bf16 v[96:111], v[32:35], v[156:159], v[96:111]
  ds_read_b128 v[56:59], v70 offset:9216
  v_mul_f32 v17, v17, v68
  v_and_b32 v18, 0xffff0000, v16
  v_sub_f32 v24, v16, v18
  v_and_b32 v19, 0xffff0000, v24
  s_waitcnt vmcnt(14) lgkmcnt(5)
  v_mfma_f32_32x32x16_bf16 v[80:95], v[36:39], v[196:199], v[80:95]
  ds_read_b128 v[60:63], v2 offset:21504
  v_sub_f32 v24, v24, v19
  v_and_b32 v20, 0xffff0000, v24
  v_and_b32 v21, 0xffff0000, v17
  v_sub_f32 v24, v17, v21
  s_waitcnt vmcnt(13) lgkmcnt(5)
  v_mfma_f32_32x32x16_bf16 v[80:95], v[40:43], v[200:203], v[80:95]
  ds_read_b128 v[32:35], v2 offset:22528
  v_and_b32 v22, 0xffff0000, v24
  v_sub_f32 v24, v24, v22
  v_and_b32 v23, 0xffff0000, v24
  v_lshrrev_b32 v72, 16, v18
  s_waitcnt lgkmcnt(5)
  v_mfma_f32_32x32x16_bf16 v[96:111], v[44:47], v[160:163], v[96:111]
  ds_read_b128 v[36:39], v70 offset:10240
  v_or_b32 v72, v72, v19
  v_lshrrev_b32 v73, 16, v20
  v_or_b32 v73, v73, v21
  v_lshrrev_b32 v74, 16, v22
  s_waitcnt vmcnt(12) lgkmcnt(5)
  v_mfma_f32_32x32x16_bf16 v[80:95], v[48:51], v[204:207], v[80:95]
  ds_read_b128 v[40:43], v2 offset:23552
  v_or_b32 v74, v74, v23
  v_lshrrev_b32 v75, 16, v18
  v_or_b32 v75, v75, v18
  v_mul_f32 v69, 0x3fb8aa3b, v68
  s_waitcnt vmcnt(11) lgkmcnt(5)
  v_mfma_f32_32x32x16_bf16 v[80:95], v[52:55], v[208:211], v[80:95]
  ds_read_b128 v[44:47], v2 offset:24576
  v_mul_f32 v66, -2.0, v68
  s_waitcnt lgkmcnt(5)
  v_mfma_f32_32x32x16_bf16 v[96:111], v[56:59], v[164:167], v[96:111]
  ds_read_b128 v[48:51], v70 offset:11264
  s_waitcnt vmcnt(10) lgkmcnt(5)
  v_mfma_f32_32x32x16_bf16 v[80:95], v[60:63], v[212:215], v[80:95]
  ds_read_b128 v[52:55], v2 offset:25600
  s_waitcnt vmcnt(9) lgkmcnt(5)
  v_mfma_f32_32x32x16_bf16 v[80:95], v[32:35], v[216:219], v[80:95]
  ds_read_b128 v[56:59], v2 offset:26624
  s_waitcnt lgkmcnt(5)
  v_mfma_f32_32x32x16_bf16 v[96:111], v[36:39], v[168:171], v[96:111]
  ds_read_b128 v[60:63], v70 offset:12288
  s_waitcnt vmcnt(8) lgkmcnt(5)
  v_mfma_f32_32x32x16_bf16 v[80:95], v[40:43], v[220:223], v[80:95]
  ds_read_b128 v[32:35], v2 offset:27648
  s_waitcnt vmcnt(7) lgkmcnt(5)
  v_mfma_f32_32x32x16_bf16 v[80:95], v[44:47], v[224:227], v[80:95]
  ds_read_b128 v[36:39], v2 offset:28672
  s_waitcnt lgkmcnt(5)
  v_mfma_f32_32x32x16_bf16 v[96:111], v[48:51], v[172:175], v[96:111]
  ds_read_b128 v[40:43], v70 offset:13312
  s_waitcnt vmcnt(6) lgkmcnt(5)
  v_mfma_f32_32x32x16_bf16 v[80:95], v[52:55], v[228:231], v[80:95]
  ds_read_b128 v[44:47], v2 offset:29696
  s_waitcnt vmcnt(5) lgkmcnt(5)
  v_mfma_f32_32x32x16_bf16 v[80:95], v[56:59], v[232:235], v[80:95]
  ds_read_b128 v[48:51], v2 offset:30720
  s_waitcnt lgkmcnt(5)
  v_mfma_f32_32x32x16_bf16 v[96:111], v[60:63], v[176:179], v[96:111]
  ds_read_b128 v[52:55], v70 offset:14336
  s_waitcnt vmcnt(4) lgkmcnt(5)
  v_mfma_f32_32x32x16_bf16 v[80:95], v[32:35], v[236:239], v[80:95]
  ds_read_b128 v[56:59], v2 offset:31744
  s_waitcnt vmcnt(3) lgkmcnt(5)
  v_mfma_f32_32x32x16_bf16 v[80:95], v[36:39], v[240:243], v[80:95]
  ds_read_b128 v[60:63], v2 offset:32768
  s_waitcnt lgkmcnt(5)
  v_mfma_f32_32x32x16_bf16 v[96:111], v[40:43], v[180:183], v[96:111]
  ds_read_b128 v[32:35], v70 offset:15360
  s_waitcnt vmcnt(2) lgkmcnt(5)
  v_mfma_f32_32x32x16_bf16 v[80:95], v[44:47], v[244:247], v[80:95]
  ds_read_b128 v[36:39], v70 offset:16384
  s_waitcnt vmcnt(1) lgkmcnt(5)
  v_mfma_f32_32x32x16_bf16 v[80:95], v[48:51], v[248:251], v[80:95]
  ds_read_b128 v[40:43], v70 offset:17408
  s_waitcnt lgkmcnt(5)
  v_mfma_f32_32x32x16_bf16 v[96:111], v[52:55], v[184:187], v[96:111]
  ds_read_b128 v[44:47], v70 offset:18432
  s_waitcnt vmcnt(0) lgkmcnt(5)
  v_mfma_f32_32x32x16_bf16 v[80:95], v[56:59], v[252:255], v[80:95]
  ds_read_b128 v[48:51], v70 offset:19456
  s_waitcnt lgkmcnt(5)
  v_mfma_f32_32x32x16_bf16 v[80:95], v[60:63], v[72:75], v[80:95]
  ds_read_b128 v[52:55], v70 offset:20480
  s_mov_b64 exec, 1
  ds_add_u32 v67, v79 offset:0
  s_mov_b64 exec, -1
  s_waitcnt lgkmcnt(5)
  v_mfma_f32_32x32x16_bf16 v[96:111], v[32:35], v[188:191], v[96:111]
  ds_read_b128 v[56:59], v70 offset:21504
  v_mfma_f32_32x32x16_bf16 v[96:111], v[36:39], v[192:195], v[96:111]
  ds_read_b128 v[60:63], v70 offset:22528
  s_waitcnt lgkmcnt(5)
  v_mfma_f32_32x32x16_bf16 v[96:111], v[40:43], v[196:199], v[96:111]
  ds_read_b128 v[32:35], v70 offset:23552
  v_mul_f32 v16, v69, v80
  v_mul_f32 v17, v69, v81
  v_mul_f32 v18, v69, v82
  v_mul_f32 v19, v69, v83
  v_mul_f32 v20, v69, v84
  v_mul_f32 v21, v69, v85
  v_mfma_f32_32x32x16_bf16 v[96:111], v[44:47], v[200:203], v[96:111]
  ds_read_b128 v[36:39], v70 offset:24576
  v_mul_f32 v22, v69, v86
  v_mul_f32 v23, v69, v87
  v_exp_f32 v16, v16
  v_exp_f32 v17, v17
  s_waitcnt lgkmcnt(5)
  v_mfma_f32_32x32x16_bf16 v[96:111], v[48:51], v[204:207], v[96:111]
  ds_read_b128 v[40:43], v70 offset:25600
  v_exp_f32 v18, v18
  v_exp_f32 v19, v19
  v_exp_f32 v20, v20
  v_mfma_f32_32x32x16_bf16 v[96:111], v[52:55], v[208:211], v[96:111]
  ds_read_b128 v[44:47], v70 offset:26624
  v_exp_f32 v21, v21
  v_exp_f32 v22, v22
  v_exp_f32 v23, v23
  s_waitcnt lgkmcnt(4)
  v_mfma_f32_32x32x16_bf16 v[96:111], v[56:59], v[212:215], v[96:111]
  ds_read_b128 v[48:51], v70 offset:27648
  v_add_f32 v24, 2.0, v16
  v_add_f32 v25, 2.0, v17
  v_add_f32 v26, 2.0, v18
  v_add_f32 v27, 2.0, v19
  v_add_f32 v28, 2.0, v20
  v_add_f32 v29, 2.0, v21
  v_mfma_f32_32x32x16_bf16 v[96:111], v[60:63], v[216:219], v[96:111]
  ds_read_b128 v[52:55], v70 offset:28672
  v_add_f32 v30, 2.0, v22
  v_add_f32 v31, 2.0, v23
  v_fma_f32 v16, v16, v24, 2.0
  v_fma_f32 v17, v17, v25, 2.0
  v_fma_f32 v18, v18, v26, 2.0
  v_fma_f32 v19, v19, v27, 2.0
  s_waitcnt lgkmcnt(4)
  v_mfma_f32_32x32x16_bf16 v[96:111], v[32:35], v[220:223], v[96:111]
  ds_read_b128 v[56:59], v70 offset:29696
  v_fma_f32 v20, v20, v28, 2.0
  v_fma_f32 v21, v21, v29, 2.0
  v_fma_f32 v22, v22, v30, 2.0
  v_fma_f32 v23, v23, v31, 2.0
  v_rcp_f32 v16, v16
  v_mfma_f32_32x32x16_bf16 v[96:111], v[36:39], v[224:227], v[96:111]
  ds_read_b128 v[60:63], v70 offset:30720
  v_rcp_f32 v17, v17
  v_rcp_f32 v18, v18
  v_rcp_f32 v19, v19
  s_waitcnt lgkmcnt(4)
  v_mfma_f32_32x32x16_bf16 v[96:111], v[40:43], v[228:231], v[96:111]
  ds_read_b128 v[32:35], v70 offset:31744
  v_rcp_f32 v20, v20
  v_rcp_f32 v21, v21
  v_rcp_f32 v22, v22
  v_mfma_f32_32x32x16_bf16 v[96:111], v[44:47], v[232:235], v[96:111]
  ds_read_b128 v[36:39], v70 offset:32768
  v_rcp_f32 v23, v23
  v_fma_f32 v16, v16, v66, v68
  v_fma_f32 v17, v17, v66, v68
  v_fma_f32 v18, v18, v66, v68
  v_fma_f32 v19, v19, v66, v68
  s_waitcnt lgkmcnt(4)
  v_mfma_f32_32x32x16_bf16 v[96:111], v[48:51], v[236:239], v[96:111]
  ds_read_b128 v[40:43], v71 offset:0
  v_fma_f32 v20, v20, v66, v68
  v_fma_f32 v21, v21, v66, v68
  v_fma_f32 v22, v22, v66, v68
  v_fma_f32 v23, v23, v66, v68
  v_mul_f32 v80, v16, v80
  v_mul_f32 v81, v17, v81
  v_mfma_f32_32x32x16_bf16 v[96:111], v[52:55], v[240:243], v[96:111]
  ds_read_b128 v[44:47], v71 offset:1024
  v_mul_f32 v82, v18, v82
  v_mul_f32 v83, v19, v83
  v_mul_f32 v84, v20, v84
  v_mul_f32 v85, v21, v85
  v_mul_f32 v86, v22, v86
  v_mul_f32 v87, v23, v87
  s_waitcnt lgkmcnt(4)
  v_mfma_f32_32x32x16_bf16 v[96:111], v[56:59], v[244:247], v[96:111]
  ds_read_b128 v[48:51], v71 offset:2048
  v_cvt_pk_bf16_f32 v80, v80, v81
  v_cvt_pk_bf16_f32 v81, v82, v83
  v_cvt_pk_bf16_f32 v82, v84, v85
  v_cvt_pk_bf16_f32 v83, v86, v87
  buffer_store_dwordx4 v[80:83], v2, s[4:7], s56 offen offset:0 sc1
  v_mfma_f32_32x32x16_bf16 v[96:111], v[60:63], v[248:251], v[96:111]
  ds_read_b128 v[52:55], v71 offset:3072
  v_mul_f32 v16, v69, v88
  v_mul_f32 v17, v69, v89
  v_mul_f32 v18, v69, v90
  v_mul_f32 v19, v69, v91
  v_mul_f32 v20, v69, v92
  v_mul_f32 v21, v69, v93
  s_waitcnt lgkmcnt(4)
  v_mfma_f32_32x32x16_bf16 v[96:111], v[32:35], v[252:255], v[96:111]
  ds_read_b128 v[56:59], v71 offset:4096
  v_mul_f32 v22, v69, v94
  v_mul_f32 v23, v69, v95
  v_exp_f32 v16, v16
  v_exp_f32 v17, v17
  v_mfma_f32_32x32x16_bf16 v[96:111], v[36:39], v[72:75], v[96:111]
  ds_read_b128 v[60:63], v71 offset:5120
  s_mov_b64 exec, 1
  ds_add_u32 v67, v79 offset:4
  s_mov_b64 exec, -1
  v_exp_f32 v18, v18
  v_exp_f32 v19, v19
  v_exp_f32 v20, v20
  s_waitcnt lgkmcnt(5)
  v_mfma_f32_32x32x16_bf16 v[112:127], v[40:43], v[128:131], 0
  ds_read_b128 v[32:35], v71 offset:6144
  v_exp_f32 v21, v21
  v_exp_f32 v22, v22
  v_exp_f32 v23, v23
  v_mfma_f32_32x32x16_bf16 v[112:127], v[44:47], v[132:135], v[112:127]
  ds_read_b128 v[36:39], v71 offset:7168
  v_add_f32 v24, 2.0, v16
  v_add_f32 v25, 2.0, v17
  v_add_f32 v26, 2.0, v18
  v_add_f32 v27, 2.0, v19
  v_add_f32 v28, 2.0, v20
  v_add_f32 v29, 2.0, v21
  s_waitcnt lgkmcnt(5)
  v_mfma_f32_32x32x16_bf16 v[112:127], v[48:51], v[136:139], v[112:127]
  ds_read_b128 v[40:43], v71 offset:8192
  v_add_f32 v30, 2.0, v22
  v_add_f32 v31, 2.0, v23
  v_fma_f32 v16, v16, v24, 2.0
  v_fma_f32 v17, v17, v25, 2.0
  v_fma_f32 v18, v18, v26, 2.0
  v_fma_f32 v19, v19, v27, 2.0
  v_mfma_f32_32x32x16_bf16 v[112:127], v[52:55], v[140:143], v[112:127]
  ds_read_b128 v[44:47], v71 offset:9216
  v_fma_f32 v20, v20, v28, 2.0
  v_fma_f32 v21, v21, v29, 2.0
  v_fma_f32 v22, v22, v30, 2.0
  v_fma_f32 v23, v23, v31, 2.0
  v_rcp_f32 v16, v16
  s_waitcnt lgkmcnt(5)
  v_mfma_f32_32x32x16_bf16 v[112:127], v[56:59], v[144:147], v[112:127]
  ds_read_b128 v[48:51], v71 offset:10240
  v_rcp_f32 v17, v17
  v_rcp_f32 v18, v18
  v_rcp_f32 v19, v19
  v_mfma_f32_32x32x16_bf16 v[112:127], v[60:63], v[148:151], v[112:127]
  ds_read_b128 v[52:55], v71 offset:11264
  v_rcp_f32 v20, v20
  v_rcp_f32 v21, v21
  v_rcp_f32 v22, v22
  s_waitcnt lgkmcnt(4)
  v_mfma_f32_32x32x16_bf16 v[112:127], v[32:35], v[152:155], v[112:127]
  ds_read_b128 v[56:59], v71 offset:12288
  v_rcp_f32 v23, v23
  v_fma_f32 v16, v16, v66, v68
  v_fma_f32 v17, v17, v66, v68
  v_fma_f32 v18, v18, v66, v68
  v_fma_f32 v19, v19, v66, v68
  v_mfma_f32_32x32x16_bf16 v[112:127], v[36:39], v[156:159], v[112:127]
  ds_read_b128 v[60:63], v71 offset:13312
  v_fma_f32 v20, v20, v66, v68
  v_fma_f32 v21, v21, v66, v68
  v_fma_f32 v22, v22, v66, v68
  v_fma_f32 v23, v23, v66, v68
  v_mul_f32 v88, v16, v88
  v_mul_f32 v89, v17, v89
  s_waitcnt lgkmcnt(4)
  v_mfma_f32_32x32x16_bf16 v[112:127], v[40:43], v[160:163], v[112:127]
  ds_read_b128 v[32:35], v71 offset:14336
  v_mul_f32 v90, v18, v90
  v_mul_f32 v91, v19, v91
  v_mul_f32 v92, v20, v92
  v_mul_f32 v93, v21, v93
  v_mul_f32 v94, v22, v94
  v_mul_f32 v95, v23, v95
  v_mfma_f32_32x32x16_bf16 v[112:127], v[44:47], v[164:167], v[112:127]
  ds_read_b128 v[36:39], v71 offset:15360
  v_cvt_pk_bf16_f32 v88, v88, v89
  v_cvt_pk_bf16_f32 v89, v90, v91
  v_cvt_pk_bf16_f32 v90, v92, v93
  v_cvt_pk_bf16_f32 v91, v94, v95
  buffer_store_dwordx4 v[88:91], v2, s[4:7], s56 offen offset:1024 sc1
  s_waitcnt lgkmcnt(4)
  v_mfma_f32_32x32x16_bf16 v[112:127], v[48:51], v[168:171], v[112:127]
  ds_read_b128 v[40:43], v71 offset:16384
  v_mul_f32 v16, v69, v96
  v_mul_f32 v17, v69, v97
  v_mul_f32 v18, v69, v98
  v_mul_f32 v19, v69, v99
  v_mul_f32 v20, v69, v100
  v_mul_f32 v21, v69, v101
  v_mfma_f32_32x32x16_bf16 v[112:127], v[52:55], v[172:175], v[112:127]
  ds_read_b128 v[44:47], v71 offset:17408
  v_mul_f32 v22, v69, v102
  v_mul_f32 v23, v69, v103
  v_exp_f32 v16, v16
  v_exp_f32 v17, v17
  s_waitcnt lgkmcnt(4)
  v_mfma_f32_32x32x16_bf16 v[112:127], v[56:59], v[176:179], v[112:127]
  ds_read_b128 v[48:51], v71 offset:18432
  v_exp_f32 v18, v18
  v_exp_f32 v19, v19
  v_exp_f32 v20, v20
  v_mfma_f32_32x32x16_bf16 v[112:127], v[60:63], v[180:183], v[112:127]
  ds_read_b128 v[52:55], v71 offset:19456
  v_exp_f32 v21, v21
  v_exp_f32 v22, v22
  v_exp_f32 v23, v23
  s_waitcnt lgkmcnt(4)
  v_mfma_f32_32x32x16_bf16 v[112:127], v[32:35], v[184:187], v[112:127]
  ds_read_b128 v[56:59], v71 offset:20480
  v_add_f32 v24, 2.0, v16
  v_add_f32 v25, 2.0, v17
  v_add_f32 v26, 2.0, v18
  v_add_f32 v27, 2.0, v19
  v_add_f32 v28, 2.0, v20
  v_add_f32 v29, 2.0, v21
  v_mfma_f32_32x32x16_bf16 v[112:127], v[36:39], v[188:191], v[112:127]
  ds_read_b128 v[60:63], v71 offset:21504
  v_add_f32 v30, 2.0, v22
  v_add_f32 v31, 2.0, v23
  v_fma_f32 v16, v16, v24, 2.0
  v_fma_f32 v17, v17, v25, 2.0
  v_fma_f32 v18, v18, v26, 2.0
  v_fma_f32 v19, v19, v27, 2.0
  s_waitcnt lgkmcnt(4)
  v_mfma_f32_32x32x16_bf16 v[112:127], v[40:43], v[192:195], v[112:127]
  ds_read_b128 v[32:35], v71 offset:22528
  v_fma_f32 v20, v20, v28, 2.0
  v_fma_f32 v21, v21, v29, 2.0
  v_fma_f32 v22, v22, v30, 2.0
  v_fma_f32 v23, v23, v31, 2.0
  v_rcp_f32 v16, v16
  v_mfma_f32_32x32x16_bf16 v[112:127], v[44:47], v[196:199], v[112:127]
  ds_read_b128 v[36:39], v71 offset:23552
  v_rcp_f32 v17, v17
  v_rcp_f32 v18, v18
  v_rcp_f32 v19, v19
  s_waitcnt lgkmcnt(4)
  v_mfma_f32_32x32x16_bf16 v[112:127], v[48:51], v[200:203], v[112:127]
  ds_read_b128 v[40:43], v71 offset:24576
  v_rcp_f32 v20, v20
  v_rcp_f32 v21, v21
  v_rcp_f32 v22, v22
  v_mfma_f32_32x32x16_bf16 v[112:127], v[52:55], v[204:207], v[112:127]
  ds_read_b128 v[44:47], v71 offset:25600
  v_rcp_f32 v23, v23
  v_fma_f32 v16, v16, v66, v68
  v_fma_f32 v17, v17, v66, v68
  v_fma_f32 v18, v18, v66, v68
  v_fma_f32 v19, v19, v66, v68
  s_waitcnt lgkmcnt(4)
  v_mfma_f32_32x32x16_bf16 v[112:127], v[56:59], v[208:211], v[112:127]
  ds_read_b128 v[48:51], v71 offset:26624
  v_fma_f32 v20, v20, v66, v68
  v_fma_f32 v21, v21, v66, v68
  v_fma_f32 v22, v22, v66, v68
  v_fma_f32 v23, v23, v66, v68
  v_mul_f32 v96, v16, v96
  v_mul_f32 v97, v17, v97
  v_mfma_f32_32x32x16_bf16 v[112:127], v[60:63], v[212:215], v[112:127]
  ds_read_b128 v[52:55], v71 offset:27648
  v_mul_f32 v98, v18, v98
  v_mul_f32 v99, v19, v99
  v_mul_f32 v100, v20, v100
  v_mul_f32 v101, v21, v101
  v_mul_f32 v102, v22, v102
  v_mul_f32 v103, v23, v103
  s_waitcnt lgkmcnt(4)
  v_mfma_f32_32x32x16_bf16 v[112:127], v[32:35], v[216:219], v[112:127]
  ds_read_b128 v[56:59], v71 offset:28672
  v_cvt_pk_bf16_f32 v96, v96, v97
  v_cvt_pk_bf16_f32 v97, v98, v99
  v_cvt_pk_bf16_f32 v98, v100, v101
  v_cvt_pk_bf16_f32 v99, v102, v103
  buffer_store_dwordx4 v[96:99], v2, s[4:7], s58 offen offset:2048 sc1
  v_mfma_f32_32x32x16_bf16 v[112:127], v[36:39], v[220:223], v[112:127]
  ds_read_b128 v[60:63], v71 offset:29696
  v_mul_f32 v16, v69, v104
  v_mul_f32 v17, v69, v105
  v_mul_f32 v18, v69, v106
  v_mul_f32 v19, v69, v107
  v_mul_f32 v20, v69, v108
  v_mul_f32 v21, v69, v109
  s_waitcnt lgkmcnt(4)
  v_mfma_f32_32x32x16_bf16 v[112:127], v[40:43], v[224:227], v[112:127]
  ds_read_b128 v[32:35], v71 offset:30720
  v_mul_f32 v22, v69, v110
  v_mul_f32 v23, v69, v111
  v_exp_f32 v16, v16
  v_exp_f32 v17, v17
  v_mfma_f32_32x32x16_bf16 v[112:127], v[44:47], v[228:231], v[112:127]
  ds_read_b128 v[36:39], v71 offset:31744
  v_exp_f32 v18, v18
  v_exp_f32 v19, v19
  v_exp_f32 v20, v20
  s_waitcnt lgkmcnt(4)
  v_mfma_f32_32x32x16_bf16 v[112:127], v[48:51], v[232:235], v[112:127]
  ds_read_b128 v[40:43], v71 offset:32768
  v_exp_f32 v21, v21
  v_exp_f32 v22, v22
  v_exp_f32 v23, v23
  v_mfma_f32_32x32x16_bf16 v[112:127], v[52:55], v[236:239], v[112:127]
  v_add_f32 v24, 2.0, v16
  v_add_f32 v25, 2.0, v17
  v_add_f32 v26, 2.0, v18
  v_add_f32 v27, 2.0, v19
  v_add_f32 v28, 2.0, v20
  v_add_f32 v29, 2.0, v21
  s_waitcnt lgkmcnt(3)
  v_mfma_f32_32x32x16_bf16 v[112:127], v[56:59], v[240:243], v[112:127]
  v_add_f32 v30, 2.0, v22
  v_add_f32 v31, 2.0, v23
  v_fma_f32 v16, v16, v24, 2.0
  v_fma_f32 v17, v17, v25, 2.0
  v_fma_f32 v18, v18, v26, 2.0
  v_fma_f32 v19, v19, v27, 2.0
  v_mfma_f32_32x32x16_bf16 v[112:127], v[60:63], v[244:247], v[112:127]
  v_fma_f32 v20, v20, v28, 2.0
  v_fma_f32 v21, v21, v29, 2.0
  v_fma_f32 v22, v22, v30, 2.0
  v_fma_f32 v23, v23, v31, 2.0
  v_rcp_f32 v16, v16
  s_waitcnt lgkmcnt(1)
  v_mfma_f32_32x32x16_bf16 v[112:127], v[32:35], v[248:251], v[112:127]
  v_rcp_f32 v17, v17
  v_rcp_f32 v18, v18
  v_rcp_f32 v19, v19
  v_mfma_f32_32x32x16_bf16 v[112:127], v[36:39], v[252:255], v[112:127]
  v_rcp_f32 v20, v20
  v_rcp_f32 v21, v21
  v_rcp_f32 v22, v22
  s_waitcnt lgkmcnt(0)
  v_mfma_f32_32x32x16_bf16 v[112:127], v[40:43], v[72:75], v[112:127]
  v_rcp_f32 v23, v23
  v_fma_f32 v16, v16, v66, v68
  v_fma_f32 v17, v17, v66, v68
  v_fma_f32 v18, v18, v66, v68
  v_fma_f32 v19, v19, v66, v68
  v_fma_f32 v20, v20, v66, v68
  v_fma_f32 v21, v21, v66, v68
  v_fma_f32 v22, v22, v66, v68
  v_fma_f32 v23, v23, v66, v68
  v_mul_f32 v104, v16, v104
  v_mul_f32 v105, v17, v105
  v_mul_f32 v106, v18, v106
  v_mul_f32 v107, v19, v107
  v_mul_f32 v108, v20, v108
  v_mul_f32 v109, v21, v109
  v_mul_f32 v110, v22, v110
  v_mul_f32 v111, v23, v111
  v_cvt_pk_bf16_f32 v104, v104, v105
  v_cvt_pk_bf16_f32 v105, v106, v107
  v_cvt_pk_bf16_f32 v106, v108, v109
  v_cvt_pk_bf16_f32 v107, v110, v111
  buffer_store_dwordx4 v[104:107], v2, s[4:7], s58 offen offset:3072 sc1
  v_pk_mul_f32 v[16:17], v[112:113], v[68:69] op_sel:[0,1] op_sel_hi:[1,1]
  v_pk_mul_f32 v[18:19], v[114:115], v[68:69] op_sel:[0,1] op_sel_hi:[1,1]
  v_pk_mul_f32 v[20:21], v[116:117], v[68:69] op_sel:[0,1] op_sel_hi:[1,1]
  v_pk_mul_f32 v[22:23], v[118:119], v[68:69] op_sel:[0,1] op_sel_hi:[1,1]
  v_exp_f32 v16, v16
  v_exp_f32 v17, v17
  v_exp_f32 v18, v18
  v_exp_f32 v19, v19
  v_exp_f32 v20, v20
  v_exp_f32 v21, v21
  v_exp_f32 v22, v22
  v_exp_f32 v23, v23
  v_pk_add_f32 v[24:25], v[16:17], 2.0 op_sel_hi:[1,0]
  v_pk_add_f32 v[26:27], v[18:19], 2.0 op_sel_hi:[1,0]
  v_pk_add_f32 v[28:29], v[20:21], 2.0 op_sel_hi:[1,0]
  v_pk_add_f32 v[30:31], v[22:23], 2.0 op_sel_hi:[1,0]
  v_pk_fma_f32 v[16:17], v[16:17], v[24:25], 2.0 op_sel_hi:[1,1,0]
  v_pk_fma_f32 v[18:19], v[18:19], v[26:27], 2.0 op_sel_hi:[1,1,0]
  v_pk_fma_f32 v[20:21], v[20:21], v[28:29], 2.0 op_sel_hi:[1,1,0]
  v_pk_fma_f32 v[22:23], v[22:23], v[30:31], 2.0 op_sel_hi:[1,1,0]
  v_rcp_f32 v16, v16
  v_rcp_f32 v17, v17
  v_rcp_f32 v18, v18
  v_rcp_f32 v19, v19
  v_rcp_f32 v20, v20
  v_rcp_f32 v21, v21
  v_rcp_f32 v22, v22
  v_rcp_f32 v23, v23
  v_pk_fma_f32 v[16:17], v[16:17], v[66:67], v[68:69] op_sel_hi:[1,0,0]
  v_pk_fma_f32 v[18:19], v[18:19], v[66:67], v[68:69] op_sel_hi:[1,0,0]
  v_pk_fma_f32 v[20:21], v[20:21], v[66:67], v[68:69] op_sel_hi:[1,0,0]
  v_pk_fma_f32 v[22:23], v[22:23], v[66:67], v[68:69] op_sel_hi:[1,0,0]
  v_pk_mul_f32 v[112:113], v[112:113], v[16:17]
  v_pk_mul_f32 v[114:115], v[114:115], v[18:19]
  v_pk_mul_f32 v[116:117], v[116:117], v[20:21]
  v_pk_mul_f32 v[118:119], v[118:119], v[22:23]
  v_cvt_pk_bf16_f32 v112, v112, v113
  v_cvt_pk_bf16_f32 v113, v114, v115
  v_cvt_pk_bf16_f32 v114, v116, v117
  v_cvt_pk_bf16_f32 v115, v118, v119
  buffer_store_dwordx4 v[112:115], v2, s[4:7], s57 offen offset:0 sc1
  v_pk_mul_f32 v[16:17], v[120:121], v[68:69] op_sel:[0,1] op_sel_hi:[1,1]
  v_pk_mul_f32 v[18:19], v[122:123], v[68:69] op_sel:[0,1] op_sel_hi:[1,1]
  v_pk_mul_f32 v[20:21], v[124:125], v[68:69] op_sel:[0,1] op_sel_hi:[1,1]
  v_pk_mul_f32 v[22:23], v[126:127], v[68:69] op_sel:[0,1] op_sel_hi:[1,1]
  v_exp_f32 v16, v16
  v_exp_f32 v17, v17
  v_exp_f32 v18, v18
  v_exp_f32 v19, v19
  v_exp_f32 v20, v20
  v_exp_f32 v21, v21
  v_exp_f32 v22, v22
  v_exp_f32 v23, v23
  v_pk_add_f32 v[24:25], v[16:17], 2.0 op_sel_hi:[1,0]
  v_pk_add_f32 v[26:27], v[18:19], 2.0 op_sel_hi:[1,0]
  v_pk_add_f32 v[28:29], v[20:21], 2.0 op_sel_hi:[1,0]
  v_pk_add_f32 v[30:31], v[22:23], 2.0 op_sel_hi:[1,0]
  v_pk_fma_f32 v[16:17], v[16:17], v[24:25], 2.0 op_sel_hi:[1,1,0]
  v_pk_fma_f32 v[18:19], v[18:19], v[26:27], 2.0 op_sel_hi:[1,1,0]
  v_pk_fma_f32 v[20:21], v[20:21], v[28:29], 2.0 op_sel_hi:[1,1,0]
  v_pk_fma_f32 v[22:23], v[22:23], v[30:31], 2.0 op_sel_hi:[1,1,0]
  v_rcp_f32 v16, v16
  v_rcp_f32 v17, v17
  v_rcp_f32 v18, v18
  v_rcp_f32 v19, v19
  v_rcp_f32 v20, v20
  v_rcp_f32 v21, v21
  v_rcp_f32 v22, v22
  v_rcp_f32 v23, v23
  v_pk_fma_f32 v[16:17], v[16:17], v[66:67], v[68:69] op_sel_hi:[1,0,0]
  v_pk_fma_f32 v[18:19], v[18:19], v[66:67], v[68:69] op_sel_hi:[1,0,0]
  v_pk_fma_f32 v[20:21], v[20:21], v[66:67], v[68:69] op_sel_hi:[1,0,0]
  v_pk_fma_f32 v[22:23], v[22:23], v[66:67], v[68:69] op_sel_hi:[1,0,0]
  v_pk_mul_f32 v[120:121], v[120:121], v[16:17]
  v_pk_mul_f32 v[122:123], v[122:123], v[18:19]
  v_pk_mul_f32 v[124:125], v[124:125], v[20:21]
  v_pk_mul_f32 v[126:127], v[126:127], v[22:23]
  v_cvt_pk_bf16_f32 v120, v120, v121
  v_cvt_pk_bf16_f32 v121, v122, v123
  v_cvt_pk_bf16_f32 v122, v124, v125
  v_cvt_pk_bf16_f32 v123, v126, v127
  buffer_store_dwordx4 v[120:123], v2, s[4:7], s57 offen offset:1024 sc1
  s_lshl_b32 s42, s36, 8
  s_add_u32 s42, s42, s28
  s_add_u32 s42, s42, 1048576
  s_mov_b32 s69, -1
  s_mov_b32 s97, 0
  s_mov_b32 s41, 1
main_skip_ffn1:
  s_mul_i32 s56, s21, 86
  s_add_u32 s56, s56, s33
  s_lshl_b32 s56, s56, 10
  s_mul_i32 s29, s26, 5636096
  s_add_u32 s56, s56, s29
  s_add_u32 s56, s56, 16777216
  s_add_u32 s57, s56, 88064
  s_lshl_b32 s58, s27, 1
  s_add_u32 s58, s58, s32
  s_add_u32 s58, s58, 32243712
  s_lshl_b32 s59, s20, 12
  s_lshl_b32 s54, s22, 8
  s_add_u32 s59, s59, s54
  s_mul_i32 s54, s26, 524288
  s_add_u32 s59, s59, s54
  s_add_u32 s59, s59, 36962304
  s_and_b32 s54, s12, 1
  s_add_u32 s54, s54, 0
  s_xor_b32 s55, s54, s12
  s_mul_i32 s54, s54, 3
  s_add_u32 s54, s54, s55
  s_lshl_b32 s54, s54, 12
  s_add_u32 s54, s54, 97280
  v_add_u32 v240, s54, v2
  s_and_b32 s54, s12, 1
  s_xor_b32 s54, s54, 1
  s_add_u32 s54, s54, 0
  s_xor_b32 s55, s54, s12
  s_mul_i32 s54, s54, 3
  s_add_u32 s54, s54, s55
  s_lshl_b32 s54, s54, 12
  s_add_u32 s54, s54, 97280
  v_add_u32 v241, s54, v2
  s_and_b32 s54, s12, 1
  s_add_u32 s54, s54, 2
  s_xor_b32 s55, s54, s12
  s_mul_i32 s54, s54, 3
  s_add_u32 s54, s54, s55
  s_lshl_b32 s54, s54, 12
  s_add_u32 s54, s54, 97280
  v_add_u32 v242, s54, v2
  s_and_b32 s54, s12, 1
  s_xor_b32 s54, s54, 1
  s_add_u32 s54, s54, 2
  s_xor_b32 s55, s54, s12
  s_mul_i32 s54, s54, 3
  s_add_u32 s54, s54, s55
  s_lshl_b32 s54, s54, 12
  s_add_u32 s54, s54, 97280
  v_add_u32 v243, s54, v2
  s_mul_i32 s55, s12, 12288
  s_add_u32 s55, s55, 101376
  v_add_u32 v244, s55, v2
  v_and_b32 v245, 31, v1
  v_lshlrev_b32 v245, 10, v245
  v_lshrrev_b32 v246, 5, v1
  v_lshl_add_u32 v245, v246, 4, v245
  s_lshl_b32 s53, s20, 15
  s_lshl_b32 s54, s22, 6
  s_add_u32 s53, s53, s54
  s_cmp_ge_u32 s12, 2
  s_cbranch_scc1 main_f2_bar
  s_cmp_lg_u32 s41, 1
  s_cbranch_scc1 sge_67
  s_waitcnt vmcnt(0)
  s_mov_b64 exec, 1
  v_mov_b32 v0, 1
  s_cmp_eq_u32 s69, -1
  s_cbranch_scc0 sa_68
  s_mov_b64 exec, s[94:95]
  v_mov_b32 v0, 1
  buffer_store_dword v0, v3, s[4:7], s42 offen sc1
  s_branch sb_69
sa_68:
  buffer_atomic_add v0, v3, s[4:7], s42 offen sc0 sc1
sb_69:
  s_mov_b64 exec, -1
  s_mov_b32 s41, s97
sge_67:
  s_cmp_eq_u32 s26, 1
  s_cbranch_scc1 main_noq
  s_cmp_eq_u32 s16, 15
  s_cselect_b32 s63, 0, 4
  v_mov_b32 v4, 157696
  s_mov_b32 s51, 0
lspin_70:
  ds_read_b32 v5, v4 offset:0
  s_add_u32 s51, s51, 1
  s_waitcnt lgkmcnt(0)
  v_readfirstlane_b32 s52, v5
  s_cmp_ge_u32 s52, s63
  s_cbranch_scc1 lok_71
  s_cmp_lt_u32 s51, 16777216
  s_cbranch_scc1 lspin_70
lok_71:
  s_mul_i32 s60, s16, 33792
  s_and_b32 s64, s12, 1
  s_mul_i32 s64, s64, 16384
  s_add_u32 s61, s60, s64
  s_add_u32 s61, s61, 38289408
  s_add_u32 s60, s60, 38322176
  s_add_u32 m0, s64, 0
  s_add_u32 s62, s61, 0
  buffer_load_dwordx4 v2, s[4:7], s62 offen offset:0 sc1 lds
  buffer_load_dwordx4 v2, s[4:7], s62 offen offset:1024 sc1 lds
  buffer_load_dwordx4 v2, s[4:7], s62 offen offset:2048 sc1 lds
  buffer_load_dwordx4 v2, s[4:7], s62 offen offset:3072 sc1 lds
  s_add_u32 m0, s64, 4096
  s_add_u32 s62, s61, 4096
  buffer_load_dwordx4 v2, s[4:7], s62 offen offset:0 sc1 lds
  buffer_load_dwordx4 v2, s[4:7], s62 offen offset:1024 sc1 lds
  buffer_load_dwordx4 v2, s[4:7], s62 offen offset:2048 sc1 lds
  buffer_load_dwordx4 v2, s[4:7], s62 offen offset:3072 sc1 lds
  s_cmp_lg_u32 s41, 2
  s_cbranch_scc1 sge_72
  s_waitcnt vmcnt(8)
  v_readfirstlane_b32 s52, v0
  s_cmp_lg_u32 s52, s69
  s_cbranch_scc1 notlast_73
  s_mov_b64 exec, 1
  v_mov_b32 v0, 1
  buffer_store_dword v0, v3, s[4:7], s42 offen offset:256 sc1
  s_mov_b64 exec, -1
notlast_73:
  s_mov_b32 s41, 0
sge_72:
  s_add_u32 m0, s64, 8192
  s_add_u32 s62, s61, 8192
  buffer_load_dwordx4 v2, s[4:7], s62 offen offset:0 sc1 lds
  buffer_load_dwordx4 v2, s[4:7], s62 offen offset:1024 sc1 lds
  buffer_load_dwordx4 v2, s[4:7], s62 offen offset:2048 sc1 lds
  buffer_load_dwordx4 v2, s[4:7], s62 offen offset:3072 sc1 lds
  s_add_u32 m0, s64, 12288
  s_add_u32 s62, s61, 12288
  buffer_load_dwordx4 v2, s[4:7], s62 offen offset:0 sc1 lds
  buffer_load_dwordx4 v2, s[4:7], s62 offen offset:1024 sc1 lds
  buffer_load_dwordx4 v2, s[4:7], s62 offen offset:2048 sc1 lds
  buffer_load_dwordx4 v2, s[4:7], s62 offen offset:3072 sc1 lds
  s_mov_b32 m0, 32768
  s_nop 0
  buffer_load_dwordx4 v2, s[4:7], s60 offen sc1 lds
  s_mov_b32 s51, 0
lspin_74:
  ds_read_b32 v5, v4 offset:4
  s_add_u32 s51, s51, 1
  s_waitcnt lgkmcnt(0)
  v_readfirstlane_b32 s52, v5
  s_cmp_ge_u32 s52, s63
  s_cbranch_scc1 lok_75
  s_cmp_lt_u32 s51, 16777216
  s_cbranch_scc1 lspin_74
lok_75:
  s_mul_i32 s60, s16, 33792
  s_and_b32 s64, s12, 1
  s_mul_i32 s64, s64, 16384
  s_add_u32 s61, s60, s64
  s_add_u32 s61, s61, 38830080
  s_add_u32 s60, s60, 38862848
  s_add_u32 m0, s64, 33792
  s_add_u32 s62, s61, 0
  buffer_load_dwordx4 v2, s[4:7], s62 offen offset:0 sc1 lds
  buffer_load_dwordx4 v2, s[4:7], s62 offen offset:1024 sc1 lds
  buffer_load_dwordx4 v2, s[4:7], s62 offen offset:2048 sc1 lds
  buffer_load_dwordx4 v2, s[4:7], s62 offen offset:3072 sc1 lds
  s_add_u32 m0, s64, 37888
  s_add_u32 s62, s61, 4096
  buffer_load_dwordx4 v2, s[4:7], s62 offen offset:0 sc1 lds
  buffer_load_dwordx4 v2, s[4:7], s62 offen offset:1024 sc1 lds
  buffer_load_dwordx4 v2, s[4:7], s62 offen offset:2048 sc1 lds
  buffer_load_dwordx4 v2, s[4:7], s62 offen offset:3072 sc1 lds
  s_add_u32 m0, s64, 41984
  s_add_u32 s62, s61, 8192
  buffer_load_dwordx4 v2, s[4:7], s62 offen offset:0 sc1 lds
  buffer_load_dwordx4 v2, s[4:7], s62 offen offset:1024 sc1 lds
  buffer_load_dwordx4 v2, s[4:7], s62 offen offset:2048 sc1 lds
  buffer_load_dwordx4 v2, s[4:7], s62 offen offset:3072 sc1 lds
  s_add_u32 m0, s64, 46080
  s_add_u32 s62, s61, 12288
  buffer_load_dwordx4 v2, s[4:7], s62 offen offset:0 sc1 lds
  buffer_load_dwordx4 v2, s[4:7], s62 offen offset:1024 sc1 lds
  buffer_load_dwordx4 v2, s[4:7], s62 offen offset:2048 sc1 lds
  buffer_load_dwordx4 v2, s[4:7], s62 offen offset:3072 sc1 lds
  s_mov_b32 m0, 66560
  s_nop 0
  buffer_load_dwordx4 v2, s[4:7], s60 offen sc1 lds
main_noq:
  s_cmp_lg_u32 s41, 2
  s_cbranch_scc1 sge_76
  s_waitcnt vmcnt(0)
  v_readfirstlane_b32 s52, v0
  s_cmp_lg_u32 s52, s69
  s_cbranch_scc1 notlast_77
  s_mov_b64 exec, 1
  v_mov_b32 v0, 1
  buffer_store_dword v0, v3, s[4:7], s42 offen offset:256 sc1
  s_mov_b64 exec, -1
notlast_77:
  s_mov_b32 s41, 0
sge_76:
  s_lshl_b32 s50, s86, 8
  s_add_u32 s50, s50, s28
  s_add_u32 s50, s50, 1048576
  v_lshlrev_b32 v4, 8, v1
  s_mov_b32 s51, 0
poll_79:
  s_mov_b64 exec, 32767
  buffer_load_dword v5, v4, s[4:7], s50 offen offset:0 sc1
  s_mov_b64 exec, -1
  s_add_u32 s51, s51, 1
  s_waitcnt vmcnt(0)
  s_mov_b64 exec, 32767
  v_cmp_ne_u32 vcc, 1, v5
  s_mov_b64 exec, -1
  s_cmp_eq_u64 vcc, 0
  s_cbranch_scc1 go_78
  s_cmp_lt_u32 s51, 2097152
  s_cbranch_scc1 poll_79
go_78:
main_f2_bar:
  s_cmp_lg_u32 s41, 1
  s_cbranch_scc1 sge_80
  s_waitcnt vmcnt(0)
  s_mov_b64 exec, 1
  v_mov_b32 v0, 1
  s_cmp_eq_u32 s69, -1
  s_cbranch_scc0 sa_81
  s_mov_b64 exec, s[94:95]
  v_mov_b32 v0, 1
  buffer_store_dword v0, v3, s[4:7], s42 offen sc1
  s_branch sb_82
sa_81:
  buffer_atomic_add v0, v3, s[4:7], s42 offen sc0 sc1
sb_82:
  s_mov_b64 exec, -1
  s_mov_b32 s41, s97
sge_80:
  s_barrier
  buffer_load_dwordx4 v[80:83], v2, s[4:7], s56 offen offset:0 sc1
  buffer_load_dwordx4 v[84:87], v2, s[4:7], s56 offen offset:1024 sc1
  buffer_load_dwordx4 v[88:91], v2, s[4:7], s56 offen offset:2048 sc1
  buffer_load_dwordx4 v[92:95], v2, s[4:7], s56 offen offset:3072 sc1
  s_add_u32 s56, s56, 4096
  s_cmp_lg_u32 s41, 2
  s_cbranch_scc1 sge_83
  s_waitcnt vmcnt(4)
  v_readfirstlane_b32 s52, v0
  s_cmp_lg_u32 s52, s69
  s_cbranch_scc1 notlast_84
  s_mov_b64 exec, 1
  v_mov_b32 v0, 1
  buffer_store_dword v0, v3, s[4:7], s42 offen offset:256 sc1
  s_mov_b64 exec, -1
notlast_84:
  s_mov_b32 s41, 0
sge_83:
  s_cmp_lg_u32 s41, 1
  s_cbranch_scc1 sge_85
  s_waitcnt vmcnt(4)
  s_mov_b64 exec, 1
  v_mov_b32 v0, 1
  s_cmp_eq_u32 s69, -1
  s_cbranch_scc0 sa_86
  s_mov_b64 exec, s[94:95]
  v_mov_b32 v0, 1
  buffer_store_dword v0, v3, s[4:7], s42 offen sc1
  s_branch sb_87
sa_86:
  buffer_atomic_add v0, v3, s[4:7], s42 offen sc0 sc1
sb_87:
  s_mov_b64 exec, -1
  s_mov_b32 s41, s97
sge_85:
  buffer_load_dwordx4 v[96:99], v2, s[4:7], s56 offen offset:0 sc1
  buffer_load_dwordx4 v[100:103], v2, s[4:7], s56 offen offset:1024 sc1
  buffer_load_dwordx4 v[104:107], v2, s[4:7], s56 offen offset:2048 sc1
  buffer_load_dwordx4 v[108:111], v2, s[4:7], s56 offen offset:3072 sc1
  s_add_u32 s56, s56, 4096
  buffer_load_dwordx4 v[112:115], v2, s[4:7], s56 offen offset:0 sc1
  buffer_load_dwordx4 v[116:119], v2, s[4:7], s56 offen offset:1024 sc1
  buffer_load_dwordx4 v[120:123], v2, s[4:7], s56 offen offset:2048 sc1
  buffer_load_dwordx4 v[124:127], v2, s[4:7], s56 offen offset:3072 sc1
  s_add_u32 s56, s56, 4096
  s_waitcnt vmcnt(11)
  s_cmp_lt_u32 s12, 2
  s_cbranch_scc1 ffn2_s0_88
  v_mov_b32 v80, 0
  v_mov_b32 v81, 0
  v_mov_b32 v82, 0
  v_mov_b32 v83, 0
ffn2_s0_88:
  s_nop 1
  v_mfma_f32_32x32x16_bf16 v[32:47], a[68:71], v[80:83], 0
  buffer_load_dwordx4 v[128:131], v2, s[4:7], s56 offen offset:0 sc1
  v_mfma_f32_32x32x16_bf16 v[16:31], a[64:67], v[80:83], 0
  s_waitcnt vmcnt(11)
  v_mfma_f32_32x32x16_bf16 v[32:47], a[76:79], v[84:87], v[32:47]
  buffer_load_dwordx4 v[132:135], v2, s[4:7], s56 offen offset:1024 sc1
  v_mfma_f32_32x32x16_bf16 v[16:31], a[72:75], v[84:87], v[16:31]
  s_waitcnt vmcnt(11)
  v_mfma_f32_32x32x16_bf16 v[32:47], a[84:87], v[88:91], v[32:47]
  buffer_load_dwordx4 v[136:139], v2, s[4:7], s56 offen offset:2048 sc1
  v_mfma_f32_32x32x16_bf16 v[16:31], a[80:83], v[88:91], v[16:31]
  s_waitcnt vmcnt(11)
  v_mfma_f32_32x32x16_bf16 v[32:47], a[92:95], v[92:95], v[32:47]
  buffer_load_dwordx4 v[140:143], v2, s[4:7], s56 offen offset:3072 sc1
  s_add_u32 s56, s56, 4096
  v_mfma_f32_32x32x16_bf16 v[16:31], a[88:91], v[92:95], v[16:31]
  s_waitcnt vmcnt(11)
  v_mfma_f32_32x32x16_bf16 v[32:47], a[100:103], v[96:99], v[32:47]
  s_cmp_lg_u32 s41, 2
  s_cbranch_scc1 sge_89
  s_waitcnt vmcnt(12)
  v_readfirstlane_b32 s52, v0
  s_cmp_lg_u32 s52, s69
  s_cbranch_scc1 notlast_90
  s_mov_b64 exec, 1
  v_mov_b32 v0, 1
  buffer_store_dword v0, v3, s[4:7], s42 offen offset:256 sc1
  s_mov_b64 exec, -1
notlast_90:
  s_mov_b32 s41, 0
sge_89:
  buffer_load_dwordx4 v[144:147], v2, s[4:7], s56 offen offset:0 sc1
  v_mfma_f32_32x32x16_bf16 v[16:31], a[96:99], v[96:99], v[16:31]
  s_waitcnt vmcnt(11)
  v_mfma_f32_32x32x16_bf16 v[32:47], a[108:111], v[100:103], v[32:47]
  buffer_load_dwordx4 v[148:151], v2, s[4:7], s56 offen offset:1024 sc1
  v_mfma_f32_32x32x16_bf16 v[16:31], a[104:107], v[100:103], v[16:31]
  s_waitcnt vmcnt(11)
  v_mfma_f32_32x32x16_bf16 v[32:47], a[116:119], v[104:107], v[32:47]
  buffer_load_dwordx4 v[152:155], v2, s[4:7], s56 offen offset:2048 sc1
  v_mfma_f32_32x32x16_bf16 v[16:31], a[112:115], v[104:107], v[16:31]
  s_waitcnt vmcnt(11)
  v_mfma_f32_32x32x16_bf16 v[32:47], a[124:127], v[108:111], v[32:47]
  buffer_load_dwordx4 v[156:159], v2, s[4:7], s56 offen offset:3072 sc1
  s_add_u32 s56, s56, 4096
  v_mfma_f32_32x32x16_bf16 v[16:31], a[120:123], v[108:111], v[16:31]
  s_waitcnt vmcnt(11)
  v_mfma_f32_32x32x16_bf16 v[32:47], a[132:135], v[112:115], v[32:47]
  buffer_load_dwordx4 v[160:163], v2, s[4:7], s56 offen offset:0 sc1
  v_mfma_f32_32x32x16_bf16 v[16:31], a[128:131], v[112:115], v[16:31]
  s_waitcnt vmcnt(11)
  v_mfma_f32_32x32x16_bf16 v[32:47], a[140:143], v[116:119], v[32:47]
  buffer_load_dwordx4 v[164:167], v2, s[4:7], s56 offen offset:1024 sc1
  v_mfma_f32_32x32x16_bf16 v[16:31], a[136:139], v[116:119], v[16:31]
  s_waitcnt vmcnt(11)
  v_mfma_f32_32x32x16_bf16 v[32:47], a[148:151], v[120:123], v[32:47]
  v_mfma_f32_32x32x16_bf16 v[16:31], a[144:147], v[120:123], v[16:31]
  s_cmp_lg_u32 s12, 3
  s_cbranch_scc1 f2_nopoll
  s_lshl_b32 s50, s86, 8
  s_add_u32 s50, s50, s28
  s_add_u32 s50, s50, 1052672
  v_lshlrev_b32 v4, 8, v1
  s_mov_b32 s51, 0
poll_92:
  s_mov_b64 exec, 32767
  buffer_load_dword v5, v4, s[4:7], s50 offen offset:0 sc1
  s_mov_b64 exec, -1
  s_add_u32 s51, s51, 1
  s_waitcnt vmcnt(0)
  s_mov_b64 exec, 32767
  v_cmp_ne_u32 vcc, 1, v5
  s_mov_b64 exec, -1
  s_cmp_eq_u64 vcc, 0
  s_cbranch_scc1 go_91
  s_cmp_lt_u32 s51, 2097152
  s_cbranch_scc1 poll_92
go_91:
f2_nopoll:
  s_barrier
  buffer_load_dwordx4 v[168:171], v2, s[4:7], s57 offen offset:0 sc1
  s_waitcnt vmcnt(11)
  v_mfma_f32_32x32x16_bf16 v[32:47], a[156:159], v[124:127], v[32:47]
  buffer_load_dwordx4 v[172:175], v2, s[4:7], s57 offen offset:1024 sc1
  v_mfma_f32_32x32x16_bf16 v[16:31], a[152:155], v[124:127], v[16:31]
  s_waitcnt vmcnt(11)
  v_mfma_f32_32x32x16_bf16 v[32:47], a[164:167], v[128:131], v[32:47]
  buffer_load_dwordx4 v[80:83], v2, s[4:7], s57 offen offset:2048 sc1
  v_mfma_f32_32x32x16_bf16 v[16:31], a[160:163], v[128:131], v[16:31]
  s_waitcnt vmcnt(11)
  v_mfma_f32_32x32x16_bf16 v[32:47], a[172:175], v[132:135], v[32:47]
  buffer_load_dwordx4 v[84:87], v2, s[4:7], s57 offen offset:3072 sc1
  s_add_u32 s57, s57, 4096
  v_mfma_f32_32x32x16_bf16 v[16:31], a[168:171], v[132:135], v[16:31]
  s_waitcnt vmcnt(11)
  v_mfma_f32_32x32x16_bf16 v[32:47], a[180:183], v[136:139], v[32:47]
  buffer_load_dwordx4 v[88:91], v2, s[4:7], s57 offen offset:0 sc1
  v_mfma_f32_32x32x16_bf16 v[16:31], a[176:179], v[136:139], v[16:31]
  s_waitcnt vmcnt(11)
  v_mfma_f32_32x32x16_bf16 v[32:47], a[188:191], v[140:143], v[32:47]
  buffer_load_dwordx4 v[92:95], v2, s[4:7], s57 offen offset:1024 sc1
  v_mfma_f32_32x32x16_bf16 v[16:31], a[184:187], v[140:143], v[16:31]
  s_waitcnt vmcnt(11)
  v_mfma_f32_32x32x16_bf16 v[32:47], a[196:199], v[144:147], v[32:47]
  buffer_load_dwordx4 v[96:99], v2, s[4:7], s57 offen offset:2048 sc1
  v_mfma_f32_32x32x16_bf16 v[16:31], a[192:195], v[144:147], v[16:31]
  s_waitcnt vmcnt(11)
  v_mfma_f32_32x32x16_bf16 v[32:47], a[204:207], v[148:151], v[32:47]
  buffer_load_dwordx4 v[100:103], v2, s[4:7], s57 offen offset:3072 sc1
  s_add_u32 s57, s57, 4096
  v_mfma_f32_32x32x16_bf16 v[16:31], a[200:203], v[148:151], v[16:31]
  s_waitcnt vmcnt(11)
  v_mfma_f32_32x32x16_bf16 v[32:47], a[212:215], v[152:155], v[32:47]
  buffer_load_dwordx4 v[104:107], v2, s[4:7], s57 offen offset:0 sc1
  v_mfma_f32_32x32x16_bf16 v[16:31], a[208:211], v[152:155], v[16:31]
  s_waitcnt vmcnt(11)
  v_mfma_f32_32x32x16_bf16 v[32:47], a[220:223], v[156:159], v[32:47]
  buffer_load_dwordx4 v[108:111], v2, s[4:7], s57 offen offset:1024 sc1
  v_mfma_f32_32x32x16_bf16 v[16:31], a[216:219], v[156:159], v[16:31]
  s_waitcnt vmcnt(11)
  v_mfma_f32_32x32x16_bf16 v[32:47], a[228:231], v[160:163], v[32:47]
  buffer_load_dwordx4 v[112:115], v2, s[4:7], s57 offen offset:2048 sc1
  v_mfma_f32_32x32x16_bf16 v[16:31], a[224:227], v[160:163], v[16:31]
  s_waitcnt vmcnt(11)
  v_mfma_f32_32x32x16_bf16 v[32:47], a[236:239], v[164:167], v[32:47]
  buffer_load_dwordx4 v[116:119], v2, s[4:7], s57 offen offset:3072 sc1
  s_add_u32 s57, s57, 4096
  v_mfma_f32_32x32x16_bf16 v[16:31], a[232:235], v[164:167], v[16:31]
  s_cmp_lt_u32 s12, 2
  s_cbranch_scc1 f2_own_93
  s_waitcnt vmcnt(11)
  s_cmp_lt_u32 s12, 2
  s_cbranch_scc1 ffn2_s0_96
  v_mov_b32 v168, 0
  v_mov_b32 v169, 0
  v_mov_b32 v170, 0
  v_mov_b32 v171, 0
ffn2_s0_96:
  s_nop 1
  v_mfma_f32_32x32x16_bf16 v[64:79], a[68:71], v[168:171], 0
  buffer_load_dwordx4 v[120:123], v2, s[4:7], s57 offen offset:0 sc1
  v_mfma_f32_32x32x16_bf16 v[48:63], a[64:67], v[168:171], 0
  ds_write_b128 v241, v[32:35] offset:0
  ds_write_b128 v241, v[36:39] offset:1024
  s_waitcnt vmcnt(11)
  v_mfma_f32_32x32x16_bf16 v[64:79], a[76:79], v[172:175], v[64:79]
  buffer_load_dwordx4 v[124:127], v2, s[4:7], s57 offen offset:1024 sc1
  ds_write_b128 v241, v[40:43] offset:2048
  ds_write_b128 v241, v[44:47] offset:3072
  v_mfma_f32_32x32x16_bf16 v[48:63], a[72:75], v[172:175], v[48:63]
  ds_write_b128 v240, v[16:19] offset:0
  ds_write_b128 v240, v[20:23] offset:1024
  s_waitcnt vmcnt(11)
  v_mfma_f32_32x32x16_bf16 v[64:79], a[84:87], v[80:83], v[64:79]
  buffer_load_dwordx4 v[128:131], v2, s[4:7], s57 offen offset:2048 sc1
  ds_write_b128 v240, v[24:27] offset:2048
  ds_write_b128 v240, v[28:31] offset:3072
  v_mfma_f32_32x32x16_bf16 v[48:63], a[80:83], v[80:83], v[48:63]
  s_waitcnt vmcnt(11)
  v_mfma_f32_32x32x16_bf16 v[64:79], a[92:95], v[84:87], v[64:79]
  buffer_load_dwordx4 v[132:135], v2, s[4:7], s57 offen offset:3072 sc1
  s_add_u32 s57, s57, 4096
  s_waitcnt lgkmcnt(0)
  s_barrier
  v_mfma_f32_32x32x16_bf16 v[48:63], a[88:91], v[84:87], v[48:63]
  s_waitcnt vmcnt(11)
  v_mfma_f32_32x32x16_bf16 v[64:79], a[100:103], v[88:91], v[64:79]
  buffer_load_dwordx4 v[136:139], v2, s[4:7], s57 offen offset:0 sc1
  v_mfma_f32_32x32x16_bf16 v[48:63], a[96:99], v[88:91], v[48:63]
  s_waitcnt vmcnt(11)
  v_mfma_f32_32x32x16_bf16 v[64:79], a[108:111], v[92:95], v[64:79]
  buffer_load_dwordx4 v[140:143], v2, s[4:7], s57 offen offset:1024 sc1
  v_mfma_f32_32x32x16_bf16 v[48:63], a[104:107], v[92:95], v[48:63]
  s_waitcnt vmcnt(11)
  v_mfma_f32_32x32x16_bf16 v[64:79], a[116:119], v[96:99], v[64:79]
  buffer_load_dwordx4 v[144:147], v2, s[4:7], s57 offen offset:2048 sc1
  v_mfma_f32_32x32x16_bf16 v[48:63], a[112:115], v[96:99], v[48:63]
  s_waitcnt vmcnt(11)
  v_mfma_f32_32x32x16_bf16 v[64:79], a[124:127], v[100:103], v[64:79]
  buffer_load_dwordx4 v[148:151], v2, s[4:7], s57 offen offset:3072 sc1
  s_add_u32 s57, s57, 4096
  v_mfma_f32_32x32x16_bf16 v[48:63], a[120:123], v[100:103], v[48:63]
  s_waitcnt vmcnt(11)
  v_mfma_f32_32x32x16_bf16 v[64:79], a[132:135], v[104:107], v[64:79]
  buffer_load_dwordx4 v[152:155], v2, s[4:7], s57 offen offset:0 sc1
  v_mfma_f32_32x32x16_bf16 v[48:63], a[128:131], v[104:107], v[48:63]
  s_waitcnt vmcnt(11)
  v_mfma_f32_32x32x16_bf16 v[64:79], a[140:143], v[108:111], v[64:79]
  buffer_load_dwordx4 v[156:159], v2, s[4:7], s57 offen offset:1024 sc1
  v_mfma_f32_32x32x16_bf16 v[48:63], a[136:139], v[108:111], v[48:63]
  s_waitcnt vmcnt(11)
  v_mfma_f32_32x32x16_bf16 v[64:79], a[148:151], v[112:115], v[64:79]
  v_mfma_f32_32x32x16_bf16 v[48:63], a[144:147], v[112:115], v[48:63]
  s_waitcnt vmcnt(10)
  v_mfma_f32_32x32x16_bf16 v[64:79], a[156:159], v[116:119], v[64:79]
  v_mfma_f32_32x32x16_bf16 v[48:63], a[152:155], v[116:119], v[48:63]
  s_waitcnt vmcnt(9)
  v_mfma_f32_32x32x16_bf16 v[64:79], a[164:167], v[120:123], v[64:79]
  v_mfma_f32_32x32x16_bf16 v[48:63], a[160:163], v[120:123], v[48:63]
  s_waitcnt vmcnt(8)
  v_mfma_f32_32x32x16_bf16 v[64:79], a[172:175], v[124:127], v[64:79]
  v_mfma_f32_32x32x16_bf16 v[48:63], a[168:171], v[124:127], v[48:63]
  s_waitcnt vmcnt(7)
  v_mfma_f32_32x32x16_bf16 v[64:79], a[180:183], v[128:131], v[64:79]
  v_mfma_f32_32x32x16_bf16 v[48:63], a[176:179], v[128:131], v[48:63]
  s_waitcnt vmcnt(6)
  v_mfma_f32_32x32x16_bf16 v[64:79], a[188:191], v[132:135], v[64:79]
  v_mfma_f32_32x32x16_bf16 v[48:63], a[184:187], v[132:135], v[48:63]
  s_waitcnt vmcnt(5)
  v_mfma_f32_32x32x16_bf16 v[64:79], a[196:199], v[136:139], v[64:79]
  v_mfma_f32_32x32x16_bf16 v[48:63], a[192:195], v[136:139], v[48:63]
  s_waitcnt vmcnt(4)
  v_mfma_f32_32x32x16_bf16 v[64:79], a[204:207], v[140:143], v[64:79]
  v_mfma_f32_32x32x16_bf16 v[48:63], a[200:203], v[140:143], v[48:63]
  s_waitcnt vmcnt(3)
  v_mfma_f32_32x32x16_bf16 v[64:79], a[212:215], v[144:147], v[64:79]
  v_mfma_f32_32x32x16_bf16 v[48:63], a[208:211], v[144:147], v[48:63]
  s_waitcnt vmcnt(2)
  v_mfma_f32_32x32x16_bf16 v[64:79], a[220:223], v[148:151], v[64:79]
  s_waitcnt vmcnt(1)
  v_mfma_f32_32x32x16_bf16 v[64:79], a[228:231], v[152:155], v[64:79]
  s_waitcnt vmcnt(0)
  v_mfma_f32_32x32x16_bf16 v[64:79], a[236:239], v[156:159], v[64:79]
  v_mfma_f32_32x32x16_bf16 v[48:63], a[216:219], v[148:151], v[48:63]
  v_mfma_f32_32x32x16_bf16 v[48:63], a[224:227], v[152:155], v[48:63]
  v_mfma_f32_32x32x16_bf16 v[48:63], a[232:235], v[156:159], v[48:63]
  s_branch f2_join_94
f2_own_93:
  s_waitcnt vmcnt(11)
  s_cmp_lt_u32 s12, 2
  s_cbranch_scc1 ffn2_s0_98
  v_mov_b32 v168, 0
  v_mov_b32 v169, 0
  v_mov_b32 v170, 0
  v_mov_b32 v171, 0
ffn2_s0_98:
  s_nop 1
  v_mfma_f32_32x32x16_bf16 v[64:79], a[68:71], v[168:171], 0
  buffer_load_dwordx4 v[120:123], v2, s[4:7], s57 offen offset:0 sc1
  v_mfma_f32_32x32x16_bf16 v[48:63], a[64:67], v[168:171], 0
  ds_write_b128 v241, v[32:35] offset:0
  ds_write_b128 v241, v[36:39] offset:1024
  s_waitcnt vmcnt(11)
  v_mfma_f32_32x32x16_bf16 v[64:79], a[76:79], v[172:175], v[64:79]
  buffer_load_dwordx4 v[124:127], v2, s[4:7], s57 offen offset:1024 sc1
  ds_write_b128 v241, v[40:43] offset:2048
  ds_write_b128 v241, v[44:47] offset:3072
  v_mfma_f32_32x32x16_bf16 v[48:63], a[72:75], v[172:175], v[48:63]
  s_waitcnt vmcnt(11)
  v_mfma_f32_32x32x16_bf16 v[64:79], a[84:87], v[80:83], v[64:79]
  buffer_load_dwordx4 v[128:131], v2, s[4:7], s57 offen offset:2048 sc1
  v_mfma_f32_32x32x16_bf16 v[48:63], a[80:83], v[80:83], v[48:63]
  s_waitcnt vmcnt(11)
  v_mfma_f32_32x32x16_bf16 v[64:79], a[92:95], v[84:87], v[64:79]
  buffer_load_dwordx4 v[132:135], v2, s[4:7], s57 offen offset:3072 sc1
  s_add_u32 s57, s57, 4096
  s_waitcnt lgkmcnt(0)
  s_barrier
  v_mfma_f32_32x32x16_bf16 v[48:63], a[88:91], v[84:87], v[48:63]
  ds_read_b128 v[176:179], v244 offset:0
  ds_read_b128 v[180:183], v244 offset:1024
  ds_read_b128 v[184:187], v244 offset:2048
  ds_read_b128 v[188:191], v244 offset:3072
  ds_read_b128 v[192:195], v244 offset:4096
  ds_read_b128 v[196:199], v244 offset:5120
  s_waitcnt vmcnt(11)
  v_mfma_f32_32x32x16_bf16 v[64:79], a[100:103], v[88:91], v[64:79]
  buffer_load_dwordx4 v[136:139], v2, s[4:7], s57 offen offset:0 sc1
  ds_read_b128 v[200:203], v244 offset:6144
  ds_read_b128 v[204:207], v244 offset:7168
  ds_read_b128 v[208:211], v244 offset:8192
  ds_read_b128 v[212:215], v244 offset:9216
  ds_read_b128 v[216:219], v244 offset:10240
  ds_read_b128 v[220:223], v244 offset:11264
  v_mfma_f32_32x32x16_bf16 v[48:63], a[96:99], v[88:91], v[48:63]
  v_lshlrev_b32 v224, 16, v8
  v_and_b32 v225, 0xffff0000, v8
  v_lshlrev_b32 v226, 16, v9
  v_and_b32 v227, 0xffff0000, v9
  v_lshlrev_b32 v228, 16, v10
  v_and_b32 v229, 0xffff0000, v10
  s_waitcnt vmcnt(11)
  v_mfma_f32_32x32x16_bf16 v[64:79], a[108:111], v[92:95], v[64:79]
  buffer_load_dwordx4 v[140:143], v2, s[4:7], s57 offen offset:1024 sc1
  v_lshlrev_b32 v230, 16, v11
  v_and_b32 v231, 0xffff0000, v11
  v_lshlrev_b32 v232, 16, v12
  v_and_b32 v233, 0xffff0000, v12
  v_lshlrev_b32 v234, 16, v13
  v_and_b32 v235, 0xffff0000, v13
  v_mfma_f32_32x32x16_bf16 v[48:63], a[104:107], v[92:95], v[48:63]
  v_lshlrev_b32 v236, 16, v14
  v_and_b32 v237, 0xffff0000, v14
  v_lshlrev_b32 v238, 16, v15
  v_and_b32 v239, 0xffff0000, v15
  v_add_f32 v16, v16, v224
  v_add_f32 v17, v17, v225
  s_waitcnt vmcnt(11)
  v_mfma_f32_32x32x16_bf16 v[64:79], a[116:119], v[96:99], v[64:79]
  buffer_load_dwordx4 v[144:147], v2, s[4:7], s57 offen offset:2048 sc1
  v_add_f32 v18, v18, v226
  v_add_f32 v19, v19, v227
  v_add_f32 v20, v20, v228
  v_add_f32 v21, v21, v229
  v_add_f32 v22, v22, v230
  v_add_f32 v23, v23, v231
  v_mfma_f32_32x32x16_bf16 v[48:63], a[112:115], v[96:99], v[48:63]
  v_add_f32 v24, v24, v232
  v_add_f32 v25, v25, v233
  v_add_f32 v26, v26, v234
  v_add_f32 v27, v27, v235
  v_add_f32 v28, v28, v236
  v_add_f32 v29, v29, v237
  s_waitcnt vmcnt(11)
  v_mfma_f32_32x32x16_bf16 v[64:79], a[124:127], v[100:103], v[64:79]
  buffer_load_dwordx4 v[148:151], v2, s[4:7], s57 offen offset:3072 sc1
  s_add_u32 s57, s57, 4096
  v_add_f32 v30, v30, v238
  v_add_f32 v31, v31, v239
  s_waitcnt lgkmcnt(8)
  v_add_f32 v16, v16, v176
  v_add_f32 v17, v17, v177
  v_add_f32 v18, v18, v178
  v_mfma_f32_32x32x16_bf16 v[48:63], a[120:123], v[100:103], v[48:63]
  v_add_f32 v19, v19, v179
  v_add_f32 v20, v20, v180
  v_add_f32 v21, v21, v181
  v_add_f32 v22, v22, v182
  v_add_f32 v23, v23, v183
  v_add_f32 v24, v24, v184
  s_waitcnt vmcnt(11)
  v_mfma_f32_32x32x16_bf16 v[64:79], a[132:135], v[104:107], v[64:79]
  buffer_load_dwordx4 v[152:155], v2, s[4:7], s57 offen offset:0 sc1
  v_add_f32 v25, v25, v185
  v_add_f32 v26, v26, v186
  v_add_f32 v27, v27, v187
  v_add_f32 v28, v28, v188
  v_add_f32 v29, v29, v189
  v_add_f32 v30, v30, v190
  v_mfma_f32_32x32x16_bf16 v[48:63], a[128:131], v[104:107], v[48:63]
  v_add_f32 v31, v31, v191
  s_waitcnt lgkmcnt(4)
  v_add_f32 v16, v16, v192
  v_add_f32 v17, v17, v193
  v_add_f32 v18, v18, v194
  v_add_f32 v19, v19, v195
  s_waitcnt vmcnt(11)
  v_mfma_f32_32x32x16_bf16 v[64:79], a[140:143], v[108:111], v[64:79]
  buffer_load_dwordx4 v[156:159], v2, s[4:7], s57 offen offset:1024 sc1
  v_add_f32 v20, v20, v196
  v_add_f32 v21, v21, v197
  v_add_f32 v22, v22, v198
  v_add_f32 v23, v23, v199
  v_add_f32 v24, v24, v200
  v_add_f32 v25, v25, v201
  v_mfma_f32_32x32x16_bf16 v[48:63], a[136:139], v[108:111], v[48:63]
  v_add_f32 v26, v26, v202
  v_add_f32 v27, v27, v203
  v_add_f32 v28, v28, v204
  v_add_f32 v29, v29, v205
  v_add_f32 v30, v30, v206
  v_add_f32 v31, v31, v207
  s_waitcnt vmcnt(11)
  v_mfma_f32_32x32x16_bf16 v[64:79], a[148:151], v[112:115], v[64:79]
  s_waitcnt lgkmcnt(0)
  v_add_f32 v16, v16, v208
  v_add_f32 v17, v17, v209
  v_add_f32 v18, v18, v210
  v_add_f32 v19, v19, v211
  v_add_f32 v20, v20, v212
  v_mfma_f32_32x32x16_bf16 v[48:63], a[144:147], v[112:115], v[48:63]
  v_add_f32 v21, v21, v213
  v_add_f32 v22, v22, v214
  v_add_f32 v23, v23, v215
  v_add_f32 v24, v24, v216
  v_add_f32 v25, v25, v217
  v_add_f32 v26, v26, v218
  s_waitcnt vmcnt(10)
  v_mfma_f32_32x32x16_bf16 v[64:79], a[156:159], v[116:119], v[64:79]
  v_add_f32 v27, v27, v219
  v_add_f32 v28, v28, v220
  v_add_f32 v29, v29, v221
  v_add_f32 v30, v30, v222
  v_add_f32 v31, v31, v223
  v_cvt_pk_bf16_f32 v8, v16, v17
  v_mfma_f32_32x32x16_bf16 v[48:63], a[152:155], v[116:119], v[48:63]
  v_cvt_pk_bf16_f32 v9, v18, v19
  v_cvt_pk_bf16_f32 v10, v20, v21
  v_cvt_pk_bf16_f32 v11, v22, v23
  v_cvt_pk_bf16_f32 v12, v24, v25
  v_cvt_pk_bf16_f32 v13, v26, v27
  v_cvt_pk_bf16_f32 v14, v28, v29
  s_waitcnt vmcnt(9)
  v_mfma_f32_32x32x16_bf16 v[64:79], a[164:167], v[120:123], v[64:79]
  v_cvt_pk_bf16_f32 v15, v30, v31
  s_cmp_eq_u32 s26, 0
  s_cbranch_scc1 notfinal_99
  v_permlane32_swap_b32 v8, v10
  v_permlane32_swap_b32 v9, v11
  buffer_store_dwordx4 v[8:11], v245, s[8:11], s53 offen offset:0
  v_permlane32_swap_b32 v12, v14
  v_permlane32_swap_b32 v13, v15
  buffer_store_dwordx4 v[12:15], v245, s[8:11], s53 offen offset:32
  s_branch stored_100
notfinal_99:
  buffer_store_dwordx4 v[8:11], v2, s[4:7], s58 offen sc1
  buffer_store_dwordx4 v[12:15], v2, s[4:7], s58 offen offset:1024 sc1
stored_100:
  v_add_f32 v6, v16, v17
  v_mul_f32 v7, v16, v16
  v_fmac_f32 v7, v17, v17
  v_add_f32 v6, v6, v18
  v_mfma_f32_32x32x16_bf16 v[48:63], a[160:163], v[120:123], v[48:63]
  v_fmac_f32 v7, v18, v18
  v_add_f32 v6, v6, v19
  v_fmac_f32 v7, v19, v19
  v_add_f32 v6, v6, v20
  v_fmac_f32 v7, v20, v20
  v_add_f32 v6, v6, v21
  s_waitcnt vmcnt(10)
  v_mfma_f32_32x32x16_bf16 v[64:79], a[172:175], v[124:127], v[64:79]
  v_fmac_f32 v7, v21, v21
  v_add_f32 v6, v6, v22
  v_fmac_f32 v7, v22, v22
  v_add_f32 v6, v6, v23
  v_fmac_f32 v7, v23, v23
  v_add_f32 v6, v6, v24
  v_mfma_f32_32x32x16_bf16 v[48:63], a[168:171], v[124:127], v[48:63]
  v_fmac_f32 v7, v24, v24
  v_add_f32 v6, v6, v25
  v_fmac_f32 v7, v25, v25
  v_add_f32 v6, v6, v26
  v_fmac_f32 v7, v26, v26
  v_add_f32 v6, v6, v27
  s_waitcnt vmcnt(9)
  v_mfma_f32_32x32x16_bf16 v[64:79], a[180:183], v[128:131], v[64:79]
  v_fmac_f32 v7, v27, v27
  v_add_f32 v6, v6, v28
  v_fmac_f32 v7, v28, v28
  v_add_f32 v6, v6, v29
  v_fmac_f32 v7, v29, v29
  v_add_f32 v6, v6, v30
  v_mfma_f32_32x32x16_bf16 v[48:63], a[176:179], v[128:131], v[48:63]
  v_fmac_f32 v7, v30, v30
  v_add_f32 v6, v6, v31
  v_fmac_f32 v7, v31, v31
  s_nop 1
  v_permlane32_swap_b32 v6, v7
  v_add_f32 v6, v6, v7
  buffer_store_dword v6, v3, s[4:7], s59 offen sc1
  s_waitcnt vmcnt(9)
  v_mfma_f32_32x32x16_bf16 v[64:79], a[188:191], v[132:135], v[64:79]
  s_lshl_b32 s42, s84, 8
  s_add_u32 s42, s42, s28
  s_add_u32 s42, s42, 1310720
  s_mov_b32 s69, -1
  s_mov_b32 s97, 0
  s_mov_b32 s41, 1
  v_mfma_f32_32x32x16_bf16 v[48:63], a[184:187], v[132:135], v[48:63]
  s_waitcnt vmcnt(8)
  v_mfma_f32_32x32x16_bf16 v[64:79], a[196:199], v[136:139], v[64:79]
  v_mfma_f32_32x32x16_bf16 v[48:63], a[192:195], v[136:139], v[48:63]
  s_waitcnt vmcnt(7)
  v_mfma_f32_32x32x16_bf16 v[64:79], a[204:207], v[140:143], v[64:79]
  v_mfma_f32_32x32x16_bf16 v[48:63], a[200:203], v[140:143], v[48:63]
  s_waitcnt vmcnt(6)
  v_mfma_f32_32x32x16_bf16 v[64:79], a[212:215], v[144:147], v[64:79]
  v_mfma_f32_32x32x16_bf16 v[48:63], a[208:211], v[144:147], v[48:63]
  s_waitcnt vmcnt(5)
  v_mfma_f32_32x32x16_bf16 v[64:79], a[220:223], v[148:151], v[64:79]
  s_waitcnt vmcnt(4)
  v_mfma_f32_32x32x16_bf16 v[64:79], a[228:231], v[152:155], v[64:79]
  s_waitcnt vmcnt(3)
  v_mfma_f32_32x32x16_bf16 v[64:79], a[236:239], v[156:159], v[64:79]
  v_mfma_f32_32x32x16_bf16 v[48:63], a[216:219], v[148:151], v[48:63]
  v_mfma_f32_32x32x16_bf16 v[48:63], a[224:227], v[152:155], v[48:63]
  v_mfma_f32_32x32x16_bf16 v[48:63], a[232:235], v[156:159], v[48:63]
  s_cmp_eq_u32 s26, 1
  s_cselect_b32 s41, 0, s41
  s_cmp_lg_u32 s41, 1
  s_cbranch_scc1 sge_101
  s_waitcnt vmcnt(0)
  s_mov_b64 exec, 1
  v_mov_b32 v0, 1
  s_cmp_eq_u32 s69, -1
  s_cbranch_scc0 sa_102
  s_mov_b64 exec, s[94:95]
  v_mov_b32 v0, 1
  buffer_store_dword v0, v3, s[4:7], s42 offen sc1
  s_branch sb_103
sa_102:
  buffer_atomic_add v0, v3, s[4:7], s42 offen sc0 sc1
sb_103:
  s_mov_b64 exec, -1
  s_mov_b32 s41, s97
sge_101:
f2_join_94:
  s_lshl_b32 s50, s85, 8
  s_add_u32 s50, s50, s28
  s_add_u32 s50, s50, 1310720
  v_lshlrev_b32 v4, 8, v1
  s_mov_b64 exec, 65535
  buffer_load_dword v5, v4, s[4:7], s50 offen offset:0 sc1
  s_mov_b64 exec, -1
  s_nop 0
  ds_write_b128 v243, v[64:67] offset:0
  ds_write_b128 v243, v[68:71] offset:1024
  ds_write_b128 v243, v[72:75] offset:2048
  ds_write_b128 v243, v[76:79] offset:3072
  s_lshr_b32 s54, s12, 1
  s_cmp_eq_u32 s54, 1
  s_cbranch_scc1 b_self_104
  ds_write_b128 v242, v[48:51] offset:0
  ds_write_b128 v242, v[52:55] offset:1024
  ds_write_b128 v242, v[56:59] offset:2048
  ds_write_b128 v242, v[60:63] offset:3072
b_self_104:
  s_waitcnt lgkmcnt(0)
  s_barrier
  s_lshr_b32 s54, s12, 1
  s_cmp_lg_u32 s54, 1
  s_cbranch_scc1 b_notown_105
  ds_read_b128 v[176:179], v244 offset:0
  ds_read_b128 v[180:183], v244 offset:1024
  ds_read_b128 v[184:187], v244 offset:2048
  ds_read_b128 v[188:191], v244 offset:3072
  ds_read_b128 v[192:195], v244 offset:4096
  ds_read_b128 v[196:199], v244 offset:5120
  ds_read_b128 v[200:203], v244 offset:6144
  ds_read_b128 v[204:207], v244 offset:7168
  ds_read_b128 v[208:211], v244 offset:8192
  ds_read_b128 v[212:215], v244 offset:9216
  ds_read_b128 v[216:219], v244 offset:10240
  ds_read_b128 v[220:223], v244 offset:11264
  v_lshlrev_b32 v224, 16, v8
  v_and_b32 v225, 0xffff0000, v8
  v_lshlrev_b32 v226, 16, v9
  v_and_b32 v227, 0xffff0000, v9
  v_lshlrev_b32 v228, 16, v10
  v_and_b32 v229, 0xffff0000, v10
  v_lshlrev_b32 v230, 16, v11
  v_and_b32 v231, 0xffff0000, v11
  v_lshlrev_b32 v232, 16, v12
  v_and_b32 v233, 0xffff0000, v12
  v_lshlrev_b32 v234, 16, v13
  v_and_b32 v235, 0xffff0000, v13
  v_lshlrev_b32 v236, 16, v14
  v_and_b32 v237, 0xffff0000, v14
  v_lshlrev_b32 v238, 16, v15
  v_and_b32 v239, 0xffff0000, v15
  v_pk_add_f32 v[48:49], v[48:49], v[224:225]
  v_pk_add_f32 v[50:51], v[50:51], v[226:227]
  v_pk_add_f32 v[52:53], v[52:53], v[228:229]
  v_pk_add_f32 v[54:55], v[54:55], v[230:231]
  v_pk_add_f32 v[56:57], v[56:57], v[232:233]
  v_pk_add_f32 v[58:59], v[58:59], v[234:235]
  v_pk_add_f32 v[60:61], v[60:61], v[236:237]
  v_pk_add_f32 v[62:63], v[62:63], v[238:239]
  s_waitcnt lgkmcnt(8)
  v_pk_add_f32 v[48:49], v[48:49], v[176:177]
  v_pk_add_f32 v[50:51], v[50:51], v[178:179]
  v_pk_add_f32 v[52:53], v[52:53], v[180:181]
  v_pk_add_f32 v[54:55], v[54:55], v[182:183]
  v_pk_add_f32 v[56:57], v[56:57], v[184:185]
  v_pk_add_f32 v[58:59], v[58:59], v[186:187]
  v_pk_add_f32 v[60:61], v[60:61], v[188:189]
  v_pk_add_f32 v[62:63], v[62:63], v[190:191]
  s_waitcnt lgkmcnt(4)
  v_pk_add_f32 v[48:49], v[48:49], v[192:193]
  v_pk_add_f32 v[50:51], v[50:51], v[194:195]
  v_pk_add_f32 v[52:53], v[52:53], v[196:197]
  v_pk_add_f32 v[54:55], v[54:55], v[198:199]
  v_pk_add_f32 v[56:57], v[56:57], v[200:201]
  v_pk_add_f32 v[58:59], v[58:59], v[202:203]
  v_pk_add_f32 v[60:61], v[60:61], v[204:205]
  v_pk_add_f32 v[62:63], v[62:63], v[206:207]
  s_waitcnt lgkmcnt(0)
  v_pk_add_f32 v[48:49], v[48:49], v[208:209]
  v_pk_add_f32 v[50:51], v[50:51], v[210:211]
  v_pk_add_f32 v[52:53], v[52:53], v[212:213]
  v_pk_add_f32 v[54:55], v[54:55], v[214:215]
  v_pk_add_f32 v[56:57], v[56:57], v[216:217]
  v_pk_add_f32 v[58:59], v[58:59], v[218:219]
  v_pk_add_f32 v[60:61], v[60:61], v[220:221]
  v_pk_add_f32 v[62:63], v[62:63], v[222:223]
  v_cvt_pk_bf16_f32 v8, v48, v49
  v_cvt_pk_bf16_f32 v9, v50, v51
  v_cvt_pk_bf16_f32 v10, v52, v53
  v_cvt_pk_bf16_f32 v11, v54, v55
  v_cvt_pk_bf16_f32 v12, v56, v57
  v_cvt_pk_bf16_f32 v13, v58, v59
  v_cvt_pk_bf16_f32 v14, v60, v61
  v_cvt_pk_bf16_f32 v15, v62, v63
  s_cmp_eq_u32 s26, 0
  s_cbranch_scc1 notfinal_106
  v_permlane32_swap_b32 v8, v10
  v_permlane32_swap_b32 v9, v11
  buffer_store_dwordx4 v[8:11], v245, s[8:11], s53 offen offset:0
  v_permlane32_swap_b32 v12, v14
  v_permlane32_swap_b32 v13, v15
  buffer_store_dwordx4 v[12:15], v245, s[8:11], s53 offen offset:32
  s_branch b_notown_105
notfinal_106:
  buffer_store_dwordx4 v[8:11], v2, s[4:7], s58 offen sc1
  buffer_store_dwordx4 v[12:15], v2, s[4:7], s58 offen offset:1024 sc1
  v_pk_add_f32 v[176:177], v[48:49], v[50:51]
  v_pk_mul_f32 v[178:179], v[48:49], v[48:49]
  v_pk_fma_f32 v[178:179], v[50:51], v[50:51], v[178:179]
  v_pk_add_f32 v[176:177], v[176:177], v[52:53]
  v_pk_fma_f32 v[178:179], v[52:53], v[52:53], v[178:179]
  v_pk_add_f32 v[176:177], v[176:177], v[54:55]
  v_pk_fma_f32 v[178:179], v[54:55], v[54:55], v[178:179]
  v_pk_add_f32 v[176:177], v[176:177], v[56:57]
  v_pk_fma_f32 v[178:179], v[56:57], v[56:57], v[178:179]
  v_pk_add_f32 v[176:177], v[176:177], v[58:59]
  v_pk_fma_f32 v[178:179], v[58:59], v[58:59], v[178:179]
  v_pk_add_f32 v[176:177], v[176:177], v[60:61]
  v_pk_fma_f32 v[178:179], v[60:61], v[60:61], v[178:179]
  v_pk_add_f32 v[176:177], v[176:177], v[62:63]
  v_pk_fma_f32 v[178:179], v[62:63], v[62:63], v[178:179]
  v_add_f32 v6, v176, v177
  v_add_f32 v7, v178, v179
  s_nop 1
  v_permlane32_swap_b32 v6, v7
  v_add_f32 v6, v6, v7
  buffer_store_dword v6, v3, s[4:7], s59 offen sc1
  s_lshl_b32 s42, s84, 8
  s_add_u32 s42, s42, s28
  s_add_u32 s42, s42, 1310720
  s_mov_b32 s69, -1
  s_mov_b32 s97, 0
  s_mov_b32 s41, 1
b_notown_105:
  s_cmp_lg_u32 s41, 1
  s_cbranch_scc1 sge_109
  s_waitcnt vmcnt(0)
  s_mov_b64 exec, 1
  v_mov_b32 v0, 1
  s_cmp_eq_u32 s69, -1
  s_cbranch_scc0 sa_110
  s_mov_b64 exec, s[94:95]
  v_mov_b32 v0, 1
  buffer_store_dword v0, v3, s[4:7], s42 offen sc1
  s_branch sb_111
sa_110:
  buffer_atomic_add v0, v3, s[4:7], s42 offen sc0 sc1
sb_111:
  s_mov_b64 exec, -1
  s_mov_b32 s41, s97
sge_109:
  s_lshr_b32 s54, s12, 1
  s_andn2_b32 s54, s54, s26
  s_cbranch_scc0 f2_nc_108
  s_mul_i32 s60, s16, 33792
  s_and_b32 s64, s12, 1
  s_mul_i32 s64, s64, 16384
  s_add_u32 s61, s60, s64
  s_add_u32 s61, s61, 37748736
  s_add_u32 s60, s60, 37781504
  s_add_u32 m0, s64, 67584
  s_add_u32 s62, s61, 0
  buffer_load_dwordx4 v2, s[4:7], s62 offen offset:0 sc1 lds
  buffer_load_dwordx4 v2, s[4:7], s62 offen offset:1024 sc1 lds
  buffer_load_dwordx4 v2, s[4:7], s62 offen offset:2048 sc1 lds
  buffer_load_dwordx4 v2, s[4:7], s62 offen offset:3072 sc1 lds
  s_add_u32 m0, s64, 71680
  s_add_u32 s62, s61, 4096
  buffer_load_dwordx4 v2, s[4:7], s62 offen offset:0 sc1 lds
  buffer_load_dwordx4 v2, s[4:7], s62 offen offset:1024 sc1 lds
  buffer_load_dwordx4 v2, s[4:7], s62 offen offset:2048 sc1 lds
  buffer_load_dwordx4 v2, s[4:7], s62 offen offset:3072 sc1 lds
  s_cmp_lg_u32 s41, 2
  s_cbranch_scc1 sge_112
  s_waitcnt vmcnt(8)
  v_readfirstlane_b32 s52, v0
  s_cmp_lg_u32 s52, s69
  s_cbranch_scc1 notlast_113
  s_mov_b64 exec, 1
  v_mov_b32 v0, 1
  buffer_store_dword v0, v3, s[4:7], s42 offen offset:256 sc1
  s_mov_b64 exec, -1
notlast_113:
  s_mov_b32 s41, 0
sge_112:
  s_add_u32 m0, s64, 75776
  s_add_u32 s62, s61, 8192
  buffer_load_dwordx4 v2, s[4:7], s62 offen offset:0 sc1 lds
  buffer_load_dwordx4 v2, s[4:7], s62 offen offset:1024 sc1 lds
  buffer_load_dwordx4 v2, s[4:7], s62 offen offset:2048 sc1 lds
  buffer_load_dwordx4 v2, s[4:7], s62 offen offset:3072 sc1 lds
  s_add_u32 m0, s64, 79872
  s_add_u32 s62, s61, 12288
  buffer_load_dwordx4 v2, s[4:7], s62 offen offset:0 sc1 lds
  buffer_load_dwordx4 v2, s[4:7], s62 offen offset:1024 sc1 lds
  buffer_load_dwordx4 v2, s[4:7], s62 offen offset:2048 sc1 lds
  buffer_load_dwordx4 v2, s[4:7], s62 offen offset:3072 sc1 lds
  s_mov_b32 m0, 100352
  s_nop 0
  buffer_load_dwordx4 v2, s[4:7], s60 offen sc1 lds
  s_waitcnt vmcnt(0)
  v_mov_b32 v6, 157696
  v_mov_b32 v7, 1
  s_mov_b64 exec, 1
  ds_add_u32 v6, v7 offset:8
  s_mov_b64 exec, -1
f2_nc_108:
  s_cmp_lg_u32 s41, 1
  s_cbranch_scc1 sge_114
  s_waitcnt vmcnt(0)
  s_mov_b64 exec, 1
  v_mov_b32 v0, 1
  s_cmp_eq_u32 s69, -1
  s_cbranch_scc0 sa_115
  s_mov_b64 exec, s[94:95]
  v_mov_b32 v0, 1
  buffer_store_dword v0, v3, s[4:7], s42 offen sc1
  s_branch sb_116
sa_115:
  buffer_atomic_add v0, v3, s[4:7], s42 offen sc0 sc1
sb_116:
  s_mov_b64 exec, -1
  s_mov_b32 s41, s97
sge_114:
  s_cmp_lg_u32 s41, 2
  s_cbranch_scc1 sge_117
  s_waitcnt vmcnt(0)
  v_readfirstlane_b32 s52, v0
  s_cmp_lg_u32 s52, s69
  s_cbranch_scc1 notlast_118
  s_mov_b64 exec, 1
  v_mov_b32 v0, 1
  buffer_store_dword v0, v3, s[4:7], s42 offen offset:256 sc1
  s_mov_b64 exec, -1
notlast_118:
  s_mov_b32 s41, 0
sge_117:
  s_cmp_eq_u32 s26, 1
  s_cbranch_scc1 main_end
  s_mov_b32 s26, 1
  s_mov_b32 s27, 2097152
  s_add_u32 s28, s28, 1572864
  s_branch main_layer
main_end:
  s_endpgm
.section .rodata,"a"
.p2align 6
.amdhsa_kernel interleave_layers__mha_block__dense_activation_mish__prompt_kernel
  .amdhsa_next_free_vgpr 512
  .amdhsa_next_free_sgpr 102
  .amdhsa_accum_offset 256
  .amdhsa_group_segment_fixed_size 0
  .amdhsa_kernarg_size 80
  .amdhsa_user_sgpr_count 2
  .amdhsa_user_sgpr_kernarg_segment_ptr 1
  .amdhsa_system_sgpr_workgroup_id_x 1
.end_amdhsa_kernel
```
